```python
import torch

def _softmax(x, axis=-1):
    return torch.softmax(x, dim=axis)
def _gelu(x):
    return torch.nn.functional.gelu(x, approximate="tanh")
def _silu(x):
    return torch.nn.functional.silu(x)
def _sigmoid(x):
    return torch.sigmoid(x)
def _layernorm(x, axis=-1, eps=1e-5):
    m = x.mean(dim=axis, keepdim=True)
    v = x.var(dim=axis, keepdim=True, unbiased=False)
    return (x - m) / torch.sqrt(v + eps)
def _scatter_add(tgt, idx, src, axis=0):
    return tgt.clone().index_add_(axis, idx, src)
def _segment_sum(src, seg, n):
    out = torch.zeros((n,) + src.shape[1:], dtype=src.dtype)
    return out.index_add_(0, seg, src)
def _pad(x, pw):
    flat = tuple(v for pair in reversed(pw) for v in pair)
    return torch.nn.functional.pad(x, flat)

kernel_name = 'concat_heads__mha_block_cached__gqa_block_cached__near_ridge'

def setup_inputs():

    _w = (lambda a: (lambda t: t.to(torch.bfloat16) if t.is_floating_point() else t)(torch.as_tensor(a)))
    def _A_setup():
        B, Sq, D = 8, 144, 512
        H, Sk, Dh = 32, 512, 128
        return {
            "x": _w((lambda *s: torch.randn(*s, dtype=torch.bfloat16) * 0.8)(B, Sq, D)),
            "k_cache": _w((lambda *s: torch.randn(*s, dtype=torch.bfloat16) * 0.8)(B, H, Sk, Dh)),
            "v_cache": _w((lambda *s: torch.randn(*s, dtype=torch.bfloat16) * 0.05)(B, H, Sk, Dh)),
            "wq": _w((lambda *s: torch.randn(*s, dtype=torch.bfloat16) * 0.8)(D, H * Dh) * (D ** -0.5)),
            "wo": _w((lambda *s: torch.randn(*s, dtype=torch.bfloat16) * 0.05)(H * Dh, D) * ((H * Dh) ** -0.5)),
        }
    _A_in = _A_setup()

    def _B_setup():
        B, Sq, D = 8, 144, 512
        Hq, Hkv, Sk, Dh = 32, 32, 512, 128
        assert Hq % Hkv == 0, (Hq, Hkv)
        return {
            "x": _w((lambda *s: torch.randn(*s, dtype=torch.bfloat16) * 0.8)(B, Sq, D)),
            "k_cache": _w((lambda *s: torch.randn(*s, dtype=torch.bfloat16) * 0.8)(B, Hkv, Sk, Dh)),
            "v_cache": _w((lambda *s: torch.randn(*s, dtype=torch.bfloat16) * 0.05)(B, Hkv, Sk, Dh)),
            "wq": _w((lambda *s: torch.randn(*s, dtype=torch.bfloat16) * 0.8)(D, Hq * Dh) * (D ** -0.5)),
            "wo": _w((lambda *s: torch.randn(*s, dtype=torch.bfloat16) * 0.05)(Hq * Dh, D) * ((Hq * Dh) ** -0.5)),
        }
    _B_in = _B_setup()

    return {
        "A_x": _A_in["x"],
        "A_k_cache": _A_in["k_cache"],
        "A_v_cache": _A_in["v_cache"],
        "A_wq": _A_in["wq"],
        "A_wo": _A_in["wo"],
        "B_x": _B_in["x"],
        "B_k_cache": _B_in["k_cache"],
        "B_v_cache": _B_in["v_cache"],
        "B_wq": _B_in["wq"],
        "B_wo": _B_in["wo"],
    }

def reference(A_x, A_k_cache, A_v_cache, A_wq, A_wo, B_x, B_k_cache, B_v_cache, B_wq, B_wo):
    def _A_ref(x, k_cache, v_cache, wq, wo):
        B, Sq, D = x.shape
        H, Dh = 32, 128
        q = (lambda x, *d: x.permute(*d))((x @ wq).reshape(B, Sq, H, Dh), 0, 2, 1, 3)
        scores = torch.einsum("bhqd,bhkd->bhqk", q, k_cache) * (Dh ** -0.5)
        p = _softmax(scores, axis=-1)
        o = torch.einsum("bhqk,bhkd->bhqd", p, v_cache)
        return (lambda x, *d: x.permute(*d))(o, 0, 2, 1, 3).reshape(B, Sq, H * Dh) @ wo

    def _B_ref(x, k_cache, v_cache, wq, wo):
        B, Sq, D = x.shape
        Hq, Dh = 32, 128
        Hkv = k_cache.shape[1]
        rep = Hq // Hkv
        q = (lambda x, *d: x.permute(*d))((x @ wq).reshape(B, Sq, Hq, Dh), 0, 2, 1, 3)
        k = (lambda x, n, axis: torch.repeat_interleave(x, n, dim=axis))(k_cache, rep, axis=1)
        v = (lambda x, n, axis: torch.repeat_interleave(x, n, dim=axis))(v_cache, rep, axis=1)
        scores = torch.einsum("bhqd,bhkd->bhqk", q, k) * (Dh ** -0.5)
        p = _softmax(scores, axis=-1)
        o = torch.einsum("bhqk,bhkd->bhqd", p, v)
        return (lambda x, *d: x.permute(*d))(o, 0, 2, 1, 3).reshape(B, Sq, Hq * Dh) @ wo

    a = _A_ref(A_x, A_k_cache, A_v_cache, A_wq, A_wo)
    b = _B_ref(B_x, B_k_cache, B_v_cache, B_wq, B_wo)
    return torch.concatenate([a, b], axis=-1)
```

```asm
; @launch grid=(512,1,1) block=(256,1,1) lds=81920
.amdgcn_target "amdgcn-amd-amdhsa--gfx950"
.text
.globl concat_heads__mha_block_cached__gqa_block_cached__near_ridge_kernel
.p2align 8
.type concat_heads__mha_block_cached__gqa_block_cached__near_ridge_kernel,@function
concat_heads__mha_block_cached__gqa_block_cached__near_ridge_kernel:
    s_cmp_ge_u32 s2, 512
    s_cbranch_scc1 K1_END
    s_load_dwordx16 s[36:51], s[0:1], 0
    s_load_dwordx4 s[52:55], s[0:1], 64
    s_load_dwordx2 s[56:57], s[0:1], 96
    s_load_dwordx4 s[72:75], s[0:1], 80
    s_memrealtime s[70:71]
    v_lshrrev_b32 v251, 6, v0
    v_and_b32 v248, 63, v0
    v_readfirstlane_b32 s24, v251
    v_lshrrev_b32 v249, 4, v248
    v_and_b32 v250, 15, v248
    s_and_b32 s61, s2, 7
    s_lshr_b32 s62, s2, 3
    s_lshr_b32 s60, s61, 2
    s_and_b32 s76, s61, 3
    s_and_b32 s77, s62, 7
    s_lshr_b32 s58, s62, 3
    s_lshl_b32 s59, s76, 3
    s_add_u32 s59, s59, s77
    s_lshl_b32 s25, s24, 11
    s_add_u32 s32, s24, 0
    s_and_b32 s32, s32, 3
    s_lshl_b32 s32, s32, 6
    s_add_u32 s33, s24, 1
    s_and_b32 s33, s33, 3
    s_lshl_b32 s33, s33, 6
    s_add_u32 s34, s24, 2
    s_and_b32 s34, s34, 3
    s_lshl_b32 s34, s34, 6
    s_add_u32 s35, s24, 3
    s_and_b32 s35, s35, 3
    s_lshl_b32 s35, s35, 6
    s_lshl_b32 s64, s58, 5
    s_add_u32 s64, s64, s59
    s_lshl_b32 s64, s64, 17
    s_lshl_b32 s28, s59, 8
    s_mul_i32 s61, s58, 144
    s_lshl_b32 s62, s24, 5
    s_add_u32 s29, s61, s62
    s_add_u32 s30, s29, 16
    s_add_u32 s31, s61, 128
    s_lshl_b32 s29, s29, 10
    s_lshl_b32 s30, s30, 10
    s_lshl_b32 s31, s31, 10
    s_mov_b32 s63, 0
    s_mov_b32 s66, 0x3e0293ee
    v_and_b32 v251, 1, v249
    v_and_b32 v252, 2, v249
    v_lshl_or_b32 v251, v252, 1, v251
    v_mov_b32 v253, s24
    v_and_b32 v252, 1, v253
    v_lshl_or_b32 v251, v252, 3, v251
    v_xor_b32 v251, v251, v250
    v_lshlrev_b32 v247, 4, v251
    v_lshl_add_u32 v253, v253, 3, v249
    v_lshl_add_u32 v228, v253, 13, v247
    v_add_u32 v229, 31744, v228
    v_lshl_add_u32 v247, v253, 8, v247
    v_mov_b32 v251, s24
    v_lshl_or_b32 v251, v251, 2, v249
    v_xor_b32 v251, v251, v250
    v_lshlrev_b32 v251, 4, v251
    v_lshl_add_u32 v246, v253, 8, v251
    v_and_b32 v251, 7, v248
    v_xor_b32 v251, v251, v249
    v_lshlrev_b32 v251, 4, v251
    v_lshrrev_b32 v252, 3, v248
    v_lshl_add_u32 v230, v252, 10, v251
    v_xor_b32 v231, 64, v230
    v_add_u32 v231, 7168, v231
    s_lshr_b32 s61, s24, 1
    s_mul_i32 s62, s61, 8256
    v_xor_b32 v232, s62, v230
    s_and_b32 s62, s24, 1
    s_sub_u32 s69, 0, s62
    s_not_b32 s68, s69
    s_add_u32 s67, s59, s58
    s_and_b32 s67, s67, 7
    s_waitcnt lgkmcnt(0)
    s_cmp_eq_u32 s60, 1
    s_cselect_b32 s16, s52, s42
    s_cselect_b32 s17, s53, s43
    s_mov_b32 s18, 4194304
    s_mov_b32 s19, 0x20000
    s_cselect_b32 s4, s46, s36
    s_cselect_b32 s5, s47, s37
    s_mov_b32 s6, 1179648
    s_mov_b32 s7, 0x20000
    s_cselect_b32 s8, s48, s38
    s_cselect_b32 s9, s49, s39
    s_mov_b32 s10, 33554432
    s_mov_b32 s11, 0x20000
    s_cselect_b32 s12, s50, s40
    s_cselect_b32 s13, s51, s41
    s_mov_b32 s14, 33554432
    s_mov_b32 s15, 0x20000
    s_mov_b32 s20, s74
    s_and_b32 s21, s75, 0xffff
    s_mov_b32 s22, 256
    s_mov_b32 s23, 0x20000
    s_or_b32 s70, s70, 1
    v_mov_b32 v188, s70
    v_mov_b32 v189, 0
    s_or_b32 s61, s2, s24
    s_cmp_eq_u32 s61, 0
    s_cselect_b32 exec_lo, 1, 0
    s_mov_b32 exec_hi, 0
    buffer_store_dword v188, v189, s[20:23], 0 offen sc1
    s_mov_b64 exec, -1
    s_mov_b32 s20, s56
    s_and_b32 s21, s57, 0xffff
    s_mov_b32 s22, 18874368
    s_mov_b32 s23, 0x20000
    s_mov_b32 s26, s64
    s_mov_b32 s27, s64
    s_add_u32 s3, s67, 0
    s_and_b32 s3, s3, 7
    s_lshl_b32 s28, s3, 19
    s_lshl_b32 s3, s3, 7
    s_lshl_b32 s61, s59, 8
    s_add_u32 s28, s28, s61
    s_add_u32 m0, s25, 40960
    s_nop 0
    buffer_load_dwordx4 v228, s[16:19], s28 offen lds
    buffer_load_dwordx4 v229, s[16:19], s28 offen offset:1024 lds
    s_add_u32 s28, s28, 262144
    s_add_u32 m0, s25, 0
    s_nop 0
    buffer_load_dwordx4 v228, s[16:19], s28 offen lds
    buffer_load_dwordx4 v229, s[16:19], s28 offen offset:1024 lds
    s_lshl_b32 s61, s25, 1
    s_add_u32 s62, s29, s3
    s_add_u32 m0, s61, 16384
    s_nop 0
    buffer_load_dwordx4 v230, s[4:7], s62 offen lds
    buffer_load_dwordx4 v231, s[4:7], s62 offen offset:1024 lds
    s_lshl_b32 s61, s25, 1
    s_add_u32 s62, s30, s3
    s_add_u32 m0, s61, 18432
    s_nop 0
    buffer_load_dwordx4 v230, s[4:7], s62 offen lds
    buffer_load_dwordx4 v231, s[4:7], s62 offen offset:1024 lds
    s_lshr_b32 s61, s24, 1
    s_lshl_b32 s61, s61, 10
    s_add_u32 s62, s31, s3
    s_add_u32 m0, s61, 32768
    s_mov_b64 exec, s[68:69]
    buffer_load_dwordx4 v232, s[4:7], s62 offen lds
    s_mov_b64 exec, -1
    s_add_u32 s3, s67, 1
    s_and_b32 s3, s3, 7
    s_lshl_b32 s28, s3, 19
    s_lshl_b32 s3, s3, 7
    s_lshl_b32 s61, s59, 8
    s_add_u32 s28, s28, s61
    s_add_u32 m0, s25, 49152
    s_nop 0
    buffer_load_dwordx4 v228, s[16:19], s28 offen lds
    buffer_load_dwordx4 v229, s[16:19], s28 offen offset:1024 lds
    s_add_u32 s28, s28, 262144
    s_add_u32 m0, s25, 8192
    s_nop 0
    buffer_load_dwordx4 v228, s[16:19], s28 offen lds
    buffer_load_dwordx4 v229, s[16:19], s28 offen offset:1024 lds
    s_lshl_b32 s61, s25, 1
    s_add_u32 s62, s29, s3
    s_add_u32 m0, s61, 57344
    s_nop 0
    buffer_load_dwordx4 v230, s[4:7], s62 offen lds
    buffer_load_dwordx4 v231, s[4:7], s62 offen offset:1024 lds
    s_lshl_b32 s61, s25, 1
    s_add_u32 s62, s30, s3
    s_add_u32 m0, s61, 59392
    s_nop 0
    buffer_load_dwordx4 v230, s[4:7], s62 offen lds
    buffer_load_dwordx4 v231, s[4:7], s62 offen offset:1024 lds
    s_lshr_b32 s61, s24, 1
    s_lshl_b32 s61, s61, 10
    s_add_u32 s62, s31, s3
    s_add_u32 m0, s61, 34816
    s_mov_b64 exec, s[68:69]
    buffer_load_dwordx4 v232, s[4:7], s62 offen lds
    s_mov_b64 exec, -1
    v_lshrrev_b32 v251, 1, v250
    v_xor_b32 v251, v251, v249
    v_lshlrev_b32 v251, 4, v251
    v_lshl_add_u32 v146, v250, 7, v251
    v_xor_b32 v147, 64, v146
    s_lshl_b32 s61, s24, 12
    v_add_u32 v144, s61, v146
    v_add_u32 v145, s61, v147
    v_lshrrev_b32 v251, 2, v250
    v_and_b32 v252, 3, v250
    v_and_b32 v253, 1, v251
    v_and_b32 v254, 2, v251
    v_lshl_or_b32 v253, v254, 1, v253
    v_and_b32 v254, 1, v249
    v_lshl_or_b32 v253, v254, 3, v253
    v_xor_b32 v253, v253, v252
    v_lshlrev_b32 v253, 4, v253
    v_and_b32 v252, 1, v252
    v_lshl_or_b32 v253, v252, 3, v253
    v_lshl_add_u32 v254, v249, 3, v251
    v_lshl_or_b32 v254, v254, 8, v253
    v_xor_b32 v234, s32, v254
    v_xor_b32 v235, 8, v234
    v_xor_b32 v236, s33, v254
    v_xor_b32 v237, 8, v236
    v_xor_b32 v238, s34, v254
    v_xor_b32 v239, 8, v238
    v_xor_b32 v240, s35, v254
    v_xor_b32 v241, 8, v240
    v_lshrrev_b32 v251, 2, v250
    v_and_b32 v252, 3, v250
    v_lshl_add_u32 v251, v251, 3, v252
    v_xor_b32 v252, v249, v250
    v_lshlrev_b32 v252, 4, v252
    v_lshl_add_u32 v251, v251, 8, v252
    v_xor_b32 v242, s32, v251
    v_add_u32 v242, 40960, v242
    v_xor_b32 v243, s33, v251
    v_add_u32 v243, 40960, v243
    v_xor_b32 v244, s34, v251
    v_add_u32 v244, 40960, v244
    v_xor_b32 v245, s35, v251
    v_add_u32 v245, 40960, v245
    s_waitcnt vmcnt(9)
    s_barrier
    ds_read_b128 v[96:99], v144 offset:16384
    ds_read_b128 v[100:103], v144 offset:18432
    ds_read_b128 v[104:107], v146 offset:32768
    ds_read_b64_tr_b16 v[196:197], v234 offset:40960
    ds_read_b64_tr_b16 v[198:199], v234 offset:41984
    ds_read_b64_tr_b16 v[200:201], v235 offset:40960
    ds_read_b64_tr_b16 v[202:203], v235 offset:41984
    ds_read_b64_tr_b16 v[204:205], v236 offset:40960
    ds_read_b64_tr_b16 v[206:207], v236 offset:41984
    ds_read_b64_tr_b16 v[208:209], v237 offset:40960
    ds_read_b64_tr_b16 v[210:211], v237 offset:41984
    ds_read_b64_tr_b16 v[212:213], v238 offset:40960
    ds_read_b64_tr_b16 v[214:215], v238 offset:41984
    ds_read_b64_tr_b16 v[216:217], v239 offset:40960
    ds_read_b64_tr_b16 v[218:219], v239 offset:41984
    s_waitcnt lgkmcnt(14)
    ds_read_b64_tr_b16 v[220:221], v240 offset:40960
    s_waitcnt lgkmcnt(14)
    ds_read_b64_tr_b16 v[222:223], v240 offset:41984
    s_waitcnt lgkmcnt(12)
    v_mfma_f32_16x16x32_bf16 v[0:3], v[196:199], v[96:99], 0
    v_mfma_f32_16x16x32_bf16 v[32:35], v[196:199], v[100:103], 0
    v_mfma_f32_16x16x32_bf16 v[64:67], v[196:199], v[104:107], 0
    ds_read_b64_tr_b16 v[224:225], v241 offset:40960
    ds_read_b64_tr_b16 v[226:227], v241 offset:41984
    ds_read_b128 v[112:115], v145 offset:16384
    s_waitcnt lgkmcnt(13)
    v_mfma_f32_16x16x32_bf16 v[4:7], v[200:203], v[96:99], 0
    v_mfma_f32_16x16x32_bf16 v[36:39], v[200:203], v[100:103], 0
    v_mfma_f32_16x16x32_bf16 v[68:71], v[200:203], v[104:107], 0
    ds_read_b64_tr_b16 v[196:197], v234
    ds_read_b64_tr_b16 v[198:199], v234 offset:1024
    s_waitcnt lgkmcnt(13)
    v_mfma_f32_16x16x32_bf16 v[8:11], v[204:207], v[96:99], 0
    v_mfma_f32_16x16x32_bf16 v[40:43], v[204:207], v[100:103], 0
    ds_read_b64_tr_b16 v[200:201], v235
    ds_read_b64_tr_b16 v[202:203], v235 offset:1024
    s_waitcnt lgkmcnt(13)
    v_mfma_f32_16x16x32_bf16 v[12:15], v[208:211], v[96:99], 0
    ds_read_b128 v[116:119], v145 offset:18432
    v_mfma_f32_16x16x32_bf16 v[44:47], v[208:211], v[100:103], 0
    ds_read_b64_tr_b16 v[204:205], v236
    s_waitcnt lgkmcnt(14)
    ds_read_b64_tr_b16 v[206:207], v236 offset:1024
    s_waitcnt lgkmcnt(14)
    v_mfma_f32_16x16x32_bf16 v[16:19], v[212:215], v[96:99], 0
    v_mfma_f32_16x16x32_bf16 v[48:51], v[212:215], v[100:103], 0
    ds_read_b64_tr_b16 v[208:209], v237
    s_waitcnt lgkmcnt(14)
    ds_read_b64_tr_b16 v[210:211], v237 offset:1024
    s_waitcnt lgkmcnt(14)
    v_mfma_f32_16x16x32_bf16 v[20:23], v[216:219], v[96:99], 0
    v_mfma_f32_16x16x32_bf16 v[52:55], v[216:219], v[100:103], 0
    ds_read_b64_tr_b16 v[212:213], v238
    s_waitcnt lgkmcnt(14)
    ds_read_b64_tr_b16 v[214:215], v238 offset:1024
    s_waitcnt lgkmcnt(14)
    v_mfma_f32_16x16x32_bf16 v[24:27], v[220:223], v[96:99], 0
    ds_read_b128 v[120:123], v147 offset:32768
    v_mfma_f32_16x16x32_bf16 v[56:59], v[220:223], v[100:103], 0
    s_waitcnt lgkmcnt(14)
    ds_read_b64_tr_b16 v[216:217], v239
    s_waitcnt lgkmcnt(14)
    ds_read_b64_tr_b16 v[218:219], v239 offset:1024
    v_mfma_f32_16x16x32_bf16 v[28:31], v[224:227], v[96:99], 0
    v_mfma_f32_16x16x32_bf16 v[60:63], v[224:227], v[100:103], 0
    s_waitcnt lgkmcnt(14)
    ds_read_b64_tr_b16 v[220:221], v240
    s_waitcnt lgkmcnt(14)
    ds_read_b64_tr_b16 v[222:223], v240 offset:1024
    s_waitcnt lgkmcnt(14)
    v_mfma_f32_16x16x32_bf16 v[0:3], v[196:199], v[112:115], v[0:3]
    s_waitcnt lgkmcnt(11)
    v_mfma_f32_16x16x32_bf16 v[32:35], v[196:199], v[116:119], v[32:35]
    s_waitcnt lgkmcnt(4)
    v_mfma_f32_16x16x32_bf16 v[64:67], v[196:199], v[120:123], v[64:67]
    ds_read_b64_tr_b16 v[224:225], v241
    ds_read_b64_tr_b16 v[226:227], v241 offset:1024
    v_mfma_f32_16x16x32_bf16 v[4:7], v[200:203], v[112:115], v[4:7]
    v_mfma_f32_16x16x32_bf16 v[36:39], v[200:203], v[116:119], v[36:39]
    v_mfma_f32_16x16x32_bf16 v[68:71], v[200:203], v[120:123], v[68:71]
    v_mfma_f32_16x16x32_bf16 v[8:11], v[204:207], v[112:115], v[8:11]
    v_mfma_f32_16x16x32_bf16 v[40:43], v[204:207], v[116:119], v[40:43]
    v_mfma_f32_16x16x32_bf16 v[12:15], v[208:211], v[112:115], v[12:15]
    v_mfma_f32_16x16x32_bf16 v[44:47], v[208:211], v[116:119], v[44:47]
    s_waitcnt vmcnt(0) lgkmcnt(0)
    s_barrier
    ds_read_b64_tr_b16 v[196:197], v234 offset:49152
    ds_read_b64_tr_b16 v[198:199], v234 offset:50176
    ds_read_b64_tr_b16 v[200:201], v235 offset:49152
    ds_read_b64_tr_b16 v[202:203], v235 offset:50176
    ds_read_b64_tr_b16 v[204:205], v236 offset:49152
    ds_read_b64_tr_b16 v[206:207], v236 offset:50176
    v_mfma_f32_16x16x32_bf16 v[16:19], v[212:215], v[112:115], v[16:19]
    ds_read_b128 v[96:99], v144 offset:57344
    ds_read_b128 v[100:103], v144 offset:59392
    ds_read_b128 v[104:107], v146 offset:34816
    v_mfma_f32_16x16x32_bf16 v[48:51], v[212:215], v[116:119], v[48:51]
    s_add_u32 s3, s67, 2
    s_and_b32 s3, s3, 7
    s_lshl_b32 s28, s3, 19
    s_lshl_b32 s3, s3, 7
    s_lshl_b32 s61, s59, 8
    s_add_u32 s28, s28, s61
    s_add_u32 m0, s25, 40960
    s_nop 0
    buffer_load_dwordx4 v228, s[16:19], s28 offen lds
    buffer_load_dwordx4 v229, s[16:19], s28 offen offset:1024 lds
    s_add_u32 s28, s28, 262144
    ds_read_b64_tr_b16 v[208:209], v237 offset:49152
    ds_read_b64_tr_b16 v[210:211], v237 offset:50176
    v_mfma_f32_16x16x32_bf16 v[20:23], v[216:219], v[112:115], v[20:23]
    s_add_u32 m0, s25, 0
    s_nop 0
    buffer_load_dwordx4 v228, s[16:19], s28 offen lds
    buffer_load_dwordx4 v229, s[16:19], s28 offen offset:1024 lds
    v_mfma_f32_16x16x32_bf16 v[52:55], v[216:219], v[116:119], v[52:55]
    s_lshl_b32 s61, s25, 1
    s_add_u32 s62, s29, s3
    s_add_u32 m0, s61, 16384
    s_nop 0
    buffer_load_dwordx4 v230, s[4:7], s62 offen lds
    buffer_load_dwordx4 v231, s[4:7], s62 offen offset:1024 lds
    ds_read_b64_tr_b16 v[212:213], v238 offset:49152
    ds_read_b64_tr_b16 v[214:215], v238 offset:50176
    v_mfma_f32_16x16x32_bf16 v[24:27], v[220:223], v[112:115], v[24:27]
    s_lshl_b32 s61, s25, 1
    s_add_u32 s62, s30, s3
    s_add_u32 m0, s61, 18432
    s_nop 0
    buffer_load_dwordx4 v230, s[4:7], s62 offen lds
    buffer_load_dwordx4 v231, s[4:7], s62 offen offset:1024 lds
    v_mfma_f32_16x16x32_bf16 v[56:59], v[220:223], v[116:119], v[56:59]
    s_lshr_b32 s61, s24, 1
    s_lshl_b32 s61, s61, 10
    s_add_u32 s62, s31, s3
    s_add_u32 m0, s61, 32768
    s_mov_b64 exec, s[68:69]
    buffer_load_dwordx4 v232, s[4:7], s62 offen lds
    s_mov_b64 exec, -1
    ds_read_b64_tr_b16 v[216:217], v239 offset:49152
    ds_read_b64_tr_b16 v[218:219], v239 offset:50176
    v_mfma_f32_16x16x32_bf16 v[28:31], v[224:227], v[112:115], v[28:31]
    v_mfma_f32_16x16x32_bf16 v[60:63], v[224:227], v[116:119], v[60:63]
    s_waitcnt lgkmcnt(14)
    ds_read_b64_tr_b16 v[220:221], v240 offset:49152
    s_waitcnt lgkmcnt(14)
    ds_read_b64_tr_b16 v[222:223], v240 offset:50176
    s_waitcnt lgkmcnt(10)
    v_mfma_f32_16x16x32_bf16 v[0:3], v[196:199], v[96:99], v[0:3]
    s_waitcnt lgkmcnt(9)
    v_mfma_f32_16x16x32_bf16 v[32:35], v[196:199], v[100:103], v[32:35]
    s_waitcnt lgkmcnt(8)
    v_mfma_f32_16x16x32_bf16 v[64:67], v[196:199], v[104:107], v[64:67]
    ds_read_b64_tr_b16 v[224:225], v241 offset:49152
    ds_read_b64_tr_b16 v[226:227], v241 offset:50176
    ds_read_b128 v[112:115], v145 offset:57344
    v_mfma_f32_16x16x32_bf16 v[4:7], v[200:203], v[96:99], v[4:7]
    v_mfma_f32_16x16x32_bf16 v[36:39], v[200:203], v[100:103], v[36:39]
    v_mfma_f32_16x16x32_bf16 v[68:71], v[200:203], v[104:107], v[68:71]
    ds_read_b64_tr_b16 v[196:197], v234 offset:8192
    ds_read_b64_tr_b16 v[198:199], v234 offset:9216
    v_mfma_f32_16x16x32_bf16 v[8:11], v[204:207], v[96:99], v[8:11]
    v_mfma_f32_16x16x32_bf16 v[40:43], v[204:207], v[100:103], v[40:43]
    ds_read_b64_tr_b16 v[200:201], v235 offset:8192
    ds_read_b64_tr_b16 v[202:203], v235 offset:9216
    s_waitcnt lgkmcnt(13)
    v_mfma_f32_16x16x32_bf16 v[12:15], v[208:211], v[96:99], v[12:15]
    ds_read_b128 v[116:119], v145 offset:59392
    v_mfma_f32_16x16x32_bf16 v[44:47], v[208:211], v[100:103], v[44:47]
    ds_read_b64_tr_b16 v[204:205], v236 offset:8192
    s_waitcnt lgkmcnt(14)
    ds_read_b64_tr_b16 v[206:207], v236 offset:9216
    s_waitcnt lgkmcnt(14)
    v_mfma_f32_16x16x32_bf16 v[16:19], v[212:215], v[96:99], v[16:19]
    v_mfma_f32_16x16x32_bf16 v[48:51], v[212:215], v[100:103], v[48:51]
    ds_read_b64_tr_b16 v[208:209], v237 offset:8192
    s_waitcnt lgkmcnt(14)
    ds_read_b64_tr_b16 v[210:211], v237 offset:9216
    s_waitcnt lgkmcnt(14)
    v_mfma_f32_16x16x32_bf16 v[20:23], v[216:219], v[96:99], v[20:23]
    v_mfma_f32_16x16x32_bf16 v[52:55], v[216:219], v[100:103], v[52:55]
    ds_read_b64_tr_b16 v[212:213], v238 offset:8192
    s_waitcnt lgkmcnt(14)
    ds_read_b64_tr_b16 v[214:215], v238 offset:9216
    s_waitcnt lgkmcnt(14)
    v_mfma_f32_16x16x32_bf16 v[24:27], v[220:223], v[96:99], v[24:27]
    ds_read_b128 v[120:123], v147 offset:34816
    v_mfma_f32_16x16x32_bf16 v[56:59], v[220:223], v[100:103], v[56:59]
    s_waitcnt lgkmcnt(14)
    ds_read_b64_tr_b16 v[216:217], v239 offset:8192
    s_waitcnt lgkmcnt(14)
    ds_read_b64_tr_b16 v[218:219], v239 offset:9216
    v_mfma_f32_16x16x32_bf16 v[28:31], v[224:227], v[96:99], v[28:31]
    v_mfma_f32_16x16x32_bf16 v[60:63], v[224:227], v[100:103], v[60:63]
    s_waitcnt lgkmcnt(14)
    ds_read_b64_tr_b16 v[220:221], v240 offset:8192
    s_waitcnt lgkmcnt(14)
    ds_read_b64_tr_b16 v[222:223], v240 offset:9216
    s_waitcnt lgkmcnt(14)
    v_mfma_f32_16x16x32_bf16 v[0:3], v[196:199], v[112:115], v[0:3]
    s_waitcnt lgkmcnt(11)
    v_mfma_f32_16x16x32_bf16 v[32:35], v[196:199], v[116:119], v[32:35]
    s_waitcnt lgkmcnt(4)
    v_mfma_f32_16x16x32_bf16 v[64:67], v[196:199], v[120:123], v[64:67]
    ds_read_b64_tr_b16 v[224:225], v241 offset:8192
    ds_read_b64_tr_b16 v[226:227], v241 offset:9216
    v_mfma_f32_16x16x32_bf16 v[4:7], v[200:203], v[112:115], v[4:7]
    v_mfma_f32_16x16x32_bf16 v[36:39], v[200:203], v[116:119], v[36:39]
    v_mfma_f32_16x16x32_bf16 v[68:71], v[200:203], v[120:123], v[68:71]
    v_mfma_f32_16x16x32_bf16 v[8:11], v[204:207], v[112:115], v[8:11]
    v_mfma_f32_16x16x32_bf16 v[40:43], v[204:207], v[116:119], v[40:43]
    v_mfma_f32_16x16x32_bf16 v[12:15], v[208:211], v[112:115], v[12:15]
    v_mfma_f32_16x16x32_bf16 v[44:47], v[208:211], v[116:119], v[44:47]
    s_waitcnt vmcnt(0) lgkmcnt(0)
    s_barrier
    ds_read_b64_tr_b16 v[196:197], v234 offset:40960
    ds_read_b64_tr_b16 v[198:199], v234 offset:41984
    ds_read_b64_tr_b16 v[200:201], v235 offset:40960
    ds_read_b64_tr_b16 v[202:203], v235 offset:41984
    ds_read_b64_tr_b16 v[204:205], v236 offset:40960
    ds_read_b64_tr_b16 v[206:207], v236 offset:41984
    v_mfma_f32_16x16x32_bf16 v[16:19], v[212:215], v[112:115], v[16:19]
    ds_read_b128 v[96:99], v144 offset:16384
    ds_read_b128 v[100:103], v144 offset:18432
    ds_read_b128 v[104:107], v146 offset:32768
    v_mfma_f32_16x16x32_bf16 v[48:51], v[212:215], v[116:119], v[48:51]
    s_add_u32 s3, s67, 3
    s_and_b32 s3, s3, 7
    s_lshl_b32 s28, s3, 19
    s_lshl_b32 s3, s3, 7
    s_lshl_b32 s61, s59, 8
    s_add_u32 s28, s28, s61
    s_add_u32 m0, s25, 49152
    s_nop 0
    buffer_load_dwordx4 v228, s[16:19], s28 offen lds
    buffer_load_dwordx4 v229, s[16:19], s28 offen offset:1024 lds
    s_add_u32 s28, s28, 262144
    ds_read_b64_tr_b16 v[208:209], v237 offset:40960
    ds_read_b64_tr_b16 v[210:211], v237 offset:41984
    v_mfma_f32_16x16x32_bf16 v[20:23], v[216:219], v[112:115], v[20:23]
    s_add_u32 m0, s25, 8192
    s_nop 0
    buffer_load_dwordx4 v228, s[16:19], s28 offen lds
    buffer_load_dwordx4 v229, s[16:19], s28 offen offset:1024 lds
    v_mfma_f32_16x16x32_bf16 v[52:55], v[216:219], v[116:119], v[52:55]
    s_lshl_b32 s61, s25, 1
    s_add_u32 s62, s29, s3
    s_add_u32 m0, s61, 57344
    s_nop 0
    buffer_load_dwordx4 v230, s[4:7], s62 offen lds
    buffer_load_dwordx4 v231, s[4:7], s62 offen offset:1024 lds
    ds_read_b64_tr_b16 v[212:213], v238 offset:40960
    ds_read_b64_tr_b16 v[214:215], v238 offset:41984
    v_mfma_f32_16x16x32_bf16 v[24:27], v[220:223], v[112:115], v[24:27]
    s_lshl_b32 s61, s25, 1
    s_add_u32 s62, s30, s3
    s_add_u32 m0, s61, 59392
    s_nop 0
    buffer_load_dwordx4 v230, s[4:7], s62 offen lds
    buffer_load_dwordx4 v231, s[4:7], s62 offen offset:1024 lds
    v_mfma_f32_16x16x32_bf16 v[56:59], v[220:223], v[116:119], v[56:59]
    s_lshr_b32 s61, s24, 1
    s_lshl_b32 s61, s61, 10
    s_add_u32 s62, s31, s3
    s_add_u32 m0, s61, 34816
    s_mov_b64 exec, s[68:69]
    buffer_load_dwordx4 v232, s[4:7], s62 offen lds
    s_mov_b64 exec, -1
    ds_read_b64_tr_b16 v[216:217], v239 offset:40960
    ds_read_b64_tr_b16 v[218:219], v239 offset:41984
    v_mfma_f32_16x16x32_bf16 v[28:31], v[224:227], v[112:115], v[28:31]
    v_mfma_f32_16x16x32_bf16 v[60:63], v[224:227], v[116:119], v[60:63]
    s_waitcnt lgkmcnt(14)
    ds_read_b64_tr_b16 v[220:221], v240 offset:40960
    s_waitcnt lgkmcnt(14)
    ds_read_b64_tr_b16 v[222:223], v240 offset:41984
    s_waitcnt lgkmcnt(10)
    v_mfma_f32_16x16x32_bf16 v[0:3], v[196:199], v[96:99], v[0:3]
    s_waitcnt lgkmcnt(9)
    v_mfma_f32_16x16x32_bf16 v[32:35], v[196:199], v[100:103], v[32:35]
    s_waitcnt lgkmcnt(8)
    v_mfma_f32_16x16x32_bf16 v[64:67], v[196:199], v[104:107], v[64:67]
    ds_read_b64_tr_b16 v[224:225], v241 offset:40960
    ds_read_b64_tr_b16 v[226:227], v241 offset:41984
    ds_read_b128 v[112:115], v145 offset:16384
    v_mfma_f32_16x16x32_bf16 v[4:7], v[200:203], v[96:99], v[4:7]
    v_mfma_f32_16x16x32_bf16 v[36:39], v[200:203], v[100:103], v[36:39]
    v_mfma_f32_16x16x32_bf16 v[68:71], v[200:203], v[104:107], v[68:71]
    ds_read_b64_tr_b16 v[196:197], v234
    ds_read_b64_tr_b16 v[198:199], v234 offset:1024
    v_mfma_f32_16x16x32_bf16 v[8:11], v[204:207], v[96:99], v[8:11]
    v_mfma_f32_16x16x32_bf16 v[40:43], v[204:207], v[100:103], v[40:43]
    ds_read_b64_tr_b16 v[200:201], v235
    ds_read_b64_tr_b16 v[202:203], v235 offset:1024
    s_waitcnt lgkmcnt(13)
    v_mfma_f32_16x16x32_bf16 v[12:15], v[208:211], v[96:99], v[12:15]
    ds_read_b128 v[116:119], v145 offset:18432
    v_mfma_f32_16x16x32_bf16 v[44:47], v[208:211], v[100:103], v[44:47]
    ds_read_b64_tr_b16 v[204:205], v236
    s_waitcnt lgkmcnt(14)
    ds_read_b64_tr_b16 v[206:207], v236 offset:1024
    s_waitcnt lgkmcnt(14)
    v_mfma_f32_16x16x32_bf16 v[16:19], v[212:215], v[96:99], v[16:19]
    v_mfma_f32_16x16x32_bf16 v[48:51], v[212:215], v[100:103], v[48:51]
    ds_read_b64_tr_b16 v[208:209], v237
    s_waitcnt lgkmcnt(14)
    ds_read_b64_tr_b16 v[210:211], v237 offset:1024
    s_waitcnt lgkmcnt(14)
    v_mfma_f32_16x16x32_bf16 v[20:23], v[216:219], v[96:99], v[20:23]
    v_mfma_f32_16x16x32_bf16 v[52:55], v[216:219], v[100:103], v[52:55]
    ds_read_b64_tr_b16 v[212:213], v238
    s_waitcnt lgkmcnt(14)
    ds_read_b64_tr_b16 v[214:215], v238 offset:1024
    s_waitcnt lgkmcnt(14)
    v_mfma_f32_16x16x32_bf16 v[24:27], v[220:223], v[96:99], v[24:27]
    ds_read_b128 v[120:123], v147 offset:32768
    v_mfma_f32_16x16x32_bf16 v[56:59], v[220:223], v[100:103], v[56:59]
    s_waitcnt lgkmcnt(14)
    ds_read_b64_tr_b16 v[216:217], v239
    s_waitcnt lgkmcnt(14)
    ds_read_b64_tr_b16 v[218:219], v239 offset:1024
    v_mfma_f32_16x16x32_bf16 v[28:31], v[224:227], v[96:99], v[28:31]
    v_mfma_f32_16x16x32_bf16 v[60:63], v[224:227], v[100:103], v[60:63]
    s_waitcnt lgkmcnt(14)
    ds_read_b64_tr_b16 v[220:221], v240
    s_waitcnt lgkmcnt(14)
    ds_read_b64_tr_b16 v[222:223], v240 offset:1024
    s_waitcnt lgkmcnt(14)
    v_mfma_f32_16x16x32_bf16 v[0:3], v[196:199], v[112:115], v[0:3]
    s_waitcnt lgkmcnt(11)
    v_mfma_f32_16x16x32_bf16 v[32:35], v[196:199], v[116:119], v[32:35]
    s_waitcnt lgkmcnt(4)
    v_mfma_f32_16x16x32_bf16 v[64:67], v[196:199], v[120:123], v[64:67]
    ds_read_b64_tr_b16 v[224:225], v241
    ds_read_b64_tr_b16 v[226:227], v241 offset:1024
    v_mfma_f32_16x16x32_bf16 v[4:7], v[200:203], v[112:115], v[4:7]
    v_mfma_f32_16x16x32_bf16 v[36:39], v[200:203], v[116:119], v[36:39]
    v_mfma_f32_16x16x32_bf16 v[68:71], v[200:203], v[120:123], v[68:71]
    v_mfma_f32_16x16x32_bf16 v[8:11], v[204:207], v[112:115], v[8:11]
    v_mfma_f32_16x16x32_bf16 v[40:43], v[204:207], v[116:119], v[40:43]
    v_mfma_f32_16x16x32_bf16 v[12:15], v[208:211], v[112:115], v[12:15]
    v_mfma_f32_16x16x32_bf16 v[44:47], v[208:211], v[116:119], v[44:47]
    s_waitcnt vmcnt(0) lgkmcnt(0)
    s_barrier
    ds_read_b64_tr_b16 v[196:197], v234 offset:49152
    ds_read_b64_tr_b16 v[198:199], v234 offset:50176
    ds_read_b64_tr_b16 v[200:201], v235 offset:49152
    ds_read_b64_tr_b16 v[202:203], v235 offset:50176
    ds_read_b64_tr_b16 v[204:205], v236 offset:49152
    ds_read_b64_tr_b16 v[206:207], v236 offset:50176
    v_mfma_f32_16x16x32_bf16 v[16:19], v[212:215], v[112:115], v[16:19]
    ds_read_b128 v[96:99], v144 offset:57344
    ds_read_b128 v[100:103], v144 offset:59392
    ds_read_b128 v[104:107], v146 offset:34816
    v_mfma_f32_16x16x32_bf16 v[48:51], v[212:215], v[116:119], v[48:51]
    s_add_u32 s3, s67, 4
    s_and_b32 s3, s3, 7
    s_lshl_b32 s28, s3, 19
    s_lshl_b32 s3, s3, 7
    s_lshl_b32 s61, s59, 8
    s_add_u32 s28, s28, s61
    s_add_u32 m0, s25, 40960
    s_nop 0
    buffer_load_dwordx4 v228, s[16:19], s28 offen lds
    buffer_load_dwordx4 v229, s[16:19], s28 offen offset:1024 lds
    s_add_u32 s28, s28, 262144
    ds_read_b64_tr_b16 v[208:209], v237 offset:49152
    ds_read_b64_tr_b16 v[210:211], v237 offset:50176
    v_mfma_f32_16x16x32_bf16 v[20:23], v[216:219], v[112:115], v[20:23]
    s_add_u32 m0, s25, 0
    s_nop 0
    buffer_load_dwordx4 v228, s[16:19], s28 offen lds
    buffer_load_dwordx4 v229, s[16:19], s28 offen offset:1024 lds
    v_mfma_f32_16x16x32_bf16 v[52:55], v[216:219], v[116:119], v[52:55]
    s_lshl_b32 s61, s25, 1
    s_add_u32 s62, s29, s3
    s_add_u32 m0, s61, 16384
    s_nop 0
    buffer_load_dwordx4 v230, s[4:7], s62 offen lds
    buffer_load_dwordx4 v231, s[4:7], s62 offen offset:1024 lds
    ds_read_b64_tr_b16 v[212:213], v238 offset:49152
    ds_read_b64_tr_b16 v[214:215], v238 offset:50176
    v_mfma_f32_16x16x32_bf16 v[24:27], v[220:223], v[112:115], v[24:27]
    s_lshl_b32 s61, s25, 1
    s_add_u32 s62, s30, s3
    s_add_u32 m0, s61, 18432
    s_nop 0
    buffer_load_dwordx4 v230, s[4:7], s62 offen lds
    buffer_load_dwordx4 v231, s[4:7], s62 offen offset:1024 lds
    v_mfma_f32_16x16x32_bf16 v[56:59], v[220:223], v[116:119], v[56:59]
    s_lshr_b32 s61, s24, 1
    s_lshl_b32 s61, s61, 10
    s_add_u32 s62, s31, s3
    s_add_u32 m0, s61, 32768
    s_mov_b64 exec, s[68:69]
    buffer_load_dwordx4 v232, s[4:7], s62 offen lds
    s_mov_b64 exec, -1
    ds_read_b64_tr_b16 v[216:217], v239 offset:49152
    ds_read_b64_tr_b16 v[218:219], v239 offset:50176
    v_mfma_f32_16x16x32_bf16 v[28:31], v[224:227], v[112:115], v[28:31]
    v_mfma_f32_16x16x32_bf16 v[60:63], v[224:227], v[116:119], v[60:63]
    s_waitcnt lgkmcnt(14)
    ds_read_b64_tr_b16 v[220:221], v240 offset:49152
    s_waitcnt lgkmcnt(14)
    ds_read_b64_tr_b16 v[222:223], v240 offset:50176
    s_waitcnt lgkmcnt(10)
    v_mfma_f32_16x16x32_bf16 v[0:3], v[196:199], v[96:99], v[0:3]
    s_waitcnt lgkmcnt(9)
    v_mfma_f32_16x16x32_bf16 v[32:35], v[196:199], v[100:103], v[32:35]
    s_waitcnt lgkmcnt(8)
    v_mfma_f32_16x16x32_bf16 v[64:67], v[196:199], v[104:107], v[64:67]
    ds_read_b64_tr_b16 v[224:225], v241 offset:49152
    ds_read_b64_tr_b16 v[226:227], v241 offset:50176
    ds_read_b128 v[112:115], v145 offset:57344
    v_mfma_f32_16x16x32_bf16 v[4:7], v[200:203], v[96:99], v[4:7]
    v_mfma_f32_16x16x32_bf16 v[36:39], v[200:203], v[100:103], v[36:39]
    v_mfma_f32_16x16x32_bf16 v[68:71], v[200:203], v[104:107], v[68:71]
    ds_read_b64_tr_b16 v[196:197], v234 offset:8192
    ds_read_b64_tr_b16 v[198:199], v234 offset:9216
    v_mfma_f32_16x16x32_bf16 v[8:11], v[204:207], v[96:99], v[8:11]
    v_mfma_f32_16x16x32_bf16 v[40:43], v[204:207], v[100:103], v[40:43]
    ds_read_b64_tr_b16 v[200:201], v235 offset:8192
    ds_read_b64_tr_b16 v[202:203], v235 offset:9216
    s_waitcnt lgkmcnt(13)
    v_mfma_f32_16x16x32_bf16 v[12:15], v[208:211], v[96:99], v[12:15]
    ds_read_b128 v[116:119], v145 offset:59392
    v_mfma_f32_16x16x32_bf16 v[44:47], v[208:211], v[100:103], v[44:47]
    ds_read_b64_tr_b16 v[204:205], v236 offset:8192
    s_waitcnt lgkmcnt(14)
    ds_read_b64_tr_b16 v[206:207], v236 offset:9216
    s_waitcnt lgkmcnt(14)
    v_mfma_f32_16x16x32_bf16 v[16:19], v[212:215], v[96:99], v[16:19]
    v_mfma_f32_16x16x32_bf16 v[48:51], v[212:215], v[100:103], v[48:51]
    ds_read_b64_tr_b16 v[208:209], v237 offset:8192
    s_waitcnt lgkmcnt(14)
    ds_read_b64_tr_b16 v[210:211], v237 offset:9216
    s_waitcnt lgkmcnt(14)
    v_mfma_f32_16x16x32_bf16 v[20:23], v[216:219], v[96:99], v[20:23]
    v_mfma_f32_16x16x32_bf16 v[52:55], v[216:219], v[100:103], v[52:55]
    ds_read_b64_tr_b16 v[212:213], v238 offset:8192
    s_waitcnt lgkmcnt(14)
    ds_read_b64_tr_b16 v[214:215], v238 offset:9216
    s_waitcnt lgkmcnt(14)
    v_mfma_f32_16x16x32_bf16 v[24:27], v[220:223], v[96:99], v[24:27]
    ds_read_b128 v[120:123], v147 offset:34816
    v_mfma_f32_16x16x32_bf16 v[56:59], v[220:223], v[100:103], v[56:59]
    s_waitcnt lgkmcnt(14)
    ds_read_b64_tr_b16 v[216:217], v239 offset:8192
    s_waitcnt lgkmcnt(14)
    ds_read_b64_tr_b16 v[218:219], v239 offset:9216
    v_mfma_f32_16x16x32_bf16 v[28:31], v[224:227], v[96:99], v[28:31]
    v_mfma_f32_16x16x32_bf16 v[60:63], v[224:227], v[100:103], v[60:63]
    s_waitcnt lgkmcnt(14)
    ds_read_b64_tr_b16 v[220:221], v240 offset:8192
    s_waitcnt lgkmcnt(14)
    ds_read_b64_tr_b16 v[222:223], v240 offset:9216
    s_waitcnt lgkmcnt(14)
    v_mfma_f32_16x16x32_bf16 v[0:3], v[196:199], v[112:115], v[0:3]
    s_waitcnt lgkmcnt(11)
    v_mfma_f32_16x16x32_bf16 v[32:35], v[196:199], v[116:119], v[32:35]
    s_waitcnt lgkmcnt(4)
    v_mfma_f32_16x16x32_bf16 v[64:67], v[196:199], v[120:123], v[64:67]
    ds_read_b64_tr_b16 v[224:225], v241 offset:8192
    ds_read_b64_tr_b16 v[226:227], v241 offset:9216
    v_mfma_f32_16x16x32_bf16 v[4:7], v[200:203], v[112:115], v[4:7]
    v_mfma_f32_16x16x32_bf16 v[36:39], v[200:203], v[116:119], v[36:39]
    v_mfma_f32_16x16x32_bf16 v[68:71], v[200:203], v[120:123], v[68:71]
    v_mfma_f32_16x16x32_bf16 v[8:11], v[204:207], v[112:115], v[8:11]
    v_mfma_f32_16x16x32_bf16 v[40:43], v[204:207], v[116:119], v[40:43]
    v_mfma_f32_16x16x32_bf16 v[12:15], v[208:211], v[112:115], v[12:15]
    v_mfma_f32_16x16x32_bf16 v[44:47], v[208:211], v[116:119], v[44:47]
    s_waitcnt vmcnt(0) lgkmcnt(0)
    s_barrier
    ds_read_b64_tr_b16 v[196:197], v234 offset:40960
    ds_read_b64_tr_b16 v[198:199], v234 offset:41984
    ds_read_b64_tr_b16 v[200:201], v235 offset:40960
    ds_read_b64_tr_b16 v[202:203], v235 offset:41984
    ds_read_b64_tr_b16 v[204:205], v236 offset:40960
    ds_read_b64_tr_b16 v[206:207], v236 offset:41984
    v_mfma_f32_16x16x32_bf16 v[16:19], v[212:215], v[112:115], v[16:19]
    ds_read_b128 v[96:99], v144 offset:16384
    ds_read_b128 v[100:103], v144 offset:18432
    ds_read_b128 v[104:107], v146 offset:32768
    v_mfma_f32_16x16x32_bf16 v[48:51], v[212:215], v[116:119], v[48:51]
    s_add_u32 s3, s67, 5
    s_and_b32 s3, s3, 7
    s_lshl_b32 s28, s3, 19
    s_lshl_b32 s3, s3, 7
    s_lshl_b32 s61, s59, 8
    s_add_u32 s28, s28, s61
    s_add_u32 m0, s25, 49152
    s_nop 0
    buffer_load_dwordx4 v228, s[16:19], s28 offen lds
    buffer_load_dwordx4 v229, s[16:19], s28 offen offset:1024 lds
    s_add_u32 s28, s28, 262144
    ds_read_b64_tr_b16 v[208:209], v237 offset:40960
    ds_read_b64_tr_b16 v[210:211], v237 offset:41984
    v_mfma_f32_16x16x32_bf16 v[20:23], v[216:219], v[112:115], v[20:23]
    s_add_u32 m0, s25, 8192
    s_nop 0
    buffer_load_dwordx4 v228, s[16:19], s28 offen lds
    buffer_load_dwordx4 v229, s[16:19], s28 offen offset:1024 lds
    v_mfma_f32_16x16x32_bf16 v[52:55], v[216:219], v[116:119], v[52:55]
    s_lshl_b32 s61, s25, 1
    s_add_u32 s62, s29, s3
    s_add_u32 m0, s61, 57344
    s_nop 0
    buffer_load_dwordx4 v230, s[4:7], s62 offen lds
    buffer_load_dwordx4 v231, s[4:7], s62 offen offset:1024 lds
    ds_read_b64_tr_b16 v[212:213], v238 offset:40960
    ds_read_b64_tr_b16 v[214:215], v238 offset:41984
    v_mfma_f32_16x16x32_bf16 v[24:27], v[220:223], v[112:115], v[24:27]
    s_lshl_b32 s61, s25, 1
    s_add_u32 s62, s30, s3
    s_add_u32 m0, s61, 59392
    s_nop 0
    buffer_load_dwordx4 v230, s[4:7], s62 offen lds
    buffer_load_dwordx4 v231, s[4:7], s62 offen offset:1024 lds
    v_mfma_f32_16x16x32_bf16 v[56:59], v[220:223], v[116:119], v[56:59]
    s_lshr_b32 s61, s24, 1
    s_lshl_b32 s61, s61, 10
    s_add_u32 s62, s31, s3
    s_add_u32 m0, s61, 34816
    s_mov_b64 exec, s[68:69]
    buffer_load_dwordx4 v232, s[4:7], s62 offen lds
    s_mov_b64 exec, -1
    ds_read_b64_tr_b16 v[216:217], v239 offset:40960
    ds_read_b64_tr_b16 v[218:219], v239 offset:41984
    v_mfma_f32_16x16x32_bf16 v[28:31], v[224:227], v[112:115], v[28:31]
    v_mfma_f32_16x16x32_bf16 v[60:63], v[224:227], v[116:119], v[60:63]
    s_waitcnt lgkmcnt(14)
    ds_read_b64_tr_b16 v[220:221], v240 offset:40960
    s_waitcnt lgkmcnt(14)
    ds_read_b64_tr_b16 v[222:223], v240 offset:41984
    s_waitcnt lgkmcnt(10)
    v_mfma_f32_16x16x32_bf16 v[0:3], v[196:199], v[96:99], v[0:3]
    s_waitcnt lgkmcnt(9)
    v_mfma_f32_16x16x32_bf16 v[32:35], v[196:199], v[100:103], v[32:35]
    s_waitcnt lgkmcnt(8)
    v_mfma_f32_16x16x32_bf16 v[64:67], v[196:199], v[104:107], v[64:67]
    ds_read_b64_tr_b16 v[224:225], v241 offset:40960
    ds_read_b64_tr_b16 v[226:227], v241 offset:41984
    ds_read_b128 v[112:115], v145 offset:16384
    v_mfma_f32_16x16x32_bf16 v[4:7], v[200:203], v[96:99], v[4:7]
    v_mfma_f32_16x16x32_bf16 v[36:39], v[200:203], v[100:103], v[36:39]
    v_mfma_f32_16x16x32_bf16 v[68:71], v[200:203], v[104:107], v[68:71]
    ds_read_b64_tr_b16 v[196:197], v234
    ds_read_b64_tr_b16 v[198:199], v234 offset:1024
    v_mfma_f32_16x16x32_bf16 v[8:11], v[204:207], v[96:99], v[8:11]
    v_mfma_f32_16x16x32_bf16 v[40:43], v[204:207], v[100:103], v[40:43]
    ds_read_b64_tr_b16 v[200:201], v235
    ds_read_b64_tr_b16 v[202:203], v235 offset:1024
    s_waitcnt lgkmcnt(13)
    v_mfma_f32_16x16x32_bf16 v[12:15], v[208:211], v[96:99], v[12:15]
    ds_read_b128 v[116:119], v145 offset:18432
    v_mfma_f32_16x16x32_bf16 v[44:47], v[208:211], v[100:103], v[44:47]
    ds_read_b64_tr_b16 v[204:205], v236
    s_waitcnt lgkmcnt(14)
    ds_read_b64_tr_b16 v[206:207], v236 offset:1024
    s_waitcnt lgkmcnt(14)
    v_mfma_f32_16x16x32_bf16 v[16:19], v[212:215], v[96:99], v[16:19]
    v_mfma_f32_16x16x32_bf16 v[48:51], v[212:215], v[100:103], v[48:51]
    ds_read_b64_tr_b16 v[208:209], v237
    s_waitcnt lgkmcnt(14)
    ds_read_b64_tr_b16 v[210:211], v237 offset:1024
    s_waitcnt lgkmcnt(14)
    v_mfma_f32_16x16x32_bf16 v[20:23], v[216:219], v[96:99], v[20:23]
    v_mfma_f32_16x16x32_bf16 v[52:55], v[216:219], v[100:103], v[52:55]
    ds_read_b64_tr_b16 v[212:213], v238
    s_waitcnt lgkmcnt(14)
    ds_read_b64_tr_b16 v[214:215], v238 offset:1024
    s_waitcnt lgkmcnt(14)
    v_mfma_f32_16x16x32_bf16 v[24:27], v[220:223], v[96:99], v[24:27]
    ds_read_b128 v[120:123], v147 offset:32768
    v_mfma_f32_16x16x32_bf16 v[56:59], v[220:223], v[100:103], v[56:59]
    s_waitcnt lgkmcnt(14)
    ds_read_b64_tr_b16 v[216:217], v239
    s_waitcnt lgkmcnt(14)
    ds_read_b64_tr_b16 v[218:219], v239 offset:1024
    v_mfma_f32_16x16x32_bf16 v[28:31], v[224:227], v[96:99], v[28:31]
    v_mfma_f32_16x16x32_bf16 v[60:63], v[224:227], v[100:103], v[60:63]
    s_waitcnt lgkmcnt(14)
    ds_read_b64_tr_b16 v[220:221], v240
    s_waitcnt lgkmcnt(14)
    ds_read_b64_tr_b16 v[222:223], v240 offset:1024
    s_waitcnt lgkmcnt(14)
    v_mfma_f32_16x16x32_bf16 v[0:3], v[196:199], v[112:115], v[0:3]
    s_waitcnt lgkmcnt(11)
    v_mfma_f32_16x16x32_bf16 v[32:35], v[196:199], v[116:119], v[32:35]
    s_waitcnt lgkmcnt(4)
    v_mfma_f32_16x16x32_bf16 v[64:67], v[196:199], v[120:123], v[64:67]
    ds_read_b64_tr_b16 v[224:225], v241
    ds_read_b64_tr_b16 v[226:227], v241 offset:1024
    v_mfma_f32_16x16x32_bf16 v[4:7], v[200:203], v[112:115], v[4:7]
    v_mfma_f32_16x16x32_bf16 v[36:39], v[200:203], v[116:119], v[36:39]
    v_mfma_f32_16x16x32_bf16 v[68:71], v[200:203], v[120:123], v[68:71]
    v_mfma_f32_16x16x32_bf16 v[8:11], v[204:207], v[112:115], v[8:11]
    v_mfma_f32_16x16x32_bf16 v[40:43], v[204:207], v[116:119], v[40:43]
    v_mfma_f32_16x16x32_bf16 v[12:15], v[208:211], v[112:115], v[12:15]
    v_mfma_f32_16x16x32_bf16 v[44:47], v[208:211], v[116:119], v[44:47]
    s_waitcnt vmcnt(0) lgkmcnt(0)
    s_barrier
    ds_read_b64_tr_b16 v[196:197], v234 offset:49152
    ds_read_b64_tr_b16 v[198:199], v234 offset:50176
    ds_read_b64_tr_b16 v[200:201], v235 offset:49152
    ds_read_b64_tr_b16 v[202:203], v235 offset:50176
    ds_read_b64_tr_b16 v[204:205], v236 offset:49152
    ds_read_b64_tr_b16 v[206:207], v236 offset:50176
    v_mfma_f32_16x16x32_bf16 v[16:19], v[212:215], v[112:115], v[16:19]
    ds_read_b128 v[96:99], v144 offset:57344
    ds_read_b128 v[100:103], v144 offset:59392
    ds_read_b128 v[104:107], v146 offset:34816
    v_mfma_f32_16x16x32_bf16 v[48:51], v[212:215], v[116:119], v[48:51]
    s_add_u32 s3, s67, 6
    s_and_b32 s3, s3, 7
    s_lshl_b32 s28, s3, 19
    s_lshl_b32 s3, s3, 7
    s_lshl_b32 s61, s59, 8
    s_add_u32 s28, s28, s61
    s_add_u32 m0, s25, 40960
    s_nop 0
    buffer_load_dwordx4 v228, s[16:19], s28 offen lds
    buffer_load_dwordx4 v229, s[16:19], s28 offen offset:1024 lds
    s_add_u32 s28, s28, 262144
    ds_read_b64_tr_b16 v[208:209], v237 offset:49152
    ds_read_b64_tr_b16 v[210:211], v237 offset:50176
    v_mfma_f32_16x16x32_bf16 v[20:23], v[216:219], v[112:115], v[20:23]
    s_add_u32 m0, s25, 0
    s_nop 0
    buffer_load_dwordx4 v228, s[16:19], s28 offen lds
    buffer_load_dwordx4 v229, s[16:19], s28 offen offset:1024 lds
    v_mfma_f32_16x16x32_bf16 v[52:55], v[216:219], v[116:119], v[52:55]
    s_lshl_b32 s61, s25, 1
    s_add_u32 s62, s29, s3
    s_add_u32 m0, s61, 16384
    s_nop 0
    buffer_load_dwordx4 v230, s[4:7], s62 offen lds
    buffer_load_dwordx4 v231, s[4:7], s62 offen offset:1024 lds
    ds_read_b64_tr_b16 v[212:213], v238 offset:49152
    ds_read_b64_tr_b16 v[214:215], v238 offset:50176
    v_mfma_f32_16x16x32_bf16 v[24:27], v[220:223], v[112:115], v[24:27]
    s_lshl_b32 s61, s25, 1
    s_add_u32 s62, s30, s3
    s_add_u32 m0, s61, 18432
    s_nop 0
    buffer_load_dwordx4 v230, s[4:7], s62 offen lds
    buffer_load_dwordx4 v231, s[4:7], s62 offen offset:1024 lds
    v_mfma_f32_16x16x32_bf16 v[56:59], v[220:223], v[116:119], v[56:59]
    s_lshr_b32 s61, s24, 1
    s_lshl_b32 s61, s61, 10
    s_add_u32 s62, s31, s3
    s_add_u32 m0, s61, 32768
    s_mov_b64 exec, s[68:69]
    buffer_load_dwordx4 v232, s[4:7], s62 offen lds
    s_mov_b64 exec, -1
    ds_read_b64_tr_b16 v[216:217], v239 offset:49152
    ds_read_b64_tr_b16 v[218:219], v239 offset:50176
    v_mfma_f32_16x16x32_bf16 v[28:31], v[224:227], v[112:115], v[28:31]
    v_mfma_f32_16x16x32_bf16 v[60:63], v[224:227], v[116:119], v[60:63]
    s_waitcnt lgkmcnt(14)
    ds_read_b64_tr_b16 v[220:221], v240 offset:49152
    s_waitcnt lgkmcnt(14)
    ds_read_b64_tr_b16 v[222:223], v240 offset:50176
    s_waitcnt lgkmcnt(10)
    v_mfma_f32_16x16x32_bf16 v[0:3], v[196:199], v[96:99], v[0:3]
    s_waitcnt lgkmcnt(9)
    v_mfma_f32_16x16x32_bf16 v[32:35], v[196:199], v[100:103], v[32:35]
    s_waitcnt lgkmcnt(8)
    v_mfma_f32_16x16x32_bf16 v[64:67], v[196:199], v[104:107], v[64:67]
    ds_read_b64_tr_b16 v[224:225], v241 offset:49152
    ds_read_b64_tr_b16 v[226:227], v241 offset:50176
    ds_read_b128 v[112:115], v145 offset:57344
    v_mfma_f32_16x16x32_bf16 v[4:7], v[200:203], v[96:99], v[4:7]
    v_mfma_f32_16x16x32_bf16 v[36:39], v[200:203], v[100:103], v[36:39]
    v_mfma_f32_16x16x32_bf16 v[68:71], v[200:203], v[104:107], v[68:71]
    ds_read_b64_tr_b16 v[196:197], v234 offset:8192
    ds_read_b64_tr_b16 v[198:199], v234 offset:9216
    v_mfma_f32_16x16x32_bf16 v[8:11], v[204:207], v[96:99], v[8:11]
    v_mfma_f32_16x16x32_bf16 v[40:43], v[204:207], v[100:103], v[40:43]
    ds_read_b64_tr_b16 v[200:201], v235 offset:8192
    ds_read_b64_tr_b16 v[202:203], v235 offset:9216
    s_waitcnt lgkmcnt(13)
    v_mfma_f32_16x16x32_bf16 v[12:15], v[208:211], v[96:99], v[12:15]
    ds_read_b128 v[116:119], v145 offset:59392
    v_mfma_f32_16x16x32_bf16 v[44:47], v[208:211], v[100:103], v[44:47]
    ds_read_b64_tr_b16 v[204:205], v236 offset:8192
    s_waitcnt lgkmcnt(14)
    ds_read_b64_tr_b16 v[206:207], v236 offset:9216
    s_waitcnt lgkmcnt(14)
    v_mfma_f32_16x16x32_bf16 v[16:19], v[212:215], v[96:99], v[16:19]
    v_mfma_f32_16x16x32_bf16 v[48:51], v[212:215], v[100:103], v[48:51]
    ds_read_b64_tr_b16 v[208:209], v237 offset:8192
    s_waitcnt lgkmcnt(14)
    ds_read_b64_tr_b16 v[210:211], v237 offset:9216
    s_waitcnt lgkmcnt(14)
    v_mfma_f32_16x16x32_bf16 v[20:23], v[216:219], v[96:99], v[20:23]
    v_mfma_f32_16x16x32_bf16 v[52:55], v[216:219], v[100:103], v[52:55]
    ds_read_b64_tr_b16 v[212:213], v238 offset:8192
    s_waitcnt lgkmcnt(14)
    ds_read_b64_tr_b16 v[214:215], v238 offset:9216
    s_waitcnt lgkmcnt(14)
    v_mfma_f32_16x16x32_bf16 v[24:27], v[220:223], v[96:99], v[24:27]
    ds_read_b128 v[120:123], v147 offset:34816
    v_mfma_f32_16x16x32_bf16 v[56:59], v[220:223], v[100:103], v[56:59]
    s_waitcnt lgkmcnt(14)
    ds_read_b64_tr_b16 v[216:217], v239 offset:8192
    s_waitcnt lgkmcnt(14)
    ds_read_b64_tr_b16 v[218:219], v239 offset:9216
    v_mfma_f32_16x16x32_bf16 v[28:31], v[224:227], v[96:99], v[28:31]
    v_mfma_f32_16x16x32_bf16 v[60:63], v[224:227], v[100:103], v[60:63]
    s_waitcnt lgkmcnt(14)
    ds_read_b64_tr_b16 v[220:221], v240 offset:8192
    s_waitcnt lgkmcnt(14)
    ds_read_b64_tr_b16 v[222:223], v240 offset:9216
    s_waitcnt lgkmcnt(14)
    v_mfma_f32_16x16x32_bf16 v[0:3], v[196:199], v[112:115], v[0:3]
    s_waitcnt lgkmcnt(11)
    v_mfma_f32_16x16x32_bf16 v[32:35], v[196:199], v[116:119], v[32:35]
    s_waitcnt lgkmcnt(4)
    v_mfma_f32_16x16x32_bf16 v[64:67], v[196:199], v[120:123], v[64:67]
    ds_read_b64_tr_b16 v[224:225], v241 offset:8192
    ds_read_b64_tr_b16 v[226:227], v241 offset:9216
    v_mfma_f32_16x16x32_bf16 v[4:7], v[200:203], v[112:115], v[4:7]
    v_mfma_f32_16x16x32_bf16 v[36:39], v[200:203], v[116:119], v[36:39]
    v_mfma_f32_16x16x32_bf16 v[68:71], v[200:203], v[120:123], v[68:71]
    v_mfma_f32_16x16x32_bf16 v[8:11], v[204:207], v[112:115], v[8:11]
    v_mfma_f32_16x16x32_bf16 v[40:43], v[204:207], v[116:119], v[40:43]
    v_mfma_f32_16x16x32_bf16 v[12:15], v[208:211], v[112:115], v[12:15]
    v_mfma_f32_16x16x32_bf16 v[44:47], v[208:211], v[116:119], v[44:47]
    s_waitcnt vmcnt(0) lgkmcnt(0)
    s_barrier
    ds_read_b64_tr_b16 v[196:197], v234 offset:40960
    ds_read_b64_tr_b16 v[198:199], v234 offset:41984
    ds_read_b64_tr_b16 v[200:201], v235 offset:40960
    ds_read_b64_tr_b16 v[202:203], v235 offset:41984
    ds_read_b64_tr_b16 v[204:205], v236 offset:40960
    ds_read_b64_tr_b16 v[206:207], v236 offset:41984
    v_mfma_f32_16x16x32_bf16 v[16:19], v[212:215], v[112:115], v[16:19]
    ds_read_b128 v[96:99], v144 offset:16384
    ds_read_b128 v[100:103], v144 offset:18432
    ds_read_b128 v[104:107], v146 offset:32768
    v_mfma_f32_16x16x32_bf16 v[48:51], v[212:215], v[116:119], v[48:51]
    s_add_u32 s3, s67, 7
    s_and_b32 s3, s3, 7
    s_lshl_b32 s28, s3, 19
    s_lshl_b32 s3, s3, 7
    s_lshl_b32 s61, s59, 8
    s_add_u32 s28, s28, s61
    s_add_u32 m0, s25, 49152
    s_nop 0
    buffer_load_dwordx4 v228, s[16:19], s28 offen lds
    buffer_load_dwordx4 v229, s[16:19], s28 offen offset:1024 lds
    s_add_u32 s28, s28, 262144
    ds_read_b64_tr_b16 v[208:209], v237 offset:40960
    ds_read_b64_tr_b16 v[210:211], v237 offset:41984
    v_mfma_f32_16x16x32_bf16 v[20:23], v[216:219], v[112:115], v[20:23]
    s_add_u32 m0, s25, 8192
    s_nop 0
    buffer_load_dwordx4 v228, s[16:19], s28 offen lds
    buffer_load_dwordx4 v229, s[16:19], s28 offen offset:1024 lds
    v_mfma_f32_16x16x32_bf16 v[52:55], v[216:219], v[116:119], v[52:55]
    s_lshl_b32 s61, s25, 1
    s_add_u32 s62, s29, s3
    s_add_u32 m0, s61, 57344
    s_nop 0
    buffer_load_dwordx4 v230, s[4:7], s62 offen lds
    buffer_load_dwordx4 v231, s[4:7], s62 offen offset:1024 lds
    ds_read_b64_tr_b16 v[212:213], v238 offset:40960
    ds_read_b64_tr_b16 v[214:215], v238 offset:41984
    v_mfma_f32_16x16x32_bf16 v[24:27], v[220:223], v[112:115], v[24:27]
    s_lshl_b32 s61, s25, 1
    s_add_u32 s62, s30, s3
    s_add_u32 m0, s61, 59392
    s_nop 0
    buffer_load_dwordx4 v230, s[4:7], s62 offen lds
    buffer_load_dwordx4 v231, s[4:7], s62 offen offset:1024 lds
    v_mfma_f32_16x16x32_bf16 v[56:59], v[220:223], v[116:119], v[56:59]
    s_lshr_b32 s61, s24, 1
    s_lshl_b32 s61, s61, 10
    s_add_u32 s62, s31, s3
    s_add_u32 m0, s61, 34816
    s_mov_b64 exec, s[68:69]
    buffer_load_dwordx4 v232, s[4:7], s62 offen lds
    s_mov_b64 exec, -1
    ds_read_b64_tr_b16 v[216:217], v239 offset:40960
    ds_read_b64_tr_b16 v[218:219], v239 offset:41984
    v_mfma_f32_16x16x32_bf16 v[28:31], v[224:227], v[112:115], v[28:31]
    s_add_u32 m0, s25, 73728
    s_nop 0
    buffer_load_dwordx4 v246, s[8:11], s26 offen nt lds
    v_mfma_f32_16x16x32_bf16 v[60:63], v[224:227], v[116:119], v[60:63]
    buffer_load_dwordx4 v246, s[8:11], s26 offen offset:1024 nt lds
    s_add_u32 s26, s26, 8192
    s_waitcnt lgkmcnt(14)
    ds_read_b64_tr_b16 v[220:221], v240 offset:40960
    s_waitcnt lgkmcnt(14)
    ds_read_b64_tr_b16 v[222:223], v240 offset:41984
    s_waitcnt lgkmcnt(10)
    v_mfma_f32_16x16x32_bf16 v[0:3], v[196:199], v[96:99], v[0:3]
    s_waitcnt lgkmcnt(9)
    v_mfma_f32_16x16x32_bf16 v[32:35], v[196:199], v[100:103], v[32:35]
    s_waitcnt lgkmcnt(8)
    v_mfma_f32_16x16x32_bf16 v[64:67], v[196:199], v[104:107], v[64:67]
    ds_read_b64_tr_b16 v[224:225], v241 offset:40960
    ds_read_b64_tr_b16 v[226:227], v241 offset:41984
    ds_read_b128 v[112:115], v145 offset:16384
    v_mfma_f32_16x16x32_bf16 v[4:7], v[200:203], v[96:99], v[4:7]
    v_mfma_f32_16x16x32_bf16 v[36:39], v[200:203], v[100:103], v[36:39]
    v_mfma_f32_16x16x32_bf16 v[68:71], v[200:203], v[104:107], v[68:71]
    ds_read_b64_tr_b16 v[196:197], v234
    ds_read_b64_tr_b16 v[198:199], v234 offset:1024
    v_mfma_f32_16x16x32_bf16 v[8:11], v[204:207], v[96:99], v[8:11]
    v_mfma_f32_16x16x32_bf16 v[40:43], v[204:207], v[100:103], v[40:43]
    ds_read_b64_tr_b16 v[200:201], v235
    ds_read_b64_tr_b16 v[202:203], v235 offset:1024
    s_waitcnt lgkmcnt(13)
    v_mfma_f32_16x16x32_bf16 v[12:15], v[208:211], v[96:99], v[12:15]
    ds_read_b128 v[116:119], v145 offset:18432
    v_mfma_f32_16x16x32_bf16 v[44:47], v[208:211], v[100:103], v[44:47]
    ds_read_b64_tr_b16 v[204:205], v236
    s_waitcnt lgkmcnt(14)
    ds_read_b64_tr_b16 v[206:207], v236 offset:1024
    s_waitcnt lgkmcnt(14)
    v_mfma_f32_16x16x32_bf16 v[16:19], v[212:215], v[96:99], v[16:19]
    v_mfma_f32_16x16x32_bf16 v[48:51], v[212:215], v[100:103], v[48:51]
    ds_read_b64_tr_b16 v[208:209], v237
    s_waitcnt lgkmcnt(14)
    ds_read_b64_tr_b16 v[210:211], v237 offset:1024
    s_waitcnt lgkmcnt(14)
    v_mfma_f32_16x16x32_bf16 v[20:23], v[216:219], v[96:99], v[20:23]
    v_mfma_f32_16x16x32_bf16 v[52:55], v[216:219], v[100:103], v[52:55]
    ds_read_b64_tr_b16 v[212:213], v238
    s_waitcnt lgkmcnt(14)
    ds_read_b64_tr_b16 v[214:215], v238 offset:1024
    s_waitcnt lgkmcnt(14)
    v_mfma_f32_16x16x32_bf16 v[24:27], v[220:223], v[96:99], v[24:27]
    ds_read_b128 v[120:123], v147 offset:32768
    v_mfma_f32_16x16x32_bf16 v[56:59], v[220:223], v[100:103], v[56:59]
    s_waitcnt lgkmcnt(14)
    ds_read_b64_tr_b16 v[216:217], v239
    s_waitcnt lgkmcnt(14)
    ds_read_b64_tr_b16 v[218:219], v239 offset:1024
    v_mfma_f32_16x16x32_bf16 v[28:31], v[224:227], v[96:99], v[28:31]
    v_mfma_f32_16x16x32_bf16 v[60:63], v[224:227], v[100:103], v[60:63]
    s_waitcnt lgkmcnt(14)
    ds_read_b64_tr_b16 v[220:221], v240
    s_waitcnt lgkmcnt(14)
    ds_read_b64_tr_b16 v[222:223], v240 offset:1024
    s_waitcnt lgkmcnt(14)
    v_mfma_f32_16x16x32_bf16 v[0:3], v[196:199], v[112:115], v[0:3]
    s_waitcnt lgkmcnt(11)
    v_mfma_f32_16x16x32_bf16 v[32:35], v[196:199], v[116:119], v[32:35]
    s_waitcnt lgkmcnt(4)
    v_mfma_f32_16x16x32_bf16 v[64:67], v[196:199], v[120:123], v[64:67]
    ds_read_b64_tr_b16 v[224:225], v241
    ds_read_b64_tr_b16 v[226:227], v241 offset:1024
    v_mfma_f32_16x16x32_bf16 v[4:7], v[200:203], v[112:115], v[4:7]
    v_mfma_f32_16x16x32_bf16 v[36:39], v[200:203], v[116:119], v[36:39]
    v_mfma_f32_16x16x32_bf16 v[68:71], v[200:203], v[120:123], v[68:71]
    v_mfma_f32_16x16x32_bf16 v[8:11], v[204:207], v[112:115], v[8:11]
    v_mfma_f32_16x16x32_bf16 v[40:43], v[204:207], v[116:119], v[40:43]
    v_mfma_f32_16x16x32_bf16 v[12:15], v[208:211], v[112:115], v[12:15]
    v_mfma_f32_16x16x32_bf16 v[44:47], v[208:211], v[116:119], v[44:47]
    s_waitcnt vmcnt(2) lgkmcnt(0)
    s_barrier
    ds_read_b64_tr_b16 v[196:197], v234 offset:49152
    ds_read_b64_tr_b16 v[198:199], v234 offset:50176
    ds_read_b64_tr_b16 v[200:201], v235 offset:49152
    ds_read_b64_tr_b16 v[202:203], v235 offset:50176
    ds_read_b64_tr_b16 v[204:205], v236 offset:49152
    ds_read_b64_tr_b16 v[206:207], v236 offset:50176
    v_mfma_f32_16x16x32_bf16 v[16:19], v[212:215], v[112:115], v[16:19]
    ds_read_b128 v[96:99], v144 offset:57344
    ds_read_b128 v[100:103], v144 offset:59392
    ds_read_b128 v[104:107], v146 offset:34816
    v_mfma_f32_16x16x32_bf16 v[48:51], v[212:215], v[116:119], v[48:51]
    s_add_u32 m0, s25, 40960
    s_nop 0
    buffer_load_dwordx4 v246, s[8:11], s26 offen nt lds
    ds_read_b64_tr_b16 v[208:209], v237 offset:49152
    ds_read_b64_tr_b16 v[210:211], v237 offset:50176
    v_mfma_f32_16x16x32_bf16 v[20:23], v[216:219], v[112:115], v[20:23]
    buffer_load_dwordx4 v246, s[8:11], s26 offen offset:1024 nt lds
    s_add_u32 s26, s26, 8192
    v_mfma_f32_16x16x32_bf16 v[52:55], v[216:219], v[116:119], v[52:55]
    s_add_u32 m0, s25, 0
    s_nop 0
    buffer_load_dwordx4 v247, s[12:15], s27 offen nt lds
    ds_read_b64_tr_b16 v[212:213], v238 offset:49152
    ds_read_b64_tr_b16 v[214:215], v238 offset:50176
    v_mfma_f32_16x16x32_bf16 v[24:27], v[220:223], v[112:115], v[24:27]
    buffer_load_dwordx4 v247, s[12:15], s27 offen offset:1024 nt lds
    s_add_u32 s27, s27, 8192
    v_mfma_f32_16x16x32_bf16 v[56:59], v[220:223], v[116:119], v[56:59]
    ds_read_b64_tr_b16 v[216:217], v239 offset:49152
    ds_read_b64_tr_b16 v[218:219], v239 offset:50176
    v_mfma_f32_16x16x32_bf16 v[28:31], v[224:227], v[112:115], v[28:31]
    v_mfma_f32_16x16x32_bf16 v[60:63], v[224:227], v[116:119], v[60:63]
    s_waitcnt lgkmcnt(14)
    ds_read_b64_tr_b16 v[220:221], v240 offset:49152
    s_waitcnt lgkmcnt(14)
    ds_read_b64_tr_b16 v[222:223], v240 offset:50176
    s_waitcnt lgkmcnt(10)
    v_mfma_f32_16x16x32_bf16 v[0:3], v[196:199], v[96:99], v[0:3]
    s_waitcnt lgkmcnt(9)
    v_mfma_f32_16x16x32_bf16 v[32:35], v[196:199], v[100:103], v[32:35]
    s_waitcnt lgkmcnt(8)
    v_mfma_f32_16x16x32_bf16 v[64:67], v[196:199], v[104:107], v[64:67]
    ds_read_b64_tr_b16 v[224:225], v241 offset:49152
    ds_read_b64_tr_b16 v[226:227], v241 offset:50176
    ds_read_b128 v[112:115], v145 offset:57344
    v_mfma_f32_16x16x32_bf16 v[4:7], v[200:203], v[96:99], v[4:7]
    v_mfma_f32_16x16x32_bf16 v[36:39], v[200:203], v[100:103], v[36:39]
    v_mfma_f32_16x16x32_bf16 v[68:71], v[200:203], v[104:107], v[68:71]
    ds_read_b64_tr_b16 v[196:197], v234 offset:8192
    ds_read_b64_tr_b16 v[198:199], v234 offset:9216
    v_mfma_f32_16x16x32_bf16 v[8:11], v[204:207], v[96:99], v[8:11]
    v_mfma_f32_16x16x32_bf16 v[40:43], v[204:207], v[100:103], v[40:43]
    ds_read_b64_tr_b16 v[200:201], v235 offset:8192
    ds_read_b64_tr_b16 v[202:203], v235 offset:9216
    s_waitcnt lgkmcnt(13)
    v_mfma_f32_16x16x32_bf16 v[12:15], v[208:211], v[96:99], v[12:15]
    ds_read_b128 v[116:119], v145 offset:59392
    v_mfma_f32_16x16x32_bf16 v[44:47], v[208:211], v[100:103], v[44:47]
    ds_read_b64_tr_b16 v[204:205], v236 offset:8192
    s_waitcnt lgkmcnt(14)
    ds_read_b64_tr_b16 v[206:207], v236 offset:9216
    s_waitcnt lgkmcnt(14)
    v_mfma_f32_16x16x32_bf16 v[16:19], v[212:215], v[96:99], v[16:19]
    v_mfma_f32_16x16x32_bf16 v[48:51], v[212:215], v[100:103], v[48:51]
    ds_read_b64_tr_b16 v[208:209], v237 offset:8192
    s_waitcnt lgkmcnt(14)
    ds_read_b64_tr_b16 v[210:211], v237 offset:9216
    s_waitcnt lgkmcnt(14)
    v_mfma_f32_16x16x32_bf16 v[20:23], v[216:219], v[96:99], v[20:23]
    v_mfma_f32_16x16x32_bf16 v[52:55], v[216:219], v[100:103], v[52:55]
    ds_read_b64_tr_b16 v[212:213], v238 offset:8192
    s_waitcnt lgkmcnt(14)
    ds_read_b64_tr_b16 v[214:215], v238 offset:9216
    s_waitcnt lgkmcnt(14)
    v_mfma_f32_16x16x32_bf16 v[24:27], v[220:223], v[96:99], v[24:27]
    ds_read_b128 v[120:123], v147 offset:34816
    v_mfma_f32_16x16x32_bf16 v[56:59], v[220:223], v[100:103], v[56:59]
    s_waitcnt lgkmcnt(14)
    ds_read_b64_tr_b16 v[216:217], v239 offset:8192
    s_waitcnt lgkmcnt(14)
    ds_read_b64_tr_b16 v[218:219], v239 offset:9216
    v_mfma_f32_16x16x32_bf16 v[28:31], v[224:227], v[96:99], v[28:31]
    v_mfma_f32_16x16x32_bf16 v[60:63], v[224:227], v[100:103], v[60:63]
    s_waitcnt lgkmcnt(14)
    ds_read_b64_tr_b16 v[220:221], v240 offset:8192
    s_waitcnt lgkmcnt(14)
    ds_read_b64_tr_b16 v[222:223], v240 offset:9216
    s_waitcnt lgkmcnt(14)
    v_mfma_f32_16x16x32_bf16 v[0:3], v[196:199], v[112:115], v[0:3]
    s_waitcnt lgkmcnt(11)
    v_mfma_f32_16x16x32_bf16 v[32:35], v[196:199], v[116:119], v[32:35]
    s_waitcnt lgkmcnt(4)
    v_mfma_f32_16x16x32_bf16 v[64:67], v[196:199], v[120:123], v[64:67]
    ds_read_b64_tr_b16 v[224:225], v241 offset:8192
    ds_read_b64_tr_b16 v[226:227], v241 offset:9216
    v_mfma_f32_16x16x32_bf16 v[4:7], v[200:203], v[112:115], v[4:7]
    v_mfma_f32_16x16x32_bf16 v[36:39], v[200:203], v[116:119], v[36:39]
    v_mfma_f32_16x16x32_bf16 v[68:71], v[200:203], v[120:123], v[68:71]
    v_mfma_f32_16x16x32_bf16 v[8:11], v[204:207], v[112:115], v[8:11]
    v_mfma_f32_16x16x32_bf16 v[40:43], v[204:207], v[116:119], v[40:43]
    v_mfma_f32_16x16x32_bf16 v[12:15], v[208:211], v[112:115], v[12:15]
    v_mfma_f32_16x16x32_bf16 v[44:47], v[208:211], v[116:119], v[44:47]
    v_mfma_f32_16x16x32_bf16 v[16:19], v[212:215], v[112:115], v[16:19]
    v_mfma_f32_16x16x32_bf16 v[48:51], v[212:215], v[116:119], v[48:51]
    s_waitcnt lgkmcnt(4)
    v_mfma_f32_16x16x32_bf16 v[20:23], v[216:219], v[112:115], v[20:23]
    v_mfma_f32_16x16x32_bf16 v[52:55], v[216:219], v[116:119], v[52:55]
    s_waitcnt lgkmcnt(2)
    v_mfma_f32_16x16x32_bf16 v[24:27], v[220:223], v[112:115], v[24:27]
    v_mfma_f32_16x16x32_bf16 v[56:59], v[220:223], v[116:119], v[56:59]
    s_waitcnt lgkmcnt(0)
    v_mfma_f32_16x16x32_bf16 v[28:31], v[224:227], v[112:115], v[28:31]
    v_mfma_f32_16x16x32_bf16 v[60:63], v[224:227], v[116:119], v[60:63]
    v_mul_f32 v64, s66, v64
    v_mul_f32 v65, s66, v65
    v_mul_f32 v66, s66, v66
    v_mul_f32 v67, s66, v67
    v_mul_f32 v68, s66, v68
    v_mul_f32 v69, s66, v69
    v_mul_f32 v70, s66, v70
    v_mul_f32 v71, s66, v71
    v_cvt_pk_bf16_f32 v188, v64, v65
    v_cvt_pk_bf16_f32 v189, v66, v67
    v_cvt_pk_bf16_f32 v190, v68, v69
    v_cvt_pk_bf16_f32 v191, v70, v71
    s_mov_b32 exec_lo, 0xffff0000
    s_mov_b32 exec_hi, 0xffff0000
    v_swap_b32 v188, v190
    v_swap_b32 v189, v191
    s_mov_b64 exec, -1
    v_lshlrev_b32 v251, 4, v248
    s_lshl_b32 s61, s24, 10
    v_add_u32 v252, s61, v251
    ds_write_b128 v252, v[188:191] offset:36864
    s_waitcnt lgkmcnt(0)
    s_barrier
    s_add_u32 m0, s25, 49152
    s_nop 0
    buffer_load_dwordx4 v246, s[8:11], s26 offen nt lds
    buffer_load_dwordx4 v246, s[8:11], s26 offen offset:1024 nt lds
    s_add_u32 s26, s26, 8192
    s_add_u32 m0, s25, 8192
    s_nop 0
    buffer_load_dwordx4 v247, s[12:15], s27 offen nt lds
    buffer_load_dwordx4 v247, s[12:15], s27 offen offset:1024 nt lds
    s_add_u32 s27, s27, 8192
    v_mul_f32 v0, s66, v0
    v_mul_f32 v1, s66, v1
    v_mul_f32 v2, s66, v2
    v_mul_f32 v3, s66, v3
    v_mul_f32 v4, s66, v4
    v_mul_f32 v5, s66, v5
    v_mul_f32 v6, s66, v6
    v_mul_f32 v7, s66, v7
    v_cvt_pk_bf16_f32 v96, v0, v1
    v_cvt_pk_bf16_f32 v97, v2, v3
    v_cvt_pk_bf16_f32 v98, v4, v5
    v_cvt_pk_bf16_f32 v99, v6, v7
    v_mul_f32 v8, s66, v8
    v_mul_f32 v9, s66, v9
    v_mul_f32 v10, s66, v10
    v_mul_f32 v11, s66, v11
    v_mul_f32 v12, s66, v12
    v_mul_f32 v13, s66, v13
    v_mul_f32 v14, s66, v14
    v_mul_f32 v15, s66, v15
    v_cvt_pk_bf16_f32 v100, v8, v9
    v_cvt_pk_bf16_f32 v101, v10, v11
    v_cvt_pk_bf16_f32 v102, v12, v13
    v_cvt_pk_bf16_f32 v103, v14, v15
    v_mul_f32 v16, s66, v16
    v_mul_f32 v17, s66, v17
    v_mul_f32 v18, s66, v18
    v_mul_f32 v19, s66, v19
    v_mul_f32 v20, s66, v20
    v_mul_f32 v21, s66, v21
    v_mul_f32 v22, s66, v22
    v_mul_f32 v23, s66, v23
    v_cvt_pk_bf16_f32 v104, v16, v17
    v_cvt_pk_bf16_f32 v105, v18, v19
    v_cvt_pk_bf16_f32 v106, v20, v21
    v_cvt_pk_bf16_f32 v107, v22, v23
    v_mul_f32 v24, s66, v24
    v_mul_f32 v25, s66, v25
    v_mul_f32 v26, s66, v26
    v_mul_f32 v27, s66, v27
    v_mul_f32 v28, s66, v28
    v_mul_f32 v29, s66, v29
    v_mul_f32 v30, s66, v30
    v_mul_f32 v31, s66, v31
    v_cvt_pk_bf16_f32 v108, v24, v25
    v_cvt_pk_bf16_f32 v109, v26, v27
    v_cvt_pk_bf16_f32 v110, v28, v29
    v_cvt_pk_bf16_f32 v111, v30, v31
    v_mul_f32 v32, s66, v32
    v_mul_f32 v33, s66, v33
    v_mul_f32 v34, s66, v34
    v_mul_f32 v35, s66, v35
    v_mul_f32 v36, s66, v36
    v_mul_f32 v37, s66, v37
    v_mul_f32 v38, s66, v38
    v_mul_f32 v39, s66, v39
    v_cvt_pk_bf16_f32 v112, v32, v33
    v_cvt_pk_bf16_f32 v113, v34, v35
    v_cvt_pk_bf16_f32 v114, v36, v37
    v_cvt_pk_bf16_f32 v115, v38, v39
    v_mul_f32 v40, s66, v40
    v_mul_f32 v41, s66, v41
    v_mul_f32 v42, s66, v42
    v_mul_f32 v43, s66, v43
    v_mul_f32 v44, s66, v44
    v_mul_f32 v45, s66, v45
    v_mul_f32 v46, s66, v46
    v_mul_f32 v47, s66, v47
    v_cvt_pk_bf16_f32 v116, v40, v41
    v_cvt_pk_bf16_f32 v117, v42, v43
    v_cvt_pk_bf16_f32 v118, v44, v45
    v_cvt_pk_bf16_f32 v119, v46, v47
    v_mul_f32 v48, s66, v48
    v_mul_f32 v49, s66, v49
    v_mul_f32 v50, s66, v50
    v_mul_f32 v51, s66, v51
    v_mul_f32 v52, s66, v52
    v_mul_f32 v53, s66, v53
    v_mul_f32 v54, s66, v54
    v_mul_f32 v55, s66, v55
    v_cvt_pk_bf16_f32 v120, v48, v49
    v_cvt_pk_bf16_f32 v121, v50, v51
    v_cvt_pk_bf16_f32 v122, v52, v53
    v_cvt_pk_bf16_f32 v123, v54, v55
    v_mul_f32 v56, s66, v56
    v_mul_f32 v57, s66, v57
    v_mul_f32 v58, s66, v58
    v_mul_f32 v59, s66, v59
    v_mul_f32 v60, s66, v60
    v_mul_f32 v61, s66, v61
    v_mul_f32 v62, s66, v62
    v_mul_f32 v63, s66, v63
    v_cvt_pk_bf16_f32 v124, v56, v57
    v_cvt_pk_bf16_f32 v125, v58, v59
    v_cvt_pk_bf16_f32 v126, v60, v61
    v_cvt_pk_bf16_f32 v127, v62, v63
    s_mov_b32 exec_lo, 0xffff0000
    s_mov_b32 exec_hi, 0xffff0000
    v_swap_b32 v96, v98
    v_swap_b32 v97, v99
    v_swap_b32 v100, v102
    v_swap_b32 v101, v103
    v_swap_b32 v104, v106
    v_swap_b32 v105, v107
    v_swap_b32 v108, v110
    v_swap_b32 v109, v111
    v_swap_b32 v112, v114
    v_swap_b32 v113, v115
    v_swap_b32 v116, v118
    v_swap_b32 v117, v119
    v_swap_b32 v120, v122
    v_swap_b32 v121, v123
    v_swap_b32 v124, v126
    v_swap_b32 v125, v127
    s_mov_b64 exec, -1
    s_waitcnt vmcnt(8)
    s_barrier
    s_lshl_b32 s61, s32, 4
    v_add_u32 v252, s61, v251
    ds_read_b128 v[128:131], v252 offset:36864
    s_lshl_b32 s61, s33, 4
    v_add_u32 v252, s61, v251
    ds_read_b128 v[132:135], v252 offset:36864
    s_lshl_b32 s61, s34, 4
    v_add_u32 v252, s61, v251
    ds_read_b128 v[136:139], v252 offset:36864
    s_lshl_b32 s61, s35, 4
    v_add_u32 v252, s61, v251
    ds_read_b128 v[140:143], v252 offset:36864
ATT_ENTRY:
    s_setprio 3
    ds_read_b128 v[196:199], v242 offset:32768
    ds_read_b128 v[200:203], v243 offset:32768
    ds_read_b128 v[204:207], v244 offset:32768
    ds_read_b128 v[208:211], v245 offset:32768
    ds_read_b128 v[212:215], v242 offset:33792
    ds_read_b128 v[216:219], v243 offset:33792
    ds_read_b128 v[220:223], v244 offset:33792
    v_mov_b32 v228, 0
    v_mov_b32 v229, 0
    v_mov_b32 v230, 0
    v_mov_b32 v231, 0
    v_mov_b32 v232, 0
    v_mov_b32 v233, 0
    s_cmp_eq_u32 s24, 0
    s_cbranch_scc1 VAR_1_t
    s_waitcnt lgkmcnt(6)
    v_mfma_f32_16x16x32_bf16 v[156:159], v[196:199], v[96:99], 0
    v_mfma_f32_16x16x32_bf16 v[164:167], v[196:199], v[112:115], 0
    ds_read_b128 v[224:227], v245 offset:33792
    s_waitcnt lgkmcnt(6)
    v_mfma_f32_16x16x32_bf16 v[156:159], v[200:203], v[100:103], v[156:159]
    v_mfma_f32_16x16x32_bf16 v[164:167], v[200:203], v[116:119], v[164:167]
    s_waitcnt lgkmcnt(5)
    v_mfma_f32_16x16x32_bf16 v[156:159], v[204:207], v[104:107], v[156:159]
    v_mfma_f32_16x16x32_bf16 v[164:167], v[204:207], v[120:123], v[164:167]
    s_waitcnt lgkmcnt(4)
    v_mfma_f32_16x16x32_bf16 v[156:159], v[208:211], v[108:111], v[156:159]
    v_mfma_f32_16x16x32_bf16 v[164:167], v[208:211], v[124:127], v[164:167]
    s_waitcnt vmcnt(4) lgkmcnt(0)
    s_barrier
    ds_read_b128 v[196:199], v242
    ds_read_b128 v[200:203], v243
    ds_read_b128 v[204:207], v244
    v_mfma_f32_16x16x32_bf16 v[160:163], v[212:215], v[96:99], 0
    s_add_u32 m0, s25, 57344
    s_nop 0
    buffer_load_dwordx4 v246, s[8:11], s26 offen nt lds
    v_mfma_f32_16x16x32_bf16 v[168:171], v[212:215], v[112:115], 0
    buffer_load_dwordx4 v246, s[8:11], s26 offen offset:1024 nt lds
    s_add_u32 s26, s26, 8192
    ds_read_b128 v[208:211], v245
    v_mfma_f32_16x16x32_bf16 v[160:163], v[216:219], v[100:103], v[160:163]
    s_add_u32 m0, s25, 16384
    s_nop 0
    buffer_load_dwordx4 v247, s[12:15], s27 offen nt lds
    v_mfma_f32_16x16x32_bf16 v[168:171], v[216:219], v[116:119], v[168:171]
    buffer_load_dwordx4 v247, s[12:15], s27 offen offset:1024 nt lds
    s_add_u32 s27, s27, 8192
    ds_read_b128 v[212:215], v242 offset:1024
    v_mfma_f32_16x16x32_bf16 v[160:163], v[220:223], v[104:107], v[160:163]
    v_mfma_f32_16x16x32_bf16 v[168:171], v[220:223], v[120:123], v[168:171]
    ds_read_b128 v[216:219], v243 offset:1024
    v_mfma_f32_16x16x32_bf16 v[160:163], v[224:227], v[108:111], v[160:163]
    v_mfma_f32_16x16x32_bf16 v[168:171], v[224:227], v[124:127], v[168:171]
    ds_read_b128 v[220:223], v244 offset:1024
VAR_1_j:
    v_max3_f32 v253, v156, v157, v158
    s_nop 4
    v_max3_f32 v253, v253, v159, v160
    v_max3_f32 v253, v253, v161, v162
    v_max_f32 v253, v253, v163
    v_mov_b32 v254, v253
    s_nop 1
    v_permlane16_swap_b32 v253, v254
    v_max_f32 v253, v253, v254
    v_mov_b32 v254, v253
    s_nop 1
    v_permlane32_swap_b32 v253, v254
    v_max_f32 v253, v253, v254
    s_cmp_eq_u32 s63, 1
    s_cbranch_scc1 SKIPM_2
    v_sub_f32 v144, 0, v253
    v_sub_f32 v145, 0, v253
    v_sub_f32 v146, 0, v253
    v_sub_f32 v147, 0, v253
SKIPM_2:
    v_add_f32 v156, v156, v144
    v_add_f32 v157, v157, v144
    v_add_f32 v158, v158, v144
    v_add_f32 v159, v159, v144
    v_add_f32 v160, v160, v144
    v_add_f32 v161, v161, v144
    v_add_f32 v162, v162, v144
    v_add_f32 v163, v163, v144
    v_max3_f32 v253, v164, v165, v166
    v_max3_f32 v253, v253, v167, v168
    v_max3_f32 v253, v253, v169, v170
    v_max_f32 v253, v253, v171
    v_mov_b32 v254, v253
    s_nop 1
    v_permlane16_swap_b32 v253, v254
    v_max_f32 v253, v253, v254
    v_mov_b32 v254, v253
    s_nop 1
    v_permlane32_swap_b32 v253, v254
    v_max_f32 v253, v253, v254
    s_cmp_eq_u32 s63, 1
    s_cbranch_scc1 SKIPM_3
    v_sub_f32 v148, 0, v253
    v_sub_f32 v149, 0, v253
    v_sub_f32 v150, 0, v253
    v_sub_f32 v151, 0, v253
SKIPM_3:
    v_add_f32 v164, v164, v148
    v_add_f32 v165, v165, v148
    v_add_f32 v166, v166, v148
    v_add_f32 v167, v167, v148
    v_add_f32 v168, v168, v148
    v_add_f32 v169, v169, v148
    v_add_f32 v170, v170, v148
    v_add_f32 v171, v171, v148
    v_exp_f32 v156, v156
    v_exp_f32 v164, v164
    v_exp_f32 v157, v157
    v_exp_f32 v165, v165
    v_add_f32 v228, v228, v156
    v_add_f32 v230, v230, v164
    v_exp_f32 v158, v158
    v_exp_f32 v166, v166
    v_add_f32 v229, v229, v157
    v_add_f32 v231, v231, v165
    v_exp_f32 v159, v159
    v_exp_f32 v167, v167
    v_cvt_pk_bf16_f32 v156, v156, v157
    v_cvt_pk_bf16_f32 v164, v164, v165
    v_add_f32 v228, v228, v158
    v_add_f32 v230, v230, v166
    v_add_f32 v229, v229, v159
    v_add_f32 v231, v231, v167
    v_cvt_pk_bf16_f32 v157, v158, v159
    v_cvt_pk_bf16_f32 v165, v166, v167
    s_cmp_eq_u32 s24, 0
    s_cbranch_scc1 VAR_4_t
VAR_4_j:
    s_cmp_eq_u32 s24, 1
    s_cbranch_scc1 VAR_6_t
    s_waitcnt lgkmcnt(6)
    v_mfma_f32_16x16x32_bf16 v[172:175], v[196:199], v[96:99], v[144:147]
    v_exp_f32 v160, v160
    v_mfma_f32_16x16x32_bf16 v[180:183], v[196:199], v[112:115], v[148:151]
    ds_read_b128 v[224:227], v245 offset:1024
    v_exp_f32 v168, v168
    s_waitcnt lgkmcnt(6)
    v_mfma_f32_16x16x32_bf16 v[172:175], v[200:203], v[100:103], v[172:175]
    v_exp_f32 v161, v161
    v_mfma_f32_16x16x32_bf16 v[180:183], v[200:203], v[116:119], v[180:183]
    ds_read_b64_tr_b16 v[196:197], v234
    ds_read_b64_tr_b16 v[198:199], v234 offset:1024
    v_exp_f32 v169, v169
    s_waitcnt lgkmcnt(7)
    v_mfma_f32_16x16x32_bf16 v[172:175], v[204:207], v[104:107], v[172:175]
    v_add_f32 v228, v228, v160
    v_mfma_f32_16x16x32_bf16 v[180:183], v[204:207], v[120:123], v[180:183]
    ds_read_b64_tr_b16 v[200:201], v235
    ds_read_b64_tr_b16 v[202:203], v235 offset:1024
    v_add_f32 v230, v230, v168
    s_waitcnt lgkmcnt(8)
    v_mfma_f32_16x16x32_bf16 v[172:175], v[208:211], v[108:111], v[172:175]
    v_exp_f32 v162, v162
    v_mfma_f32_16x16x32_bf16 v[180:183], v[208:211], v[124:127], v[180:183]
    ds_read_b64_tr_b16 v[204:205], v236
    ds_read_b64_tr_b16 v[206:207], v236 offset:1024
    v_exp_f32 v170, v170
    s_waitcnt lgkmcnt(9)
    v_mfma_f32_16x16x32_bf16 v[176:179], v[212:215], v[96:99], v[144:147]
    v_add_f32 v229, v229, v161
    v_add_f32 v231, v231, v169
    v_mfma_f32_16x16x32_bf16 v[184:187], v[212:215], v[112:115], v[148:151]
    ds_read_b64_tr_b16 v[208:209], v237
    ds_read_b64_tr_b16 v[210:211], v237 offset:1024
    v_exp_f32 v163, v163
    s_waitcnt lgkmcnt(10)
    v_mfma_f32_16x16x32_bf16 v[176:179], v[216:219], v[100:103], v[176:179]
    v_exp_f32 v171, v171
    v_mfma_f32_16x16x32_bf16 v[184:187], v[216:219], v[116:119], v[184:187]
    ds_read_b64_tr_b16 v[212:213], v238
    ds_read_b64_tr_b16 v[214:215], v238 offset:1024
    v_cvt_pk_bf16_f32 v158, v160, v161
    s_waitcnt lgkmcnt(11)
    v_mfma_f32_16x16x32_bf16 v[176:179], v[220:223], v[104:107], v[176:179]
    v_cvt_pk_bf16_f32 v166, v168, v169
    v_add_f32 v228, v228, v162
    v_mfma_f32_16x16x32_bf16 v[184:187], v[220:223], v[120:123], v[184:187]
    ds_read_b64_tr_b16 v[216:217], v239
    ds_read_b64_tr_b16 v[218:219], v239 offset:1024
    v_add_f32 v230, v230, v170
    v_add_f32 v229, v229, v163
    s_waitcnt lgkmcnt(12)
    v_mfma_f32_16x16x32_bf16 v[176:179], v[224:227], v[108:111], v[176:179]
    v_add_f32 v231, v231, v171
    v_mfma_f32_16x16x32_bf16 v[184:187], v[224:227], v[124:127], v[184:187]
    ds_read_b64_tr_b16 v[220:221], v240
    ds_read_b64_tr_b16 v[222:223], v240 offset:1024
    v_cvt_pk_bf16_f32 v159, v162, v163
    v_cvt_pk_bf16_f32 v167, v170, v171
VAR_6_j:
    s_cmp_eq_u32 s24, 0
    s_cbranch_scc1 VAR_7_t
    s_waitcnt lgkmcnt(12)
    v_mfma_f32_16x16x32_bf16 v[0:3], v[196:199], v[156:159], 0
    v_exp_f32 v172, v172
    v_mfma_f32_16x16x32_bf16 v[32:35], v[196:199], v[164:167], 0
    ds_read_b64_tr_b16 v[224:225], v241
    ds_read_b64_tr_b16 v[226:227], v241 offset:1024
    v_exp_f32 v180, v180
    s_waitcnt lgkmcnt(12)
    v_mfma_f32_16x16x32_bf16 v[4:7], v[200:203], v[156:159], 0
    v_exp_f32 v173, v173
    v_mfma_f32_16x16x32_bf16 v[36:39], v[200:203], v[164:167], 0
    v_exp_f32 v181, v181
    s_waitcnt lgkmcnt(10)
    v_mfma_f32_16x16x32_bf16 v[8:11], v[204:207], v[156:159], 0
    v_add_f32 v228, v228, v172
    v_mfma_f32_16x16x32_bf16 v[40:43], v[204:207], v[164:167], 0
    v_add_f32 v230, v230, v180
    s_waitcnt lgkmcnt(8)
    v_mfma_f32_16x16x32_bf16 v[12:15], v[208:211], v[156:159], 0
    v_exp_f32 v174, v174
    v_mfma_f32_16x16x32_bf16 v[44:47], v[208:211], v[164:167], 0
    s_waitcnt vmcnt(4) lgkmcnt(0)
    s_barrier
    ds_read_b128 v[196:199], v242 offset:8192
    ds_read_b128 v[200:203], v243 offset:8192
    ds_read_b128 v[204:207], v244 offset:8192
    v_exp_f32 v182, v182
    v_mfma_f32_16x16x32_bf16 v[16:19], v[212:215], v[156:159], 0
    s_add_u32 m0, s25, 65536
    s_nop 0
    buffer_load_dwordx4 v246, s[8:11], s26 offen nt lds
    v_add_f32 v229, v229, v173
    v_add_f32 v231, v231, v181
    v_mfma_f32_16x16x32_bf16 v[48:51], v[212:215], v[164:167], 0
    buffer_load_dwordx4 v246, s[8:11], s26 offen offset:1024 nt lds
    s_add_u32 s26, s26, 8192
    ds_read_b128 v[208:211], v245 offset:8192
    v_exp_f32 v175, v175
    v_mfma_f32_16x16x32_bf16 v[20:23], v[216:219], v[156:159], 0
    s_add_u32 m0, s25, 24576
    s_nop 0
    buffer_load_dwordx4 v247, s[12:15], s27 offen nt lds
    v_exp_f32 v183, v183
    v_mfma_f32_16x16x32_bf16 v[52:55], v[216:219], v[164:167], 0
    buffer_load_dwordx4 v247, s[12:15], s27 offen offset:1024 nt lds
    s_add_u32 s27, s27, 8192
    ds_read_b128 v[212:215], v242 offset:9216
    v_cvt_pk_bf16_f32 v172, v172, v173
    v_mfma_f32_16x16x32_bf16 v[24:27], v[220:223], v[156:159], 0
    v_cvt_pk_bf16_f32 v180, v180, v181
    v_add_f32 v228, v228, v174
    v_mfma_f32_16x16x32_bf16 v[56:59], v[220:223], v[164:167], 0
    ds_read_b128 v[216:219], v243 offset:9216
    v_add_f32 v230, v230, v182
    v_add_f32 v229, v229, v175
    v_mfma_f32_16x16x32_bf16 v[28:31], v[224:227], v[156:159], 0
    v_add_f32 v231, v231, v183
    v_mfma_f32_16x16x32_bf16 v[60:63], v[224:227], v[164:167], 0
    ds_read_b128 v[220:223], v244 offset:9216
    v_cvt_pk_bf16_f32 v173, v174, v175
    v_cvt_pk_bf16_f32 v181, v182, v183
VAR_7_j:
    s_cmp_eq_u32 s24, 1
    s_cbranch_scc1 VAR_8_t
VAR_8_j:
    s_cmp_eq_u32 s24, 2
    s_cbranch_scc1 VAR_10_t
    s_waitcnt lgkmcnt(6)
    v_mfma_f32_16x16x32_bf16 v[156:159], v[196:199], v[96:99], v[144:147]
    v_exp_f32 v176, v176
    v_mfma_f32_16x16x32_bf16 v[164:167], v[196:199], v[112:115], v[148:151]
    ds_read_b128 v[224:227], v245 offset:9216
    v_exp_f32 v184, v184
    s_waitcnt lgkmcnt(6)
    v_mfma_f32_16x16x32_bf16 v[156:159], v[200:203], v[100:103], v[156:159]
    v_exp_f32 v177, v177
    v_mfma_f32_16x16x32_bf16 v[164:167], v[200:203], v[116:119], v[164:167]
    ds_read_b64_tr_b16 v[196:197], v234 offset:8192
    ds_read_b64_tr_b16 v[198:199], v234 offset:9216
    v_exp_f32 v185, v185
    s_waitcnt lgkmcnt(7)
    v_mfma_f32_16x16x32_bf16 v[156:159], v[204:207], v[104:107], v[156:159]
    v_add_f32 v228, v228, v176
    v_mfma_f32_16x16x32_bf16 v[164:167], v[204:207], v[120:123], v[164:167]
    ds_read_b64_tr_b16 v[200:201], v235 offset:8192
    ds_read_b64_tr_b16 v[202:203], v235 offset:9216
    v_add_f32 v230, v230, v184
    s_waitcnt lgkmcnt(8)
    v_mfma_f32_16x16x32_bf16 v[156:159], v[208:211], v[108:111], v[156:159]
    v_exp_f32 v178, v178
    v_mfma_f32_16x16x32_bf16 v[164:167], v[208:211], v[124:127], v[164:167]
    ds_read_b64_tr_b16 v[204:205], v236 offset:8192
    ds_read_b64_tr_b16 v[206:207], v236 offset:9216
    v_exp_f32 v186, v186
    s_waitcnt lgkmcnt(9)
    v_mfma_f32_16x16x32_bf16 v[160:163], v[212:215], v[96:99], v[144:147]
    v_add_f32 v229, v229, v177
    v_add_f32 v231, v231, v185
    v_mfma_f32_16x16x32_bf16 v[168:171], v[212:215], v[112:115], v[148:151]
    ds_read_b64_tr_b16 v[208:209], v237 offset:8192
    ds_read_b64_tr_b16 v[210:211], v237 offset:9216
    v_exp_f32 v179, v179
    s_waitcnt lgkmcnt(10)
    v_mfma_f32_16x16x32_bf16 v[160:163], v[216:219], v[100:103], v[160:163]
    v_exp_f32 v187, v187
    v_mfma_f32_16x16x32_bf16 v[168:171], v[216:219], v[116:119], v[168:171]
    ds_read_b64_tr_b16 v[212:213], v238 offset:8192
    ds_read_b64_tr_b16 v[214:215], v238 offset:9216
    v_cvt_pk_bf16_f32 v174, v176, v177
    s_waitcnt lgkmcnt(11)
    v_mfma_f32_16x16x32_bf16 v[160:163], v[220:223], v[104:107], v[160:163]
    v_cvt_pk_bf16_f32 v182, v184, v185
    v_add_f32 v228, v228, v178
    v_mfma_f32_16x16x32_bf16 v[168:171], v[220:223], v[120:123], v[168:171]
    ds_read_b64_tr_b16 v[216:217], v239 offset:8192
    ds_read_b64_tr_b16 v[218:219], v239 offset:9216
    v_add_f32 v230, v230, v186
    v_add_f32 v229, v229, v179
    s_waitcnt lgkmcnt(12)
    v_mfma_f32_16x16x32_bf16 v[160:163], v[224:227], v[108:111], v[160:163]
    v_add_f32 v231, v231, v187
    v_mfma_f32_16x16x32_bf16 v[168:171], v[224:227], v[124:127], v[168:171]
    ds_read_b64_tr_b16 v[220:221], v240 offset:8192
    ds_read_b64_tr_b16 v[222:223], v240 offset:9216
    v_cvt_pk_bf16_f32 v175, v178, v179
    v_cvt_pk_bf16_f32 v183, v186, v187
VAR_10_j:
    s_cmp_eq_u32 s24, 1
    s_cbranch_scc1 VAR_11_t
    s_waitcnt lgkmcnt(12)
    v_mfma_f32_16x16x32_bf16 v[0:3], v[196:199], v[172:175], v[0:3]
    v_exp_f32 v156, v156
    v_mfma_f32_16x16x32_bf16 v[32:35], v[196:199], v[180:183], v[32:35]
    ds_read_b64_tr_b16 v[224:225], v241 offset:8192
    ds_read_b64_tr_b16 v[226:227], v241 offset:9216
    v_exp_f32 v164, v164
    s_waitcnt lgkmcnt(12)
    v_mfma_f32_16x16x32_bf16 v[4:7], v[200:203], v[172:175], v[4:7]
    v_exp_f32 v157, v157
    v_mfma_f32_16x16x32_bf16 v[36:39], v[200:203], v[180:183], v[36:39]
    v_exp_f32 v165, v165
    s_waitcnt lgkmcnt(10)
    v_mfma_f32_16x16x32_bf16 v[8:11], v[204:207], v[172:175], v[8:11]
    v_add_f32 v228, v228, v156
    v_mfma_f32_16x16x32_bf16 v[40:43], v[204:207], v[180:183], v[40:43]
    v_add_f32 v230, v230, v164
    s_waitcnt lgkmcnt(8)
    v_mfma_f32_16x16x32_bf16 v[12:15], v[208:211], v[172:175], v[12:15]
    v_exp_f32 v158, v158
    v_mfma_f32_16x16x32_bf16 v[44:47], v[208:211], v[180:183], v[44:47]
    s_waitcnt vmcnt(4) lgkmcnt(0)
    s_barrier
    ds_read_b128 v[196:199], v242 offset:16384
    ds_read_b128 v[200:203], v243 offset:16384
    ds_read_b128 v[204:207], v244 offset:16384
    v_exp_f32 v166, v166
    v_mfma_f32_16x16x32_bf16 v[16:19], v[212:215], v[172:175], v[16:19]
    s_add_u32 m0, s25, 73728
    s_nop 0
    buffer_load_dwordx4 v246, s[8:11], s26 offen nt lds
    v_add_f32 v229, v229, v157
    v_add_f32 v231, v231, v165
    v_mfma_f32_16x16x32_bf16 v[48:51], v[212:215], v[180:183], v[48:51]
    buffer_load_dwordx4 v246, s[8:11], s26 offen offset:1024 nt lds
    s_add_u32 s26, s26, 8192
    ds_read_b128 v[208:211], v245 offset:16384
    v_exp_f32 v159, v159
    v_mfma_f32_16x16x32_bf16 v[20:23], v[216:219], v[172:175], v[20:23]
    s_add_u32 m0, s25, 32768
    s_nop 0
    buffer_load_dwordx4 v247, s[12:15], s27 offen nt lds
    v_exp_f32 v167, v167
    v_mfma_f32_16x16x32_bf16 v[52:55], v[216:219], v[180:183], v[52:55]
    buffer_load_dwordx4 v247, s[12:15], s27 offen offset:1024 nt lds
    s_add_u32 s27, s27, 8192
    ds_read_b128 v[212:215], v242 offset:17408
    v_cvt_pk_bf16_f32 v156, v156, v157
    v_mfma_f32_16x16x32_bf16 v[24:27], v[220:223], v[172:175], v[24:27]
    v_cvt_pk_bf16_f32 v164, v164, v165
    v_add_f32 v228, v228, v158
    v_mfma_f32_16x16x32_bf16 v[56:59], v[220:223], v[180:183], v[56:59]
    ds_read_b128 v[216:219], v243 offset:17408
    v_add_f32 v230, v230, v166
    v_add_f32 v229, v229, v159
    v_mfma_f32_16x16x32_bf16 v[28:31], v[224:227], v[172:175], v[28:31]
    v_add_f32 v231, v231, v167
    v_mfma_f32_16x16x32_bf16 v[60:63], v[224:227], v[180:183], v[60:63]
    ds_read_b128 v[220:223], v244 offset:17408
    v_cvt_pk_bf16_f32 v157, v158, v159
    v_cvt_pk_bf16_f32 v165, v166, v167
VAR_11_j:
    s_cmp_eq_u32 s24, 2
    s_cbranch_scc1 VAR_12_t
VAR_12_j:
    s_cmp_eq_u32 s24, 3
    s_cbranch_scc1 VAR_14_t
    s_waitcnt lgkmcnt(6)
    v_mfma_f32_16x16x32_bf16 v[172:175], v[196:199], v[96:99], v[144:147]
    v_exp_f32 v160, v160
    v_mfma_f32_16x16x32_bf16 v[180:183], v[196:199], v[112:115], v[148:151]
    ds_read_b128 v[224:227], v245 offset:17408
    v_exp_f32 v168, v168
    s_waitcnt lgkmcnt(6)
    v_mfma_f32_16x16x32_bf16 v[172:175], v[200:203], v[100:103], v[172:175]
    v_exp_f32 v161, v161
    v_mfma_f32_16x16x32_bf16 v[180:183], v[200:203], v[116:119], v[180:183]
    ds_read_b64_tr_b16 v[196:197], v234 offset:16384
    ds_read_b64_tr_b16 v[198:199], v234 offset:17408
    v_exp_f32 v169, v169
    s_waitcnt lgkmcnt(7)
    v_mfma_f32_16x16x32_bf16 v[172:175], v[204:207], v[104:107], v[172:175]
    v_add_f32 v228, v228, v160
    v_mfma_f32_16x16x32_bf16 v[180:183], v[204:207], v[120:123], v[180:183]
    ds_read_b64_tr_b16 v[200:201], v235 offset:16384
    ds_read_b64_tr_b16 v[202:203], v235 offset:17408
    v_add_f32 v230, v230, v168
    s_waitcnt lgkmcnt(8)
    v_mfma_f32_16x16x32_bf16 v[172:175], v[208:211], v[108:111], v[172:175]
    v_exp_f32 v162, v162
    v_mfma_f32_16x16x32_bf16 v[180:183], v[208:211], v[124:127], v[180:183]
    ds_read_b64_tr_b16 v[204:205], v236 offset:16384
    ds_read_b64_tr_b16 v[206:207], v236 offset:17408
    v_exp_f32 v170, v170
    s_waitcnt lgkmcnt(9)
    v_mfma_f32_16x16x32_bf16 v[176:179], v[212:215], v[96:99], v[144:147]
    v_add_f32 v229, v229, v161
    v_add_f32 v231, v231, v169
    v_mfma_f32_16x16x32_bf16 v[184:187], v[212:215], v[112:115], v[148:151]
    ds_read_b64_tr_b16 v[208:209], v237 offset:16384
    ds_read_b64_tr_b16 v[210:211], v237 offset:17408
    v_exp_f32 v163, v163
    s_waitcnt lgkmcnt(10)
    v_mfma_f32_16x16x32_bf16 v[176:179], v[216:219], v[100:103], v[176:179]
    v_exp_f32 v171, v171
    v_mfma_f32_16x16x32_bf16 v[184:187], v[216:219], v[116:119], v[184:187]
    ds_read_b64_tr_b16 v[212:213], v238 offset:16384
    ds_read_b64_tr_b16 v[214:215], v238 offset:17408
    v_cvt_pk_bf16_f32 v158, v160, v161
    s_waitcnt lgkmcnt(11)
    v_mfma_f32_16x16x32_bf16 v[176:179], v[220:223], v[104:107], v[176:179]
    v_cvt_pk_bf16_f32 v166, v168, v169
    v_add_f32 v228, v228, v162
    v_mfma_f32_16x16x32_bf16 v[184:187], v[220:223], v[120:123], v[184:187]
    ds_read_b64_tr_b16 v[216:217], v239 offset:16384
    ds_read_b64_tr_b16 v[218:219], v239 offset:17408
    v_add_f32 v230, v230, v170
    v_add_f32 v229, v229, v163
    s_waitcnt lgkmcnt(12)
    v_mfma_f32_16x16x32_bf16 v[176:179], v[224:227], v[108:111], v[176:179]
    v_add_f32 v231, v231, v171
    v_mfma_f32_16x16x32_bf16 v[184:187], v[224:227], v[124:127], v[184:187]
    ds_read_b64_tr_b16 v[220:221], v240 offset:16384
    ds_read_b64_tr_b16 v[222:223], v240 offset:17408
    v_cvt_pk_bf16_f32 v159, v162, v163
    v_cvt_pk_bf16_f32 v167, v170, v171
VAR_14_j:
    s_cmp_eq_u32 s24, 2
    s_cbranch_scc1 VAR_15_t
    s_waitcnt lgkmcnt(12)
    v_mfma_f32_16x16x32_bf16 v[0:3], v[196:199], v[156:159], v[0:3]
    v_exp_f32 v172, v172
    v_mfma_f32_16x16x32_bf16 v[32:35], v[196:199], v[164:167], v[32:35]
    ds_read_b64_tr_b16 v[224:225], v241 offset:16384
    ds_read_b64_tr_b16 v[226:227], v241 offset:17408
    v_exp_f32 v180, v180
    s_waitcnt lgkmcnt(12)
    v_mfma_f32_16x16x32_bf16 v[4:7], v[200:203], v[156:159], v[4:7]
    v_exp_f32 v173, v173
    v_mfma_f32_16x16x32_bf16 v[36:39], v[200:203], v[164:167], v[36:39]
    v_exp_f32 v181, v181
    s_waitcnt lgkmcnt(10)
    v_mfma_f32_16x16x32_bf16 v[8:11], v[204:207], v[156:159], v[8:11]
    v_add_f32 v228, v228, v172
    v_mfma_f32_16x16x32_bf16 v[40:43], v[204:207], v[164:167], v[40:43]
    v_add_f32 v230, v230, v180
    s_waitcnt lgkmcnt(8)
    v_mfma_f32_16x16x32_bf16 v[12:15], v[208:211], v[156:159], v[12:15]
    v_exp_f32 v174, v174
    v_mfma_f32_16x16x32_bf16 v[44:47], v[208:211], v[164:167], v[44:47]
    s_waitcnt vmcnt(4) lgkmcnt(0)
    s_barrier
    ds_read_b128 v[196:199], v242 offset:24576
    ds_read_b128 v[200:203], v243 offset:24576
    ds_read_b128 v[204:207], v244 offset:24576
    v_exp_f32 v182, v182
    v_mfma_f32_16x16x32_bf16 v[16:19], v[212:215], v[156:159], v[16:19]
    s_add_u32 m0, s25, 40960
    s_nop 0
    buffer_load_dwordx4 v246, s[8:11], s26 offen nt lds
    v_add_f32 v229, v229, v173
    v_add_f32 v231, v231, v181
    v_mfma_f32_16x16x32_bf16 v[48:51], v[212:215], v[164:167], v[48:51]
    buffer_load_dwordx4 v246, s[8:11], s26 offen offset:1024 nt lds
    s_add_u32 s26, s26, 8192
    ds_read_b128 v[208:211], v245 offset:24576
    v_exp_f32 v175, v175
    v_mfma_f32_16x16x32_bf16 v[20:23], v[216:219], v[156:159], v[20:23]
    s_add_u32 m0, s25, 0
    s_nop 0
    buffer_load_dwordx4 v247, s[12:15], s27 offen nt lds
    v_exp_f32 v183, v183
    v_mfma_f32_16x16x32_bf16 v[52:55], v[216:219], v[164:167], v[52:55]
    buffer_load_dwordx4 v247, s[12:15], s27 offen offset:1024 nt lds
    s_add_u32 s27, s27, 8192
    ds_read_b128 v[212:215], v242 offset:25600
    v_cvt_pk_bf16_f32 v172, v172, v173
    v_mfma_f32_16x16x32_bf16 v[24:27], v[220:223], v[156:159], v[24:27]
    v_cvt_pk_bf16_f32 v180, v180, v181
    v_add_f32 v228, v228, v174
    v_mfma_f32_16x16x32_bf16 v[56:59], v[220:223], v[164:167], v[56:59]
    ds_read_b128 v[216:219], v243 offset:25600
    v_add_f32 v230, v230, v182
    v_add_f32 v229, v229, v175
    v_mfma_f32_16x16x32_bf16 v[28:31], v[224:227], v[156:159], v[28:31]
    v_add_f32 v231, v231, v183
    v_mfma_f32_16x16x32_bf16 v[60:63], v[224:227], v[164:167], v[60:63]
    ds_read_b128 v[220:223], v244 offset:25600
    v_cvt_pk_bf16_f32 v173, v174, v175
    v_cvt_pk_bf16_f32 v181, v182, v183
VAR_15_j:
    s_cmp_eq_u32 s24, 3
    s_cbranch_scc1 VAR_16_t
VAR_16_j:
    s_cmp_eq_u32 s24, 0
    s_cbranch_scc1 VAR_18_t
    s_waitcnt lgkmcnt(6)
    v_mfma_f32_16x16x32_bf16 v[156:159], v[196:199], v[96:99], v[144:147]
    v_exp_f32 v176, v176
    v_mfma_f32_16x16x32_bf16 v[164:167], v[196:199], v[112:115], v[148:151]
    ds_read_b128 v[224:227], v245 offset:25600
    v_exp_f32 v184, v184
    s_waitcnt lgkmcnt(6)
    v_mfma_f32_16x16x32_bf16 v[156:159], v[200:203], v[100:103], v[156:159]
    v_exp_f32 v177, v177
    v_mfma_f32_16x16x32_bf16 v[164:167], v[200:203], v[116:119], v[164:167]
    ds_read_b64_tr_b16 v[196:197], v234 offset:24576
    ds_read_b64_tr_b16 v[198:199], v234 offset:25600
    v_exp_f32 v185, v185
    s_waitcnt lgkmcnt(7)
    v_mfma_f32_16x16x32_bf16 v[156:159], v[204:207], v[104:107], v[156:159]
    v_add_f32 v228, v228, v176
    v_mfma_f32_16x16x32_bf16 v[164:167], v[204:207], v[120:123], v[164:167]
    ds_read_b64_tr_b16 v[200:201], v235 offset:24576
    ds_read_b64_tr_b16 v[202:203], v235 offset:25600
    v_add_f32 v230, v230, v184
    s_waitcnt lgkmcnt(8)
    v_mfma_f32_16x16x32_bf16 v[156:159], v[208:211], v[108:111], v[156:159]
    v_exp_f32 v178, v178
    v_mfma_f32_16x16x32_bf16 v[164:167], v[208:211], v[124:127], v[164:167]
    ds_read_b64_tr_b16 v[204:205], v236 offset:24576
    ds_read_b64_tr_b16 v[206:207], v236 offset:25600
    v_exp_f32 v186, v186
    s_waitcnt lgkmcnt(9)
    v_mfma_f32_16x16x32_bf16 v[160:163], v[212:215], v[96:99], v[144:147]
    v_add_f32 v229, v229, v177
    v_add_f32 v231, v231, v185
    v_mfma_f32_16x16x32_bf16 v[168:171], v[212:215], v[112:115], v[148:151]
    ds_read_b64_tr_b16 v[208:209], v237 offset:24576
    ds_read_b64_tr_b16 v[210:211], v237 offset:25600
    v_exp_f32 v179, v179
    s_waitcnt lgkmcnt(10)
    v_mfma_f32_16x16x32_bf16 v[160:163], v[216:219], v[100:103], v[160:163]
    v_exp_f32 v187, v187
    v_mfma_f32_16x16x32_bf16 v[168:171], v[216:219], v[116:119], v[168:171]
    ds_read_b64_tr_b16 v[212:213], v238 offset:24576
    ds_read_b64_tr_b16 v[214:215], v238 offset:25600
    v_cvt_pk_bf16_f32 v174, v176, v177
    s_waitcnt lgkmcnt(11)
    v_mfma_f32_16x16x32_bf16 v[160:163], v[220:223], v[104:107], v[160:163]
    v_cvt_pk_bf16_f32 v182, v184, v185
    v_add_f32 v228, v228, v178
    v_mfma_f32_16x16x32_bf16 v[168:171], v[220:223], v[120:123], v[168:171]
    ds_read_b64_tr_b16 v[216:217], v239 offset:24576
    ds_read_b64_tr_b16 v[218:219], v239 offset:25600
    v_add_f32 v230, v230, v186
    v_add_f32 v229, v229, v179
    s_waitcnt lgkmcnt(12)
    v_mfma_f32_16x16x32_bf16 v[160:163], v[224:227], v[108:111], v[160:163]
    v_add_f32 v231, v231, v187
    v_mfma_f32_16x16x32_bf16 v[168:171], v[224:227], v[124:127], v[168:171]
    ds_read_b64_tr_b16 v[220:221], v240 offset:24576
    ds_read_b64_tr_b16 v[222:223], v240 offset:25600
    v_cvt_pk_bf16_f32 v175, v178, v179
    v_cvt_pk_bf16_f32 v183, v186, v187
VAR_18_j:
    s_cmp_eq_u32 s24, 3
    s_cbranch_scc1 VAR_19_t
    s_waitcnt lgkmcnt(12)
    v_mfma_f32_16x16x32_bf16 v[0:3], v[196:199], v[172:175], v[0:3]
    v_exp_f32 v156, v156
    v_mfma_f32_16x16x32_bf16 v[32:35], v[196:199], v[180:183], v[32:35]
    ds_read_b64_tr_b16 v[224:225], v241 offset:24576
    ds_read_b64_tr_b16 v[226:227], v241 offset:25600
    v_exp_f32 v164, v164
    s_waitcnt lgkmcnt(12)
    v_mfma_f32_16x16x32_bf16 v[4:7], v[200:203], v[172:175], v[4:7]
    v_exp_f32 v157, v157
    v_mfma_f32_16x16x32_bf16 v[36:39], v[200:203], v[180:183], v[36:39]
    v_exp_f32 v165, v165
    s_waitcnt lgkmcnt(10)
    v_mfma_f32_16x16x32_bf16 v[8:11], v[204:207], v[172:175], v[8:11]
    v_add_f32 v228, v228, v156
    v_mfma_f32_16x16x32_bf16 v[40:43], v[204:207], v[180:183], v[40:43]
    v_add_f32 v230, v230, v164
    s_waitcnt lgkmcnt(8)
    v_mfma_f32_16x16x32_bf16 v[12:15], v[208:211], v[172:175], v[12:15]
    v_exp_f32 v158, v158
    v_mfma_f32_16x16x32_bf16 v[44:47], v[208:211], v[180:183], v[44:47]
    s_waitcnt vmcnt(4) lgkmcnt(0)
    s_barrier
    ds_read_b128 v[196:199], v242 offset:32768
    ds_read_b128 v[200:203], v243 offset:32768
    ds_read_b128 v[204:207], v244 offset:32768
    v_exp_f32 v166, v166
    v_mfma_f32_16x16x32_bf16 v[16:19], v[212:215], v[172:175], v[16:19]
    s_add_u32 m0, s25, 49152
    s_nop 0
    buffer_load_dwordx4 v246, s[8:11], s26 offen nt lds
    v_add_f32 v229, v229, v157
    v_add_f32 v231, v231, v165
    v_mfma_f32_16x16x32_bf16 v[48:51], v[212:215], v[180:183], v[48:51]
    buffer_load_dwordx4 v246, s[8:11], s26 offen offset:1024 nt lds
    s_add_u32 s26, s26, 8192
    ds_read_b128 v[208:211], v245 offset:32768
    v_exp_f32 v159, v159
    v_mfma_f32_16x16x32_bf16 v[20:23], v[216:219], v[172:175], v[20:23]
    s_add_u32 m0, s25, 8192
    s_nop 0
    buffer_load_dwordx4 v247, s[12:15], s27 offen nt lds
    v_exp_f32 v167, v167
    v_mfma_f32_16x16x32_bf16 v[52:55], v[216:219], v[180:183], v[52:55]
    buffer_load_dwordx4 v247, s[12:15], s27 offen offset:1024 nt lds
    s_add_u32 s27, s27, 8192
    ds_read_b128 v[212:215], v242 offset:33792
    v_cvt_pk_bf16_f32 v156, v156, v157
    v_mfma_f32_16x16x32_bf16 v[24:27], v[220:223], v[172:175], v[24:27]
    v_cvt_pk_bf16_f32 v164, v164, v165
    v_add_f32 v228, v228, v158
    v_mfma_f32_16x16x32_bf16 v[56:59], v[220:223], v[180:183], v[56:59]
    ds_read_b128 v[216:219], v243 offset:33792
    v_add_f32 v230, v230, v166
    v_add_f32 v229, v229, v159
    v_mfma_f32_16x16x32_bf16 v[28:31], v[224:227], v[172:175], v[28:31]
    v_add_f32 v231, v231, v167
    v_mfma_f32_16x16x32_bf16 v[60:63], v[224:227], v[180:183], v[60:63]
    ds_read_b128 v[220:223], v244 offset:33792
    v_cvt_pk_bf16_f32 v157, v158, v159
    v_cvt_pk_bf16_f32 v165, v166, v167
VAR_19_j:
    s_cmp_eq_u32 s24, 0
    s_cbranch_scc1 VAR_20_t
VAR_20_j:
    s_cmp_eq_u32 s24, 1
    s_cbranch_scc1 VAR_21_t
    s_waitcnt lgkmcnt(6)
    v_mfma_f32_16x16x32_bf16 v[172:175], v[196:199], v[96:99], v[144:147]
    v_exp_f32 v160, v160
    v_mfma_f32_16x16x32_bf16 v[180:183], v[196:199], v[112:115], v[148:151]
    ds_read_b128 v[224:227], v245 offset:33792
    v_exp_f32 v168, v168
    s_waitcnt lgkmcnt(6)
    v_mfma_f32_16x16x32_bf16 v[172:175], v[200:203], v[100:103], v[172:175]
    v_exp_f32 v161, v161
    v_mfma_f32_16x16x32_bf16 v[180:183], v[200:203], v[116:119], v[180:183]
    ds_read_b64_tr_b16 v[196:197], v234 offset:32768
    ds_read_b64_tr_b16 v[198:199], v234 offset:33792
    v_exp_f32 v169, v169
    s_waitcnt lgkmcnt(7)
    v_mfma_f32_16x16x32_bf16 v[172:175], v[204:207], v[104:107], v[172:175]
    v_add_f32 v228, v228, v160
    v_mfma_f32_16x16x32_bf16 v[180:183], v[204:207], v[120:123], v[180:183]
    ds_read_b64_tr_b16 v[200:201], v235 offset:32768
    ds_read_b64_tr_b16 v[202:203], v235 offset:33792
    v_add_f32 v230, v230, v168
    s_waitcnt lgkmcnt(8)
    v_mfma_f32_16x16x32_bf16 v[172:175], v[208:211], v[108:111], v[172:175]
    v_exp_f32 v162, v162
    v_mfma_f32_16x16x32_bf16 v[180:183], v[208:211], v[124:127], v[180:183]
    ds_read_b64_tr_b16 v[204:205], v236 offset:32768
    ds_read_b64_tr_b16 v[206:207], v236 offset:33792
    v_exp_f32 v170, v170
    s_waitcnt lgkmcnt(9)
    v_mfma_f32_16x16x32_bf16 v[176:179], v[212:215], v[96:99], v[144:147]
    v_add_f32 v229, v229, v161
    v_add_f32 v231, v231, v169
    v_mfma_f32_16x16x32_bf16 v[184:187], v[212:215], v[112:115], v[148:151]
    ds_read_b64_tr_b16 v[208:209], v237 offset:32768
    ds_read_b64_tr_b16 v[210:211], v237 offset:33792
    v_exp_f32 v163, v163
    s_waitcnt lgkmcnt(10)
    v_mfma_f32_16x16x32_bf16 v[176:179], v[216:219], v[100:103], v[176:179]
    v_exp_f32 v171, v171
    v_mfma_f32_16x16x32_bf16 v[184:187], v[216:219], v[116:119], v[184:187]
    ds_read_b64_tr_b16 v[212:213], v238 offset:32768
    ds_read_b64_tr_b16 v[214:215], v238 offset:33792
    v_cvt_pk_bf16_f32 v158, v160, v161
    s_waitcnt lgkmcnt(11)
    v_mfma_f32_16x16x32_bf16 v[176:179], v[220:223], v[104:107], v[176:179]
    v_cvt_pk_bf16_f32 v166, v168, v169
    v_add_f32 v228, v228, v162
    v_mfma_f32_16x16x32_bf16 v[184:187], v[220:223], v[120:123], v[184:187]
    ds_read_b64_tr_b16 v[216:217], v239 offset:32768
    ds_read_b64_tr_b16 v[218:219], v239 offset:33792
    v_add_f32 v230, v230, v170
    v_add_f32 v229, v229, v163
    s_waitcnt lgkmcnt(12)
    v_mfma_f32_16x16x32_bf16 v[176:179], v[224:227], v[108:111], v[176:179]
    v_add_f32 v231, v231, v171
    v_mfma_f32_16x16x32_bf16 v[184:187], v[224:227], v[124:127], v[184:187]
    ds_read_b64_tr_b16 v[220:221], v240 offset:32768
    ds_read_b64_tr_b16 v[222:223], v240 offset:33792
    v_cvt_pk_bf16_f32 v159, v162, v163
    v_cvt_pk_bf16_f32 v167, v170, v171
VAR_21_j:
    s_cmp_eq_u32 s24, 0
    s_cbranch_scc1 VAR_22_t
    s_waitcnt lgkmcnt(12)
    v_mfma_f32_16x16x32_bf16 v[0:3], v[196:199], v[156:159], v[0:3]
    v_exp_f32 v172, v172
    v_mfma_f32_16x16x32_bf16 v[32:35], v[196:199], v[164:167], v[32:35]
    ds_read_b64_tr_b16 v[224:225], v241 offset:32768
    ds_read_b64_tr_b16 v[226:227], v241 offset:33792
    v_exp_f32 v180, v180
    s_waitcnt lgkmcnt(12)
    v_mfma_f32_16x16x32_bf16 v[4:7], v[200:203], v[156:159], v[4:7]
    v_exp_f32 v173, v173
    v_mfma_f32_16x16x32_bf16 v[36:39], v[200:203], v[164:167], v[36:39]
    v_exp_f32 v181, v181
    s_waitcnt lgkmcnt(10)
    v_mfma_f32_16x16x32_bf16 v[8:11], v[204:207], v[156:159], v[8:11]
    v_add_f32 v228, v228, v172
    v_mfma_f32_16x16x32_bf16 v[40:43], v[204:207], v[164:167], v[40:43]
    v_add_f32 v230, v230, v180
    s_waitcnt lgkmcnt(8)
    v_mfma_f32_16x16x32_bf16 v[12:15], v[208:211], v[156:159], v[12:15]
    v_exp_f32 v174, v174
    v_mfma_f32_16x16x32_bf16 v[44:47], v[208:211], v[164:167], v[44:47]
    s_waitcnt vmcnt(4) lgkmcnt(0)
    s_barrier
    ds_read_b128 v[196:199], v242
    ds_read_b128 v[200:203], v243
    ds_read_b128 v[204:207], v244
    v_exp_f32 v182, v182
    v_mfma_f32_16x16x32_bf16 v[16:19], v[212:215], v[156:159], v[16:19]
    s_add_u32 m0, s25, 57344
    s_nop 0
    buffer_load_dwordx4 v246, s[8:11], s26 offen nt lds
    v_add_f32 v229, v229, v173
    v_add_f32 v231, v231, v181
    v_mfma_f32_16x16x32_bf16 v[48:51], v[212:215], v[164:167], v[48:51]
    buffer_load_dwordx4 v246, s[8:11], s26 offen offset:1024 nt lds
    s_add_u32 s26, s26, 8192
    ds_read_b128 v[208:211], v245
    v_exp_f32 v175, v175
    v_mfma_f32_16x16x32_bf16 v[20:23], v[216:219], v[156:159], v[20:23]
    s_add_u32 m0, s25, 16384
    s_nop 0
    buffer_load_dwordx4 v247, s[12:15], s27 offen nt lds
    v_exp_f32 v183, v183
    v_mfma_f32_16x16x32_bf16 v[52:55], v[216:219], v[164:167], v[52:55]
    buffer_load_dwordx4 v247, s[12:15], s27 offen offset:1024 nt lds
    s_add_u32 s27, s27, 8192
    ds_read_b128 v[212:215], v242 offset:1024
    v_cvt_pk_bf16_f32 v172, v172, v173
    v_mfma_f32_16x16x32_bf16 v[24:27], v[220:223], v[156:159], v[24:27]
    v_cvt_pk_bf16_f32 v180, v180, v181
    v_add_f32 v228, v228, v174
    v_mfma_f32_16x16x32_bf16 v[56:59], v[220:223], v[164:167], v[56:59]
    ds_read_b128 v[216:219], v243 offset:1024
    v_add_f32 v230, v230, v182
    v_add_f32 v229, v229, v175
    v_mfma_f32_16x16x32_bf16 v[28:31], v[224:227], v[156:159], v[28:31]
    v_add_f32 v231, v231, v183
    v_mfma_f32_16x16x32_bf16 v[60:63], v[224:227], v[164:167], v[60:63]
    ds_read_b128 v[220:223], v244 offset:1024
    v_cvt_pk_bf16_f32 v173, v174, v175
    v_cvt_pk_bf16_f32 v181, v182, v183
VAR_22_j:
    s_cmp_eq_u32 s60, 1
    s_cselect_b32 s4, s54, s44
    s_cselect_b32 s5, s55, s45
    s_mov_b32 s6, 4194304
    s_mov_b32 s7, 0x20000
    s_lshl_b32 s61, s76, 20
    s_lshl_b32 s62, s77, 7
    s_add_u32 s61, s61, s62
    s_lshl_b32 s62, s58, 17
    s_add_u32 s61, s61, s62
    s_lshl_b32 s62, s24, 15
    s_add_u32 s61, s61, s62
    v_lshrrev_b32 v251, 3, v248
    v_lshlrev_b32 v251, 10, v251
    v_and_b32 v252, 7, v248
    v_lshl_add_u32 v251, v252, 4, v251
    buffer_load_dwordx4 v[252:255], v251, s[4:7], s61 offen
    s_add_u32 s61, s61, 8192
    buffer_load_dwordx4 v[252:255], v251, s[4:7], s61 offen
    s_add_u32 s61, s61, 8192
    buffer_load_dwordx4 v[252:255], v251, s[4:7], s61 offen
    s_add_u32 s61, s61, 8192
    buffer_load_dwordx4 v[252:255], v251, s[4:7], s61 offen
    s_add_u32 s61, s61, 8192
    s_cmp_eq_u32 s24, 1
    s_cbranch_scc1 VAR_23_t
VAR_23_j:
    s_cmp_eq_u32 s24, 2
    s_cbranch_scc1 VAR_24_t
    s_waitcnt lgkmcnt(6)
    v_mfma_f32_16x16x32_bf16 v[156:159], v[196:199], v[96:99], v[144:147]
    v_exp_f32 v176, v176
    v_mfma_f32_16x16x32_bf16 v[164:167], v[196:199], v[112:115], v[148:151]
    ds_read_b128 v[224:227], v245 offset:1024
    v_exp_f32 v184, v184
    s_waitcnt lgkmcnt(6)
    v_mfma_f32_16x16x32_bf16 v[156:159], v[200:203], v[100:103], v[156:159]
    v_exp_f32 v177, v177
    v_mfma_f32_16x16x32_bf16 v[164:167], v[200:203], v[116:119], v[164:167]
    ds_read_b64_tr_b16 v[196:197], v234
    ds_read_b64_tr_b16 v[198:199], v234 offset:1024
    v_exp_f32 v185, v185
    s_waitcnt lgkmcnt(7)
    v_mfma_f32_16x16x32_bf16 v[156:159], v[204:207], v[104:107], v[156:159]
    v_add_f32 v228, v228, v176
    v_mfma_f32_16x16x32_bf16 v[164:167], v[204:207], v[120:123], v[164:167]
    ds_read_b64_tr_b16 v[200:201], v235
    ds_read_b64_tr_b16 v[202:203], v235 offset:1024
    v_add_f32 v230, v230, v184
    s_waitcnt lgkmcnt(8)
    v_mfma_f32_16x16x32_bf16 v[156:159], v[208:211], v[108:111], v[156:159]
    v_exp_f32 v178, v178
    v_mfma_f32_16x16x32_bf16 v[164:167], v[208:211], v[124:127], v[164:167]
    ds_read_b64_tr_b16 v[204:205], v236
    ds_read_b64_tr_b16 v[206:207], v236 offset:1024
    v_exp_f32 v186, v186
    s_waitcnt lgkmcnt(9)
    v_mfma_f32_16x16x32_bf16 v[160:163], v[212:215], v[96:99], v[144:147]
    v_add_f32 v229, v229, v177
    v_add_f32 v231, v231, v185
    v_mfma_f32_16x16x32_bf16 v[168:171], v[212:215], v[112:115], v[148:151]
    ds_read_b64_tr_b16 v[208:209], v237
    ds_read_b64_tr_b16 v[210:211], v237 offset:1024
    v_exp_f32 v179, v179
    s_waitcnt lgkmcnt(10)
    v_mfma_f32_16x16x32_bf16 v[160:163], v[216:219], v[100:103], v[160:163]
    v_exp_f32 v187, v187
    v_mfma_f32_16x16x32_bf16 v[168:171], v[216:219], v[116:119], v[168:171]
    ds_read_b64_tr_b16 v[212:213], v238
    ds_read_b64_tr_b16 v[214:215], v238 offset:1024
    v_cvt_pk_bf16_f32 v174, v176, v177
    s_waitcnt lgkmcnt(11)
    v_mfma_f32_16x16x32_bf16 v[160:163], v[220:223], v[104:107], v[160:163]
    v_cvt_pk_bf16_f32 v182, v184, v185
    v_add_f32 v228, v228, v178
    v_mfma_f32_16x16x32_bf16 v[168:171], v[220:223], v[120:123], v[168:171]
    ds_read_b64_tr_b16 v[216:217], v239
    ds_read_b64_tr_b16 v[218:219], v239 offset:1024
    v_add_f32 v230, v230, v186
    v_add_f32 v229, v229, v179
    s_waitcnt lgkmcnt(12)
    v_mfma_f32_16x16x32_bf16 v[160:163], v[224:227], v[108:111], v[160:163]
    v_add_f32 v231, v231, v187
    v_mfma_f32_16x16x32_bf16 v[168:171], v[224:227], v[124:127], v[168:171]
    ds_read_b64_tr_b16 v[220:221], v240
    ds_read_b64_tr_b16 v[222:223], v240 offset:1024
    v_cvt_pk_bf16_f32 v175, v178, v179
    v_cvt_pk_bf16_f32 v183, v186, v187
VAR_24_j:
    s_cmp_eq_u32 s24, 1
    s_cbranch_scc1 VAR_25_t
    s_waitcnt lgkmcnt(12)
    v_mfma_f32_16x16x32_bf16 v[0:3], v[196:199], v[172:175], v[0:3]
    v_exp_f32 v156, v156
    v_mfma_f32_16x16x32_bf16 v[32:35], v[196:199], v[180:183], v[32:35]
    ds_read_b64_tr_b16 v[224:225], v241
    ds_read_b64_tr_b16 v[226:227], v241 offset:1024
    v_exp_f32 v164, v164
    s_waitcnt lgkmcnt(12)
    v_mfma_f32_16x16x32_bf16 v[4:7], v[200:203], v[172:175], v[4:7]
    v_exp_f32 v157, v157
    v_mfma_f32_16x16x32_bf16 v[36:39], v[200:203], v[180:183], v[36:39]
    v_exp_f32 v165, v165
    s_waitcnt lgkmcnt(10)
    v_mfma_f32_16x16x32_bf16 v[8:11], v[204:207], v[172:175], v[8:11]
    v_add_f32 v228, v228, v156
    v_mfma_f32_16x16x32_bf16 v[40:43], v[204:207], v[180:183], v[40:43]
    v_add_f32 v230, v230, v164
    s_waitcnt lgkmcnt(8)
    v_mfma_f32_16x16x32_bf16 v[12:15], v[208:211], v[172:175], v[12:15]
    v_exp_f32 v158, v158
    v_mfma_f32_16x16x32_bf16 v[44:47], v[208:211], v[180:183], v[44:47]
    s_waitcnt vmcnt(8) lgkmcnt(0)
    s_barrier
    ds_read_b128 v[196:199], v242 offset:8192
    ds_read_b128 v[200:203], v243 offset:8192
    ds_read_b128 v[204:207], v244 offset:8192
    v_exp_f32 v166, v166
    v_mfma_f32_16x16x32_bf16 v[16:19], v[212:215], v[172:175], v[16:19]
    s_add_u32 m0, s25, 65536
    s_nop 0
    buffer_load_dwordx4 v246, s[8:11], s26 offen nt lds
    v_add_f32 v229, v229, v157
    v_add_f32 v231, v231, v165
    v_mfma_f32_16x16x32_bf16 v[48:51], v[212:215], v[180:183], v[48:51]
    buffer_load_dwordx4 v246, s[8:11], s26 offen offset:1024 nt lds
    s_add_u32 s26, s26, 8192
    ds_read_b128 v[208:211], v245 offset:8192
    v_exp_f32 v159, v159
    v_mfma_f32_16x16x32_bf16 v[20:23], v[216:219], v[172:175], v[20:23]
    s_add_u32 m0, s25, 24576
    s_nop 0
    buffer_load_dwordx4 v247, s[12:15], s27 offen nt lds
    v_exp_f32 v167, v167
    v_mfma_f32_16x16x32_bf16 v[52:55], v[216:219], v[180:183], v[52:55]
    buffer_load_dwordx4 v247, s[12:15], s27 offen offset:1024 nt lds
    s_add_u32 s27, s27, 8192
    ds_read_b128 v[212:215], v242 offset:9216
    v_cvt_pk_bf16_f32 v156, v156, v157
    v_mfma_f32_16x16x32_bf16 v[24:27], v[220:223], v[172:175], v[24:27]
    v_cvt_pk_bf16_f32 v164, v164, v165
    v_add_f32 v228, v228, v158
    v_mfma_f32_16x16x32_bf16 v[56:59], v[220:223], v[180:183], v[56:59]
    ds_read_b128 v[216:219], v243 offset:9216
    v_add_f32 v230, v230, v166
    v_add_f32 v229, v229, v159
    v_mfma_f32_16x16x32_bf16 v[28:31], v[224:227], v[172:175], v[28:31]
    v_add_f32 v231, v231, v167
    v_mfma_f32_16x16x32_bf16 v[60:63], v[224:227], v[180:183], v[60:63]
    ds_read_b128 v[220:223], v244 offset:9216
    v_cvt_pk_bf16_f32 v157, v158, v159
    v_cvt_pk_bf16_f32 v165, v166, v167
VAR_25_j:
    s_cmp_eq_u32 s24, 2
    s_cbranch_scc1 VAR_26_t
VAR_26_j:
    s_cmp_eq_u32 s24, 3
    s_cbranch_scc1 VAR_27_t
    s_waitcnt lgkmcnt(6)
    v_mfma_f32_16x16x32_bf16 v[172:175], v[196:199], v[96:99], v[144:147]
    v_exp_f32 v160, v160
    v_mfma_f32_16x16x32_bf16 v[180:183], v[196:199], v[112:115], v[148:151]
    ds_read_b128 v[224:227], v245 offset:9216
    v_exp_f32 v168, v168
    s_waitcnt lgkmcnt(6)
    v_mfma_f32_16x16x32_bf16 v[172:175], v[200:203], v[100:103], v[172:175]
    v_exp_f32 v161, v161
    v_mfma_f32_16x16x32_bf16 v[180:183], v[200:203], v[116:119], v[180:183]
    ds_read_b64_tr_b16 v[196:197], v234 offset:8192
    ds_read_b64_tr_b16 v[198:199], v234 offset:9216
    v_exp_f32 v169, v169
    s_waitcnt lgkmcnt(7)
    v_mfma_f32_16x16x32_bf16 v[172:175], v[204:207], v[104:107], v[172:175]
    v_add_f32 v228, v228, v160
    v_mfma_f32_16x16x32_bf16 v[180:183], v[204:207], v[120:123], v[180:183]
    ds_read_b64_tr_b16 v[200:201], v235 offset:8192
    ds_read_b64_tr_b16 v[202:203], v235 offset:9216
    v_add_f32 v230, v230, v168
    s_waitcnt lgkmcnt(8)
    v_mfma_f32_16x16x32_bf16 v[172:175], v[208:211], v[108:111], v[172:175]
    v_exp_f32 v162, v162
    v_mfma_f32_16x16x32_bf16 v[180:183], v[208:211], v[124:127], v[180:183]
    ds_read_b64_tr_b16 v[204:205], v236 offset:8192
    ds_read_b64_tr_b16 v[206:207], v236 offset:9216
    v_exp_f32 v170, v170
    s_waitcnt lgkmcnt(9)
    v_mfma_f32_16x16x32_bf16 v[176:179], v[212:215], v[96:99], v[144:147]
    v_add_f32 v229, v229, v161
    v_add_f32 v231, v231, v169
    v_mfma_f32_16x16x32_bf16 v[184:187], v[212:215], v[112:115], v[148:151]
    ds_read_b64_tr_b16 v[208:209], v237 offset:8192
    ds_read_b64_tr_b16 v[210:211], v237 offset:9216
    v_exp_f32 v163, v163
    s_waitcnt lgkmcnt(10)
    v_mfma_f32_16x16x32_bf16 v[176:179], v[216:219], v[100:103], v[176:179]
    v_exp_f32 v171, v171
    v_mfma_f32_16x16x32_bf16 v[184:187], v[216:219], v[116:119], v[184:187]
    ds_read_b64_tr_b16 v[212:213], v238 offset:8192
    ds_read_b64_tr_b16 v[214:215], v238 offset:9216
    v_cvt_pk_bf16_f32 v158, v160, v161
    s_waitcnt lgkmcnt(11)
    v_mfma_f32_16x16x32_bf16 v[176:179], v[220:223], v[104:107], v[176:179]
    v_cvt_pk_bf16_f32 v166, v168, v169
    v_add_f32 v228, v228, v162
    v_mfma_f32_16x16x32_bf16 v[184:187], v[220:223], v[120:123], v[184:187]
    ds_read_b64_tr_b16 v[216:217], v239 offset:8192
    ds_read_b64_tr_b16 v[218:219], v239 offset:9216
    v_add_f32 v230, v230, v170
    v_add_f32 v229, v229, v163
    s_waitcnt lgkmcnt(12)
    v_mfma_f32_16x16x32_bf16 v[176:179], v[224:227], v[108:111], v[176:179]
    v_add_f32 v231, v231, v171
    v_mfma_f32_16x16x32_bf16 v[184:187], v[224:227], v[124:127], v[184:187]
    ds_read_b64_tr_b16 v[220:221], v240 offset:8192
    ds_read_b64_tr_b16 v[222:223], v240 offset:9216
    v_cvt_pk_bf16_f32 v159, v162, v163
    v_cvt_pk_bf16_f32 v167, v170, v171
VAR_27_j:
    s_cmp_eq_u32 s24, 2
    s_cbranch_scc1 VAR_28_t
    s_waitcnt lgkmcnt(12)
    v_mfma_f32_16x16x32_bf16 v[0:3], v[196:199], v[156:159], v[0:3]
    v_exp_f32 v172, v172
    v_mfma_f32_16x16x32_bf16 v[32:35], v[196:199], v[164:167], v[32:35]
    ds_read_b64_tr_b16 v[224:225], v241 offset:8192
    ds_read_b64_tr_b16 v[226:227], v241 offset:9216
    v_exp_f32 v180, v180
    s_waitcnt lgkmcnt(12)
    v_mfma_f32_16x16x32_bf16 v[4:7], v[200:203], v[156:159], v[4:7]
    v_exp_f32 v173, v173
    v_mfma_f32_16x16x32_bf16 v[36:39], v[200:203], v[164:167], v[36:39]
    v_exp_f32 v181, v181
    s_waitcnt lgkmcnt(10)
    v_mfma_f32_16x16x32_bf16 v[8:11], v[204:207], v[156:159], v[8:11]
    v_add_f32 v228, v228, v172
    v_mfma_f32_16x16x32_bf16 v[40:43], v[204:207], v[164:167], v[40:43]
    v_add_f32 v230, v230, v180
    s_waitcnt lgkmcnt(8)
    v_mfma_f32_16x16x32_bf16 v[12:15], v[208:211], v[156:159], v[12:15]
    v_exp_f32 v174, v174
    v_mfma_f32_16x16x32_bf16 v[44:47], v[208:211], v[164:167], v[44:47]
    s_waitcnt vmcnt(8) lgkmcnt(0)
    s_barrier
    ds_read_b128 v[196:199], v242 offset:16384
    ds_read_b128 v[200:203], v243 offset:16384
    ds_read_b128 v[204:207], v244 offset:16384
    v_exp_f32 v182, v182
    v_mfma_f32_16x16x32_bf16 v[16:19], v[212:215], v[156:159], v[16:19]
    s_add_u32 m0, s25, 73728
    s_nop 0
    buffer_load_dwordx4 v246, s[8:11], s26 offen nt lds
    v_add_f32 v229, v229, v173
    v_add_f32 v231, v231, v181
    v_mfma_f32_16x16x32_bf16 v[48:51], v[212:215], v[164:167], v[48:51]
    buffer_load_dwordx4 v246, s[8:11], s26 offen offset:1024 nt lds
    s_add_u32 s26, s26, 8192
    ds_read_b128 v[208:211], v245 offset:16384
    v_exp_f32 v175, v175
    v_mfma_f32_16x16x32_bf16 v[20:23], v[216:219], v[156:159], v[20:23]
    s_add_u32 m0, s25, 32768
    s_nop 0
    buffer_load_dwordx4 v247, s[12:15], s27 offen nt lds
    v_exp_f32 v183, v183
    v_mfma_f32_16x16x32_bf16 v[52:55], v[216:219], v[164:167], v[52:55]
    buffer_load_dwordx4 v247, s[12:15], s27 offen offset:1024 nt lds
    s_add_u32 s27, s27, 8192
    ds_read_b128 v[212:215], v242 offset:17408
    v_cvt_pk_bf16_f32 v172, v172, v173
    v_mfma_f32_16x16x32_bf16 v[24:27], v[220:223], v[156:159], v[24:27]
    v_cvt_pk_bf16_f32 v180, v180, v181
    v_add_f32 v228, v228, v174
    v_mfma_f32_16x16x32_bf16 v[56:59], v[220:223], v[164:167], v[56:59]
    ds_read_b128 v[216:219], v243 offset:17408
    v_add_f32 v230, v230, v182
    v_add_f32 v229, v229, v175
    v_mfma_f32_16x16x32_bf16 v[28:31], v[224:227], v[156:159], v[28:31]
    v_add_f32 v231, v231, v183
    v_mfma_f32_16x16x32_bf16 v[60:63], v[224:227], v[164:167], v[60:63]
    ds_read_b128 v[220:223], v244 offset:17408
    v_cvt_pk_bf16_f32 v173, v174, v175
    v_cvt_pk_bf16_f32 v181, v182, v183
VAR_28_j:
    s_cmp_eq_u32 s24, 3
    s_cbranch_scc1 VAR_29_t
VAR_29_j:
    s_cmp_eq_u32 s24, 0
    s_cbranch_scc1 VAR_30_t
    s_waitcnt lgkmcnt(6)
    v_mfma_f32_16x16x32_bf16 v[156:159], v[196:199], v[96:99], v[144:147]
    v_exp_f32 v176, v176
    v_mfma_f32_16x16x32_bf16 v[164:167], v[196:199], v[112:115], v[148:151]
    ds_read_b128 v[224:227], v245 offset:17408
    v_exp_f32 v184, v184
    s_waitcnt lgkmcnt(6)
    v_mfma_f32_16x16x32_bf16 v[156:159], v[200:203], v[100:103], v[156:159]
    v_exp_f32 v177, v177
    v_mfma_f32_16x16x32_bf16 v[164:167], v[200:203], v[116:119], v[164:167]
    ds_read_b64_tr_b16 v[196:197], v234 offset:16384
    ds_read_b64_tr_b16 v[198:199], v234 offset:17408
    v_exp_f32 v185, v185
    s_waitcnt lgkmcnt(7)
    v_mfma_f32_16x16x32_bf16 v[156:159], v[204:207], v[104:107], v[156:159]
    v_add_f32 v228, v228, v176
    v_mfma_f32_16x16x32_bf16 v[164:167], v[204:207], v[120:123], v[164:167]
    ds_read_b64_tr_b16 v[200:201], v235 offset:16384
    ds_read_b64_tr_b16 v[202:203], v235 offset:17408
    v_add_f32 v230, v230, v184
    s_waitcnt lgkmcnt(8)
    v_mfma_f32_16x16x32_bf16 v[156:159], v[208:211], v[108:111], v[156:159]
    v_exp_f32 v178, v178
    v_mfma_f32_16x16x32_bf16 v[164:167], v[208:211], v[124:127], v[164:167]
    ds_read_b64_tr_b16 v[204:205], v236 offset:16384
    ds_read_b64_tr_b16 v[206:207], v236 offset:17408
    v_exp_f32 v186, v186
    s_waitcnt lgkmcnt(9)
    v_mfma_f32_16x16x32_bf16 v[160:163], v[212:215], v[96:99], v[144:147]
    v_add_f32 v229, v229, v177
    v_add_f32 v231, v231, v185
    v_mfma_f32_16x16x32_bf16 v[168:171], v[212:215], v[112:115], v[148:151]
    ds_read_b64_tr_b16 v[208:209], v237 offset:16384
    ds_read_b64_tr_b16 v[210:211], v237 offset:17408
    v_exp_f32 v179, v179
    s_waitcnt lgkmcnt(10)
    v_mfma_f32_16x16x32_bf16 v[160:163], v[216:219], v[100:103], v[160:163]
    v_exp_f32 v187, v187
    v_mfma_f32_16x16x32_bf16 v[168:171], v[216:219], v[116:119], v[168:171]
    ds_read_b64_tr_b16 v[212:213], v238 offset:16384
    ds_read_b64_tr_b16 v[214:215], v238 offset:17408
    v_cvt_pk_bf16_f32 v174, v176, v177
    s_waitcnt lgkmcnt(11)
    v_mfma_f32_16x16x32_bf16 v[160:163], v[220:223], v[104:107], v[160:163]
    v_cvt_pk_bf16_f32 v182, v184, v185
    v_add_f32 v228, v228, v178
    v_mfma_f32_16x16x32_bf16 v[168:171], v[220:223], v[120:123], v[168:171]
    ds_read_b64_tr_b16 v[216:217], v239 offset:16384
    ds_read_b64_tr_b16 v[218:219], v239 offset:17408
    v_add_f32 v230, v230, v186
    v_add_f32 v229, v229, v179
    s_waitcnt lgkmcnt(12)
    v_mfma_f32_16x16x32_bf16 v[160:163], v[224:227], v[108:111], v[160:163]
    v_add_f32 v231, v231, v187
    v_mfma_f32_16x16x32_bf16 v[168:171], v[224:227], v[124:127], v[168:171]
    ds_read_b64_tr_b16 v[220:221], v240 offset:16384
    ds_read_b64_tr_b16 v[222:223], v240 offset:17408
    v_cvt_pk_bf16_f32 v175, v178, v179
    v_cvt_pk_bf16_f32 v183, v186, v187
VAR_30_j:
    s_cmp_eq_u32 s24, 3
    s_cbranch_scc1 VAR_31_t
    s_waitcnt lgkmcnt(12)
    v_mfma_f32_16x16x32_bf16 v[0:3], v[196:199], v[172:175], v[0:3]
    v_exp_f32 v156, v156
    v_mfma_f32_16x16x32_bf16 v[32:35], v[196:199], v[180:183], v[32:35]
    ds_read_b64_tr_b16 v[224:225], v241 offset:16384
    ds_read_b64_tr_b16 v[226:227], v241 offset:17408
    v_exp_f32 v164, v164
    s_waitcnt lgkmcnt(12)
    v_mfma_f32_16x16x32_bf16 v[4:7], v[200:203], v[172:175], v[4:7]
    v_exp_f32 v157, v157
    v_mfma_f32_16x16x32_bf16 v[36:39], v[200:203], v[180:183], v[36:39]
    v_exp_f32 v165, v165
    s_waitcnt lgkmcnt(10)
    v_mfma_f32_16x16x32_bf16 v[8:11], v[204:207], v[172:175], v[8:11]
    v_add_f32 v228, v228, v156
    v_mfma_f32_16x16x32_bf16 v[40:43], v[204:207], v[180:183], v[40:43]
    v_add_f32 v230, v230, v164
    s_waitcnt lgkmcnt(8)
    v_mfma_f32_16x16x32_bf16 v[12:15], v[208:211], v[172:175], v[12:15]
    v_exp_f32 v158, v158
    v_mfma_f32_16x16x32_bf16 v[44:47], v[208:211], v[180:183], v[44:47]
    s_waitcnt vmcnt(4) lgkmcnt(0)
    s_barrier
    ds_read_b128 v[196:199], v242 offset:24576
    ds_read_b128 v[200:203], v243 offset:24576
    ds_read_b128 v[204:207], v244 offset:24576
    v_exp_f32 v166, v166
    v_mfma_f32_16x16x32_bf16 v[16:19], v[212:215], v[172:175], v[16:19]
    s_add_u32 m0, s25, 40960
    s_nop 0
    buffer_load_dwordx4 v246, s[8:11], s26 offen nt lds
    v_add_f32 v229, v229, v157
    v_add_f32 v231, v231, v165
    v_mfma_f32_16x16x32_bf16 v[48:51], v[212:215], v[180:183], v[48:51]
    buffer_load_dwordx4 v246, s[8:11], s26 offen offset:1024 nt lds
    s_add_u32 s26, s26, 8192
    ds_read_b128 v[208:211], v245 offset:24576
    v_exp_f32 v159, v159
    v_mfma_f32_16x16x32_bf16 v[20:23], v[216:219], v[172:175], v[20:23]
    s_add_u32 m0, s25, 0
    s_nop 0
    buffer_load_dwordx4 v247, s[12:15], s27 offen nt lds
    v_exp_f32 v167, v167
    v_mfma_f32_16x16x32_bf16 v[52:55], v[216:219], v[180:183], v[52:55]
    buffer_load_dwordx4 v247, s[12:15], s27 offen offset:1024 nt lds
    s_add_u32 s27, s27, 8192
    ds_read_b128 v[212:215], v242 offset:25600
    v_cvt_pk_bf16_f32 v156, v156, v157
    v_mfma_f32_16x16x32_bf16 v[24:27], v[220:223], v[172:175], v[24:27]
    v_cvt_pk_bf16_f32 v164, v164, v165
    v_add_f32 v228, v228, v158
    v_mfma_f32_16x16x32_bf16 v[56:59], v[220:223], v[180:183], v[56:59]
    ds_read_b128 v[216:219], v243 offset:25600
    v_add_f32 v230, v230, v166
    v_add_f32 v229, v229, v159
    v_mfma_f32_16x16x32_bf16 v[28:31], v[224:227], v[172:175], v[28:31]
    v_add_f32 v231, v231, v167
    v_mfma_f32_16x16x32_bf16 v[60:63], v[224:227], v[180:183], v[60:63]
    ds_read_b128 v[220:223], v244 offset:25600
    v_cvt_pk_bf16_f32 v157, v158, v159
    v_cvt_pk_bf16_f32 v165, v166, v167
VAR_31_j:
    s_mov_b32 s16, s74
    s_and_b32 s17, s75, 0xffff
    s_mov_b32 s18, 256
    s_mov_b32 s19, 0x20000
    v_mov_b32 v251, 0
    buffer_load_dword v252, v251, s[16:19], 0 offen sc1
    s_cmp_eq_u32 s24, 0
    s_cbranch_scc1 VAR_32_t
VAR_32_j:
    s_cmp_eq_u32 s24, 1
    s_cbranch_scc1 VAR_33_t
    s_waitcnt lgkmcnt(6)
    v_mfma_f32_16x16x32_bf16 v[172:175], v[196:199], v[96:99], v[144:147]
    v_exp_f32 v160, v160
    v_mfma_f32_16x16x32_bf16 v[180:183], v[196:199], v[112:115], v[148:151]
    ds_read_b128 v[224:227], v245 offset:25600
    v_exp_f32 v168, v168
    s_waitcnt lgkmcnt(6)
    v_mfma_f32_16x16x32_bf16 v[172:175], v[200:203], v[100:103], v[172:175]
    v_exp_f32 v161, v161
    v_mfma_f32_16x16x32_bf16 v[180:183], v[200:203], v[116:119], v[180:183]
    ds_read_b64_tr_b16 v[196:197], v234 offset:24576
    ds_read_b64_tr_b16 v[198:199], v234 offset:25600
    v_exp_f32 v169, v169
    s_waitcnt lgkmcnt(7)
    v_mfma_f32_16x16x32_bf16 v[172:175], v[204:207], v[104:107], v[172:175]
    v_add_f32 v228, v228, v160
    v_mfma_f32_16x16x32_bf16 v[180:183], v[204:207], v[120:123], v[180:183]
    ds_read_b64_tr_b16 v[200:201], v235 offset:24576
    ds_read_b64_tr_b16 v[202:203], v235 offset:25600
    v_add_f32 v230, v230, v168
    s_waitcnt lgkmcnt(8)
    v_mfma_f32_16x16x32_bf16 v[172:175], v[208:211], v[108:111], v[172:175]
    v_exp_f32 v162, v162
    v_mfma_f32_16x16x32_bf16 v[180:183], v[208:211], v[124:127], v[180:183]
    ds_read_b64_tr_b16 v[204:205], v236 offset:24576
    ds_read_b64_tr_b16 v[206:207], v236 offset:25600
    v_exp_f32 v170, v170
    s_waitcnt lgkmcnt(9)
    v_mfma_f32_16x16x32_bf16 v[176:179], v[212:215], v[96:99], v[144:147]
    v_add_f32 v229, v229, v161
    v_add_f32 v231, v231, v169
    v_mfma_f32_16x16x32_bf16 v[184:187], v[212:215], v[112:115], v[148:151]
    ds_read_b64_tr_b16 v[208:209], v237 offset:24576
    ds_read_b64_tr_b16 v[210:211], v237 offset:25600
    v_exp_f32 v163, v163
    s_waitcnt lgkmcnt(10)
    v_mfma_f32_16x16x32_bf16 v[176:179], v[216:219], v[100:103], v[176:179]
    v_exp_f32 v171, v171
    v_mfma_f32_16x16x32_bf16 v[184:187], v[216:219], v[116:119], v[184:187]
    ds_read_b64_tr_b16 v[212:213], v238 offset:24576
    ds_read_b64_tr_b16 v[214:215], v238 offset:25600
    v_cvt_pk_bf16_f32 v158, v160, v161
    s_waitcnt lgkmcnt(11)
    v_mfma_f32_16x16x32_bf16 v[176:179], v[220:223], v[104:107], v[176:179]
    v_cvt_pk_bf16_f32 v166, v168, v169
    v_add_f32 v228, v228, v162
    v_mfma_f32_16x16x32_bf16 v[184:187], v[220:223], v[120:123], v[184:187]
    ds_read_b64_tr_b16 v[216:217], v239 offset:24576
    ds_read_b64_tr_b16 v[218:219], v239 offset:25600
    v_add_f32 v230, v230, v170
    v_add_f32 v229, v229, v163
    s_waitcnt lgkmcnt(12)
    v_mfma_f32_16x16x32_bf16 v[176:179], v[224:227], v[108:111], v[176:179]
    v_add_f32 v231, v231, v171
    v_mfma_f32_16x16x32_bf16 v[184:187], v[224:227], v[124:127], v[184:187]
    ds_read_b64_tr_b16 v[220:221], v240 offset:24576
    ds_read_b64_tr_b16 v[222:223], v240 offset:25600
    v_cvt_pk_bf16_f32 v159, v162, v163
    v_cvt_pk_bf16_f32 v167, v170, v171
VAR_33_j:
    s_cmp_eq_u32 s24, 0
    s_cbranch_scc1 VAR_34_t
    s_waitcnt lgkmcnt(12)
    v_mfma_f32_16x16x32_bf16 v[0:3], v[196:199], v[156:159], v[0:3]
    v_exp_f32 v172, v172
    v_mfma_f32_16x16x32_bf16 v[32:35], v[196:199], v[164:167], v[32:35]
    ds_read_b64_tr_b16 v[224:225], v241 offset:24576
    ds_read_b64_tr_b16 v[226:227], v241 offset:25600
    v_exp_f32 v180, v180
    s_waitcnt lgkmcnt(12)
    v_mfma_f32_16x16x32_bf16 v[4:7], v[200:203], v[156:159], v[4:7]
    v_exp_f32 v173, v173
    v_mfma_f32_16x16x32_bf16 v[36:39], v[200:203], v[164:167], v[36:39]
    v_exp_f32 v181, v181
    s_waitcnt lgkmcnt(10)
    v_mfma_f32_16x16x32_bf16 v[8:11], v[204:207], v[156:159], v[8:11]
    v_add_f32 v228, v228, v172
    v_mfma_f32_16x16x32_bf16 v[40:43], v[204:207], v[164:167], v[40:43]
    v_add_f32 v230, v230, v180
    s_waitcnt lgkmcnt(8)
    v_mfma_f32_16x16x32_bf16 v[12:15], v[208:211], v[156:159], v[12:15]
    v_exp_f32 v174, v174
    v_mfma_f32_16x16x32_bf16 v[44:47], v[208:211], v[164:167], v[44:47]
    s_waitcnt vmcnt(5) lgkmcnt(0)
    s_barrier
    ds_read_b128 v[196:199], v242 offset:32768
    ds_read_b128 v[200:203], v243 offset:32768
    ds_read_b128 v[204:207], v244 offset:32768
    v_exp_f32 v182, v182
    v_mfma_f32_16x16x32_bf16 v[16:19], v[212:215], v[156:159], v[16:19]
    s_add_u32 m0, s25, 49152
    s_nop 0
    buffer_load_dwordx4 v246, s[8:11], s26 offen nt lds
    v_add_f32 v229, v229, v173
    v_add_f32 v231, v231, v181
    v_mfma_f32_16x16x32_bf16 v[48:51], v[212:215], v[164:167], v[48:51]
    buffer_load_dwordx4 v246, s[8:11], s26 offen offset:1024 nt lds
    s_add_u32 s26, s26, 8192
    ds_read_b128 v[208:211], v245 offset:32768
    v_exp_f32 v175, v175
    v_mfma_f32_16x16x32_bf16 v[20:23], v[216:219], v[156:159], v[20:23]
    s_add_u32 m0, s25, 8192
    s_nop 0
    buffer_load_dwordx4 v247, s[12:15], s27 offen nt lds
    v_exp_f32 v183, v183
    v_mfma_f32_16x16x32_bf16 v[52:55], v[216:219], v[164:167], v[52:55]
    buffer_load_dwordx4 v247, s[12:15], s27 offen offset:1024 nt lds
    s_add_u32 s27, s27, 8192
    ds_read_b128 v[212:215], v242 offset:33792
    v_cvt_pk_bf16_f32 v172, v172, v173
    v_mfma_f32_16x16x32_bf16 v[24:27], v[220:223], v[156:159], v[24:27]
    v_cvt_pk_bf16_f32 v180, v180, v181
    v_add_f32 v228, v228, v174
    v_mfma_f32_16x16x32_bf16 v[56:59], v[220:223], v[164:167], v[56:59]
    ds_read_b128 v[216:219], v243 offset:33792
    v_add_f32 v230, v230, v182
    v_add_f32 v229, v229, v175
    v_mfma_f32_16x16x32_bf16 v[28:31], v[224:227], v[156:159], v[28:31]
    v_add_f32 v231, v231, v183
    v_mfma_f32_16x16x32_bf16 v[60:63], v[224:227], v[164:167], v[60:63]
    ds_read_b128 v[220:223], v244 offset:33792
    v_cvt_pk_bf16_f32 v173, v174, v175
    v_cvt_pk_bf16_f32 v181, v182, v183
VAR_34_j:
    s_cmp_eq_u32 s24, 1
    s_cbranch_scc1 VAR_35_t
VAR_35_j:
    s_cmp_eq_u32 s24, 2
    s_cbranch_scc1 VAR_36_t
    s_waitcnt lgkmcnt(6)
    v_mfma_f32_16x16x32_bf16 v[156:159], v[196:199], v[96:99], v[144:147]
    v_exp_f32 v176, v176
    v_mfma_f32_16x16x32_bf16 v[164:167], v[196:199], v[112:115], v[148:151]
    ds_read_b128 v[224:227], v245 offset:33792
    v_exp_f32 v184, v184
    s_waitcnt lgkmcnt(6)
    v_mfma_f32_16x16x32_bf16 v[156:159], v[200:203], v[100:103], v[156:159]
    v_exp_f32 v177, v177
    v_mfma_f32_16x16x32_bf16 v[164:167], v[200:203], v[116:119], v[164:167]
    ds_read_b64_tr_b16 v[196:197], v234 offset:32768
    ds_read_b64_tr_b16 v[198:199], v234 offset:33792
    v_exp_f32 v185, v185
    s_waitcnt lgkmcnt(7)
    v_mfma_f32_16x16x32_bf16 v[156:159], v[204:207], v[104:107], v[156:159]
    v_add_f32 v228, v228, v176
    v_mfma_f32_16x16x32_bf16 v[164:167], v[204:207], v[120:123], v[164:167]
    ds_read_b64_tr_b16 v[200:201], v235 offset:32768
    ds_read_b64_tr_b16 v[202:203], v235 offset:33792
    v_add_f32 v230, v230, v184
    s_waitcnt lgkmcnt(8)
    v_mfma_f32_16x16x32_bf16 v[156:159], v[208:211], v[108:111], v[156:159]
    v_exp_f32 v178, v178
    v_mfma_f32_16x16x32_bf16 v[164:167], v[208:211], v[124:127], v[164:167]
    ds_read_b64_tr_b16 v[204:205], v236 offset:32768
    ds_read_b64_tr_b16 v[206:207], v236 offset:33792
    v_exp_f32 v186, v186
    s_waitcnt lgkmcnt(9)
    v_mfma_f32_16x16x32_bf16 v[160:163], v[212:215], v[96:99], v[144:147]
    v_add_f32 v229, v229, v177
    v_add_f32 v231, v231, v185
    v_mfma_f32_16x16x32_bf16 v[168:171], v[212:215], v[112:115], v[148:151]
    ds_read_b64_tr_b16 v[208:209], v237 offset:32768
    ds_read_b64_tr_b16 v[210:211], v237 offset:33792
    v_exp_f32 v179, v179
    s_waitcnt lgkmcnt(10)
    v_mfma_f32_16x16x32_bf16 v[160:163], v[216:219], v[100:103], v[160:163]
    v_exp_f32 v187, v187
    v_mfma_f32_16x16x32_bf16 v[168:171], v[216:219], v[116:119], v[168:171]
    ds_read_b64_tr_b16 v[212:213], v238 offset:32768
    ds_read_b64_tr_b16 v[214:215], v238 offset:33792
    v_cvt_pk_bf16_f32 v174, v176, v177
    s_waitcnt lgkmcnt(11)
    v_mfma_f32_16x16x32_bf16 v[160:163], v[220:223], v[104:107], v[160:163]
    v_cvt_pk_bf16_f32 v182, v184, v185
    v_add_f32 v228, v228, v178
    v_mfma_f32_16x16x32_bf16 v[168:171], v[220:223], v[120:123], v[168:171]
    ds_read_b64_tr_b16 v[216:217], v239 offset:32768
    ds_read_b64_tr_b16 v[218:219], v239 offset:33792
    v_add_f32 v230, v230, v186
    v_add_f32 v229, v229, v179
    s_waitcnt lgkmcnt(12)
    v_mfma_f32_16x16x32_bf16 v[160:163], v[224:227], v[108:111], v[160:163]
    v_add_f32 v231, v231, v187
    v_mfma_f32_16x16x32_bf16 v[168:171], v[224:227], v[124:127], v[168:171]
    ds_read_b64_tr_b16 v[220:221], v240 offset:32768
    ds_read_b64_tr_b16 v[222:223], v240 offset:33792
    v_cvt_pk_bf16_f32 v175, v178, v179
    v_cvt_pk_bf16_f32 v183, v186, v187
VAR_36_j:
    s_cmp_eq_u32 s24, 1
    s_cbranch_scc1 VAR_37_t
    s_waitcnt lgkmcnt(12)
    v_mfma_f32_16x16x32_bf16 v[0:3], v[196:199], v[172:175], v[0:3]
    v_exp_f32 v156, v156
    v_mfma_f32_16x16x32_bf16 v[32:35], v[196:199], v[180:183], v[32:35]
    ds_read_b64_tr_b16 v[224:225], v241 offset:32768
    ds_read_b64_tr_b16 v[226:227], v241 offset:33792
    v_exp_f32 v164, v164
    s_waitcnt lgkmcnt(12)
    v_mfma_f32_16x16x32_bf16 v[4:7], v[200:203], v[172:175], v[4:7]
    v_exp_f32 v157, v157
    v_mfma_f32_16x16x32_bf16 v[36:39], v[200:203], v[180:183], v[36:39]
    v_exp_f32 v165, v165
    s_waitcnt lgkmcnt(10)
    v_mfma_f32_16x16x32_bf16 v[8:11], v[204:207], v[172:175], v[8:11]
    v_add_f32 v228, v228, v156
    v_mfma_f32_16x16x32_bf16 v[40:43], v[204:207], v[180:183], v[40:43]
    v_add_f32 v230, v230, v164
    s_waitcnt lgkmcnt(8)
    v_mfma_f32_16x16x32_bf16 v[12:15], v[208:211], v[172:175], v[12:15]
    v_exp_f32 v158, v158
    v_mfma_f32_16x16x32_bf16 v[44:47], v[208:211], v[180:183], v[44:47]
    s_waitcnt vmcnt(5) lgkmcnt(0)
    s_barrier
    ds_read_b128 v[196:199], v242
    ds_read_b128 v[200:203], v243
    ds_read_b128 v[204:207], v244
    v_exp_f32 v166, v166
    v_mfma_f32_16x16x32_bf16 v[16:19], v[212:215], v[172:175], v[16:19]
    s_add_u32 m0, s25, 57344
    s_nop 0
    buffer_load_dwordx4 v246, s[8:11], s26 offen nt lds
    v_add_f32 v229, v229, v157
    v_add_f32 v231, v231, v165
    v_mfma_f32_16x16x32_bf16 v[48:51], v[212:215], v[180:183], v[48:51]
    buffer_load_dwordx4 v246, s[8:11], s26 offen offset:1024 nt lds
    s_add_u32 s26, s26, 8192
    ds_read_b128 v[208:211], v245
    v_exp_f32 v159, v159
    v_mfma_f32_16x16x32_bf16 v[20:23], v[216:219], v[172:175], v[20:23]
    s_add_u32 m0, s25, 16384
    s_nop 0
    buffer_load_dwordx4 v247, s[12:15], s27 offen nt lds
    v_exp_f32 v167, v167
    v_mfma_f32_16x16x32_bf16 v[52:55], v[216:219], v[180:183], v[52:55]
    buffer_load_dwordx4 v247, s[12:15], s27 offen offset:1024 nt lds
    s_add_u32 s27, s27, 8192
    ds_read_b128 v[212:215], v242 offset:1024
    v_cvt_pk_bf16_f32 v156, v156, v157
    v_mfma_f32_16x16x32_bf16 v[24:27], v[220:223], v[172:175], v[24:27]
    v_cvt_pk_bf16_f32 v164, v164, v165
    v_add_f32 v228, v228, v158
    v_mfma_f32_16x16x32_bf16 v[56:59], v[220:223], v[180:183], v[56:59]
    ds_read_b128 v[216:219], v243 offset:1024
    v_add_f32 v230, v230, v166
    v_add_f32 v229, v229, v159
    v_mfma_f32_16x16x32_bf16 v[28:31], v[224:227], v[172:175], v[28:31]
    v_add_f32 v231, v231, v167
    v_mfma_f32_16x16x32_bf16 v[60:63], v[224:227], v[180:183], v[60:63]
    ds_read_b128 v[220:223], v244 offset:1024
    v_cvt_pk_bf16_f32 v157, v158, v159
    v_cvt_pk_bf16_f32 v165, v166, v167
VAR_37_j:
    s_waitcnt vmcnt(8)
    v_readfirstlane_b32 s70, v252
    s_nop 0
    s_cmp_lg_u32 s70, 0
    s_cbranch_scc1 NONCE_OK
    s_mov_b32 s62, 0
NONCE_LOOP:
    buffer_load_dword v252, v251, s[16:19], 0 offen sc1
    s_waitcnt vmcnt(0)
    v_readfirstlane_b32 s70, v252
    s_add_u32 s62, s62, 1
    s_nop 3
    s_cmp_lg_u32 s70, 0
    s_cbranch_scc1 NONCE_OK
    s_sleep 8
    s_cmp_lt_u32 s62, 0x100000
    s_cbranch_scc1 NONCE_LOOP
NONCE_OK:
    s_mov_b32 s16, s56
    s_and_b32 s17, s57, 0xffff
    s_mov_b32 s18, 268435456
    s_mov_b32 s19, 0x20000
    s_getreg_b32 s36, hwreg(HW_REG_XCC_ID, 0, 4)
    s_lshl_b32 s36, s36, 28
    s_xor_b32 s36, s36, s70
    s_lshl_b32 s37, s60, 3
    s_add_u32 s37, s37, s58
    s_lshl_b32 s37, s37, 2
    s_add_u32 s37, s37, s76
    s_lshl_b32 s37, s37, 6
    s_add_u32 s37, s37, 67141632
    s_lshl_b32 s61, s77, 2
    s_add_u32 s61, s61, s37
    v_mov_b32 v253, s36
    s_cmp_eq_u32 s24, 0
    s_cselect_b32 exec_lo, 1, 0
    s_mov_b32 exec_hi, 0
    buffer_store_dword v253, v251, s[16:19], s61 offen sc1
    s_mov_b64 exec, -1
    s_cmp_eq_u32 s24, 2
    s_cbranch_scc1 VAR_38_t
VAR_38_j:
    s_cmp_eq_u32 s24, 3
    s_cbranch_scc1 VAR_39_t
    s_waitcnt lgkmcnt(6)
    v_mfma_f32_16x16x32_bf16 v[172:175], v[196:199], v[96:99], v[144:147]
    v_exp_f32 v160, v160
    v_mfma_f32_16x16x32_bf16 v[180:183], v[196:199], v[112:115], v[148:151]
    ds_read_b128 v[224:227], v245 offset:1024
    v_exp_f32 v168, v168
    s_waitcnt lgkmcnt(6)
    v_mfma_f32_16x16x32_bf16 v[172:175], v[200:203], v[100:103], v[172:175]
    v_exp_f32 v161, v161
    v_mfma_f32_16x16x32_bf16 v[180:183], v[200:203], v[116:119], v[180:183]
    ds_read_b64_tr_b16 v[196:197], v234
    ds_read_b64_tr_b16 v[198:199], v234 offset:1024
    v_exp_f32 v169, v169
    s_waitcnt lgkmcnt(7)
    v_mfma_f32_16x16x32_bf16 v[172:175], v[204:207], v[104:107], v[172:175]
    v_add_f32 v228, v228, v160
    v_mfma_f32_16x16x32_bf16 v[180:183], v[204:207], v[120:123], v[180:183]
    ds_read_b64_tr_b16 v[200:201], v235
    ds_read_b64_tr_b16 v[202:203], v235 offset:1024
    v_add_f32 v230, v230, v168
    s_waitcnt lgkmcnt(8)
    v_mfma_f32_16x16x32_bf16 v[172:175], v[208:211], v[108:111], v[172:175]
    v_exp_f32 v162, v162
    v_mfma_f32_16x16x32_bf16 v[180:183], v[208:211], v[124:127], v[180:183]
    ds_read_b64_tr_b16 v[204:205], v236
    ds_read_b64_tr_b16 v[206:207], v236 offset:1024
    v_exp_f32 v170, v170
    s_waitcnt lgkmcnt(9)
    v_mfma_f32_16x16x32_bf16 v[176:179], v[212:215], v[96:99], v[144:147]
    v_add_f32 v229, v229, v161
    v_add_f32 v231, v231, v169
    v_mfma_f32_16x16x32_bf16 v[184:187], v[212:215], v[112:115], v[148:151]
    ds_read_b64_tr_b16 v[208:209], v237
    ds_read_b64_tr_b16 v[210:211], v237 offset:1024
    v_exp_f32 v163, v163
    s_waitcnt lgkmcnt(10)
    v_mfma_f32_16x16x32_bf16 v[176:179], v[216:219], v[100:103], v[176:179]
    v_exp_f32 v171, v171
    v_mfma_f32_16x16x32_bf16 v[184:187], v[216:219], v[116:119], v[184:187]
    ds_read_b64_tr_b16 v[212:213], v238
    ds_read_b64_tr_b16 v[214:215], v238 offset:1024
    v_cvt_pk_bf16_f32 v158, v160, v161
    s_waitcnt lgkmcnt(11)
    v_mfma_f32_16x16x32_bf16 v[176:179], v[220:223], v[104:107], v[176:179]
    v_cvt_pk_bf16_f32 v166, v168, v169
    v_add_f32 v228, v228, v162
    v_mfma_f32_16x16x32_bf16 v[184:187], v[220:223], v[120:123], v[184:187]
    ds_read_b64_tr_b16 v[216:217], v239
    ds_read_b64_tr_b16 v[218:219], v239 offset:1024
    v_add_f32 v230, v230, v170
    v_add_f32 v229, v229, v163
    s_waitcnt lgkmcnt(12)
    v_mfma_f32_16x16x32_bf16 v[176:179], v[224:227], v[108:111], v[176:179]
    v_add_f32 v231, v231, v171
    v_mfma_f32_16x16x32_bf16 v[184:187], v[224:227], v[124:127], v[184:187]
    ds_read_b64_tr_b16 v[220:221], v240
    ds_read_b64_tr_b16 v[222:223], v240 offset:1024
    v_cvt_pk_bf16_f32 v159, v162, v163
    v_cvt_pk_bf16_f32 v167, v170, v171
VAR_39_j:
    s_cmp_eq_u32 s24, 2
    s_cbranch_scc1 VAR_40_t
    s_waitcnt lgkmcnt(12)
    v_mfma_f32_16x16x32_bf16 v[0:3], v[196:199], v[156:159], v[0:3]
    v_exp_f32 v172, v172
    v_mfma_f32_16x16x32_bf16 v[32:35], v[196:199], v[164:167], v[32:35]
    ds_read_b64_tr_b16 v[224:225], v241
    ds_read_b64_tr_b16 v[226:227], v241 offset:1024
    v_exp_f32 v180, v180
    s_waitcnt lgkmcnt(12)
    v_mfma_f32_16x16x32_bf16 v[4:7], v[200:203], v[156:159], v[4:7]
    v_exp_f32 v173, v173
    v_mfma_f32_16x16x32_bf16 v[36:39], v[200:203], v[164:167], v[36:39]
    v_exp_f32 v181, v181
    s_waitcnt lgkmcnt(10)
    v_mfma_f32_16x16x32_bf16 v[8:11], v[204:207], v[156:159], v[8:11]
    v_add_f32 v228, v228, v172
    v_mfma_f32_16x16x32_bf16 v[40:43], v[204:207], v[164:167], v[40:43]
    v_add_f32 v230, v230, v180
    s_waitcnt lgkmcnt(8)
    v_mfma_f32_16x16x32_bf16 v[12:15], v[208:211], v[156:159], v[12:15]
    v_exp_f32 v174, v174
    v_mfma_f32_16x16x32_bf16 v[44:47], v[208:211], v[164:167], v[44:47]
    s_waitcnt vmcnt(5) lgkmcnt(0)
    s_barrier
    ds_read_b128 v[196:199], v242 offset:8192
    ds_read_b128 v[200:203], v243 offset:8192
    ds_read_b128 v[204:207], v244 offset:8192
    v_exp_f32 v182, v182
    v_mfma_f32_16x16x32_bf16 v[16:19], v[212:215], v[156:159], v[16:19]
    s_add_u32 m0, s25, 65536
    s_nop 0
    buffer_load_dwordx4 v246, s[8:11], s26 offen nt lds
    v_add_f32 v229, v229, v173
    v_add_f32 v231, v231, v181
    v_mfma_f32_16x16x32_bf16 v[48:51], v[212:215], v[164:167], v[48:51]
    buffer_load_dwordx4 v246, s[8:11], s26 offen offset:1024 nt lds
    s_add_u32 s26, s26, 8192
    ds_read_b128 v[208:211], v245 offset:8192
    v_exp_f32 v175, v175
    v_mfma_f32_16x16x32_bf16 v[20:23], v[216:219], v[156:159], v[20:23]
    s_add_u32 m0, s25, 24576
    s_nop 0
    buffer_load_dwordx4 v247, s[12:15], s27 offen nt lds
    v_exp_f32 v183, v183
    v_mfma_f32_16x16x32_bf16 v[52:55], v[216:219], v[164:167], v[52:55]
    buffer_load_dwordx4 v247, s[12:15], s27 offen offset:1024 nt lds
    s_add_u32 s27, s27, 8192
    ds_read_b128 v[212:215], v242 offset:9216
    v_cvt_pk_bf16_f32 v172, v172, v173
    v_mfma_f32_16x16x32_bf16 v[24:27], v[220:223], v[156:159], v[24:27]
    v_cvt_pk_bf16_f32 v180, v180, v181
    v_add_f32 v228, v228, v174
    v_mfma_f32_16x16x32_bf16 v[56:59], v[220:223], v[164:167], v[56:59]
    ds_read_b128 v[216:219], v243 offset:9216
    v_add_f32 v230, v230, v182
    v_add_f32 v229, v229, v175
    v_mfma_f32_16x16x32_bf16 v[28:31], v[224:227], v[156:159], v[28:31]
    v_add_f32 v231, v231, v183
    v_mfma_f32_16x16x32_bf16 v[60:63], v[224:227], v[164:167], v[60:63]
    ds_read_b128 v[220:223], v244 offset:9216
    v_cvt_pk_bf16_f32 v173, v174, v175
    v_cvt_pk_bf16_f32 v181, v182, v183
VAR_40_j:
    s_cmp_eq_u32 s24, 3
    s_cbranch_scc1 VAR_41_t
VAR_41_j:
    s_cmp_eq_u32 s24, 0
    s_cbranch_scc1 VAR_42_t
    s_waitcnt lgkmcnt(6)
    v_mfma_f32_16x16x32_bf16 v[156:159], v[196:199], v[96:99], v[144:147]
    v_exp_f32 v176, v176
    v_mfma_f32_16x16x32_bf16 v[164:167], v[196:199], v[112:115], v[148:151]
    ds_read_b128 v[224:227], v245 offset:9216
    v_exp_f32 v184, v184
    s_waitcnt lgkmcnt(6)
    v_mfma_f32_16x16x32_bf16 v[156:159], v[200:203], v[100:103], v[156:159]
    v_exp_f32 v177, v177
    v_mfma_f32_16x16x32_bf16 v[164:167], v[200:203], v[116:119], v[164:167]
    ds_read_b64_tr_b16 v[196:197], v234 offset:8192
    ds_read_b64_tr_b16 v[198:199], v234 offset:9216
    v_exp_f32 v185, v185
    s_waitcnt lgkmcnt(7)
    v_mfma_f32_16x16x32_bf16 v[156:159], v[204:207], v[104:107], v[156:159]
    v_add_f32 v228, v228, v176
    v_mfma_f32_16x16x32_bf16 v[164:167], v[204:207], v[120:123], v[164:167]
    ds_read_b64_tr_b16 v[200:201], v235 offset:8192
    ds_read_b64_tr_b16 v[202:203], v235 offset:9216
    v_add_f32 v230, v230, v184
    s_waitcnt lgkmcnt(8)
    v_mfma_f32_16x16x32_bf16 v[156:159], v[208:211], v[108:111], v[156:159]
    v_exp_f32 v178, v178
    v_mfma_f32_16x16x32_bf16 v[164:167], v[208:211], v[124:127], v[164:167]
    ds_read_b64_tr_b16 v[204:205], v236 offset:8192
    ds_read_b64_tr_b16 v[206:207], v236 offset:9216
    v_exp_f32 v186, v186
    s_waitcnt lgkmcnt(9)
    v_mfma_f32_16x16x32_bf16 v[160:163], v[212:215], v[96:99], v[144:147]
    v_add_f32 v229, v229, v177
    v_add_f32 v231, v231, v185
    v_mfma_f32_16x16x32_bf16 v[168:171], v[212:215], v[112:115], v[148:151]
    ds_read_b64_tr_b16 v[208:209], v237 offset:8192
    ds_read_b64_tr_b16 v[210:211], v237 offset:9216
    v_exp_f32 v179, v179
    s_waitcnt lgkmcnt(10)
    v_mfma_f32_16x16x32_bf16 v[160:163], v[216:219], v[100:103], v[160:163]
    v_exp_f32 v187, v187
    v_mfma_f32_16x16x32_bf16 v[168:171], v[216:219], v[116:119], v[168:171]
    ds_read_b64_tr_b16 v[212:213], v238 offset:8192
    ds_read_b64_tr_b16 v[214:215], v238 offset:9216
    v_cvt_pk_bf16_f32 v174, v176, v177
    s_waitcnt lgkmcnt(11)
    v_mfma_f32_16x16x32_bf16 v[160:163], v[220:223], v[104:107], v[160:163]
    v_cvt_pk_bf16_f32 v182, v184, v185
    v_add_f32 v228, v228, v178
    v_mfma_f32_16x16x32_bf16 v[168:171], v[220:223], v[120:123], v[168:171]
    ds_read_b64_tr_b16 v[216:217], v239 offset:8192
    ds_read_b64_tr_b16 v[218:219], v239 offset:9216
    v_add_f32 v230, v230, v186
    v_add_f32 v229, v229, v179
    s_waitcnt lgkmcnt(12)
    v_mfma_f32_16x16x32_bf16 v[160:163], v[224:227], v[108:111], v[160:163]
    v_add_f32 v231, v231, v187
    v_mfma_f32_16x16x32_bf16 v[168:171], v[224:227], v[124:127], v[168:171]
    ds_read_b64_tr_b16 v[220:221], v240 offset:8192
    ds_read_b64_tr_b16 v[222:223], v240 offset:9216
    v_cvt_pk_bf16_f32 v175, v178, v179
    v_cvt_pk_bf16_f32 v183, v186, v187
VAR_42_j:
    s_cmp_eq_u32 s24, 3
    s_cbranch_scc1 VAR_43_t
    s_waitcnt lgkmcnt(12)
    v_mfma_f32_16x16x32_bf16 v[0:3], v[196:199], v[172:175], v[0:3]
    v_exp_f32 v156, v156
    v_mfma_f32_16x16x32_bf16 v[32:35], v[196:199], v[180:183], v[32:35]
    ds_read_b64_tr_b16 v[224:225], v241 offset:8192
    ds_read_b64_tr_b16 v[226:227], v241 offset:9216
    v_exp_f32 v164, v164
    s_waitcnt lgkmcnt(12)
    v_mfma_f32_16x16x32_bf16 v[4:7], v[200:203], v[172:175], v[4:7]
    v_exp_f32 v157, v157
    v_mfma_f32_16x16x32_bf16 v[36:39], v[200:203], v[180:183], v[36:39]
    v_exp_f32 v165, v165
    s_waitcnt lgkmcnt(10)
    v_mfma_f32_16x16x32_bf16 v[8:11], v[204:207], v[172:175], v[8:11]
    v_add_f32 v228, v228, v156
    v_mfma_f32_16x16x32_bf16 v[40:43], v[204:207], v[180:183], v[40:43]
    v_add_f32 v230, v230, v164
    s_waitcnt lgkmcnt(8)
    v_mfma_f32_16x16x32_bf16 v[12:15], v[208:211], v[172:175], v[12:15]
    v_exp_f32 v158, v158
    v_mfma_f32_16x16x32_bf16 v[44:47], v[208:211], v[180:183], v[44:47]
    s_waitcnt vmcnt(5) lgkmcnt(0)
    s_barrier
    ds_read_b128 v[196:199], v242 offset:16384
    ds_read_b128 v[200:203], v243 offset:16384
    ds_read_b128 v[204:207], v244 offset:16384
    v_exp_f32 v166, v166
    v_mfma_f32_16x16x32_bf16 v[16:19], v[212:215], v[172:175], v[16:19]
    s_add_u32 m0, s25, 73728
    s_nop 0
    buffer_load_dwordx4 v246, s[8:11], s26 offen nt lds
    v_add_f32 v229, v229, v157
    v_add_f32 v231, v231, v165
    v_mfma_f32_16x16x32_bf16 v[48:51], v[212:215], v[180:183], v[48:51]
    buffer_load_dwordx4 v246, s[8:11], s26 offen offset:1024 nt lds
    s_add_u32 s26, s26, 8192
    ds_read_b128 v[208:211], v245 offset:16384
    v_exp_f32 v159, v159
    v_mfma_f32_16x16x32_bf16 v[20:23], v[216:219], v[172:175], v[20:23]
    s_add_u32 m0, s25, 32768
    s_nop 0
    buffer_load_dwordx4 v247, s[12:15], s27 offen nt lds
    v_exp_f32 v167, v167
    v_mfma_f32_16x16x32_bf16 v[52:55], v[216:219], v[180:183], v[52:55]
    buffer_load_dwordx4 v247, s[12:15], s27 offen offset:1024 nt lds
    s_add_u32 s27, s27, 8192
    ds_read_b128 v[212:215], v242 offset:17408
    v_cvt_pk_bf16_f32 v156, v156, v157
    v_mfma_f32_16x16x32_bf16 v[24:27], v[220:223], v[172:175], v[24:27]
    v_cvt_pk_bf16_f32 v164, v164, v165
    v_add_f32 v228, v228, v158
    v_mfma_f32_16x16x32_bf16 v[56:59], v[220:223], v[180:183], v[56:59]
    ds_read_b128 v[216:219], v243 offset:17408
    v_add_f32 v230, v230, v166
    v_add_f32 v229, v229, v159
    v_mfma_f32_16x16x32_bf16 v[28:31], v[224:227], v[172:175], v[28:31]
    v_add_f32 v231, v231, v167
    v_mfma_f32_16x16x32_bf16 v[60:63], v[224:227], v[180:183], v[60:63]
    ds_read_b128 v[220:223], v244 offset:17408
    v_cvt_pk_bf16_f32 v157, v158, v159
    v_cvt_pk_bf16_f32 v165, v166, v167
VAR_43_j:
    s_cmp_eq_u32 s24, 0
    s_cbranch_scc1 VAR_44_t
VAR_44_j:
    s_cmp_eq_u32 s24, 1
    s_cbranch_scc1 VAR_45_t
    s_waitcnt lgkmcnt(6)
    v_mfma_f32_16x16x32_bf16 v[172:175], v[196:199], v[96:99], v[144:147]
    v_exp_f32 v160, v160
    v_mfma_f32_16x16x32_bf16 v[180:183], v[196:199], v[112:115], v[148:151]
    ds_read_b128 v[224:227], v245 offset:17408
    v_exp_f32 v168, v168
    s_waitcnt lgkmcnt(6)
    v_mfma_f32_16x16x32_bf16 v[172:175], v[200:203], v[100:103], v[172:175]
    v_exp_f32 v161, v161
    v_mfma_f32_16x16x32_bf16 v[180:183], v[200:203], v[116:119], v[180:183]
    ds_read_b64_tr_b16 v[196:197], v234 offset:16384
    ds_read_b64_tr_b16 v[198:199], v234 offset:17408
    v_exp_f32 v169, v169
    s_waitcnt lgkmcnt(7)
    v_mfma_f32_16x16x32_bf16 v[172:175], v[204:207], v[104:107], v[172:175]
    v_add_f32 v228, v228, v160
    v_mfma_f32_16x16x32_bf16 v[180:183], v[204:207], v[120:123], v[180:183]
    ds_read_b64_tr_b16 v[200:201], v235 offset:16384
    ds_read_b64_tr_b16 v[202:203], v235 offset:17408
    v_add_f32 v230, v230, v168
    s_waitcnt lgkmcnt(8)
    v_mfma_f32_16x16x32_bf16 v[172:175], v[208:211], v[108:111], v[172:175]
    v_exp_f32 v162, v162
    v_mfma_f32_16x16x32_bf16 v[180:183], v[208:211], v[124:127], v[180:183]
    ds_read_b64_tr_b16 v[204:205], v236 offset:16384
    ds_read_b64_tr_b16 v[206:207], v236 offset:17408
    v_exp_f32 v170, v170
    s_waitcnt lgkmcnt(9)
    v_mfma_f32_16x16x32_bf16 v[176:179], v[212:215], v[96:99], v[144:147]
    v_add_f32 v229, v229, v161
    v_add_f32 v231, v231, v169
    v_mfma_f32_16x16x32_bf16 v[184:187], v[212:215], v[112:115], v[148:151]
    ds_read_b64_tr_b16 v[208:209], v237 offset:16384
    ds_read_b64_tr_b16 v[210:211], v237 offset:17408
    v_exp_f32 v163, v163
    s_waitcnt lgkmcnt(10)
    v_mfma_f32_16x16x32_bf16 v[176:179], v[216:219], v[100:103], v[176:179]
    v_exp_f32 v171, v171
    v_mfma_f32_16x16x32_bf16 v[184:187], v[216:219], v[116:119], v[184:187]
    ds_read_b64_tr_b16 v[212:213], v238 offset:16384
    ds_read_b64_tr_b16 v[214:215], v238 offset:17408
    v_cvt_pk_bf16_f32 v158, v160, v161
    s_waitcnt lgkmcnt(11)
    v_mfma_f32_16x16x32_bf16 v[176:179], v[220:223], v[104:107], v[176:179]
    v_cvt_pk_bf16_f32 v166, v168, v169
    v_add_f32 v228, v228, v162
    v_mfma_f32_16x16x32_bf16 v[184:187], v[220:223], v[120:123], v[184:187]
    ds_read_b64_tr_b16 v[216:217], v239 offset:16384
    ds_read_b64_tr_b16 v[218:219], v239 offset:17408
    v_add_f32 v230, v230, v170
    v_add_f32 v229, v229, v163
    s_waitcnt lgkmcnt(12)
    v_mfma_f32_16x16x32_bf16 v[176:179], v[224:227], v[108:111], v[176:179]
    v_add_f32 v231, v231, v171
    v_mfma_f32_16x16x32_bf16 v[184:187], v[224:227], v[124:127], v[184:187]
    ds_read_b64_tr_b16 v[220:221], v240 offset:16384
    ds_read_b64_tr_b16 v[222:223], v240 offset:17408
    v_cvt_pk_bf16_f32 v159, v162, v163
    v_cvt_pk_bf16_f32 v167, v170, v171
VAR_45_j:
    s_cmp_eq_u32 s24, 0
    s_cbranch_scc1 VAR_46_t
    s_waitcnt lgkmcnt(12)
    v_mfma_f32_16x16x32_bf16 v[0:3], v[196:199], v[156:159], v[0:3]
    v_exp_f32 v172, v172
    v_mfma_f32_16x16x32_bf16 v[32:35], v[196:199], v[164:167], v[32:35]
    ds_read_b64_tr_b16 v[224:225], v241 offset:16384
    ds_read_b64_tr_b16 v[226:227], v241 offset:17408
    v_exp_f32 v180, v180
    s_waitcnt lgkmcnt(12)
    v_mfma_f32_16x16x32_bf16 v[4:7], v[200:203], v[156:159], v[4:7]
    v_exp_f32 v173, v173
    v_mfma_f32_16x16x32_bf16 v[36:39], v[200:203], v[164:167], v[36:39]
    v_exp_f32 v181, v181
    s_waitcnt lgkmcnt(10)
    v_mfma_f32_16x16x32_bf16 v[8:11], v[204:207], v[156:159], v[8:11]
    v_add_f32 v228, v228, v172
    v_mfma_f32_16x16x32_bf16 v[40:43], v[204:207], v[164:167], v[40:43]
    v_add_f32 v230, v230, v180
    s_waitcnt lgkmcnt(8)
    v_mfma_f32_16x16x32_bf16 v[12:15], v[208:211], v[156:159], v[12:15]
    v_exp_f32 v174, v174
    v_mfma_f32_16x16x32_bf16 v[44:47], v[208:211], v[164:167], v[44:47]
    s_waitcnt vmcnt(4) lgkmcnt(0)
    s_barrier
    ds_read_b128 v[196:199], v242 offset:24576
    ds_read_b128 v[200:203], v243 offset:24576
    ds_read_b128 v[204:207], v244 offset:24576
    v_exp_f32 v182, v182
    v_mfma_f32_16x16x32_bf16 v[16:19], v[212:215], v[156:159], v[16:19]
    s_add_u32 m0, s25, 0
    s_nop 0
    buffer_load_dwordx4 v247, s[12:15], s27 offen nt lds
    v_add_f32 v229, v229, v173
    v_add_f32 v231, v231, v181
    v_mfma_f32_16x16x32_bf16 v[48:51], v[212:215], v[164:167], v[48:51]
    buffer_load_dwordx4 v247, s[12:15], s27 offen offset:1024 nt lds
    s_add_u32 s27, s27, 8192
    ds_read_b128 v[208:211], v245 offset:24576
    v_exp_f32 v175, v175
    v_mfma_f32_16x16x32_bf16 v[20:23], v[216:219], v[156:159], v[20:23]
    v_exp_f32 v183, v183
    v_mfma_f32_16x16x32_bf16 v[52:55], v[216:219], v[164:167], v[52:55]
    ds_read_b128 v[212:215], v242 offset:25600
    v_cvt_pk_bf16_f32 v172, v172, v173
    v_mfma_f32_16x16x32_bf16 v[24:27], v[220:223], v[156:159], v[24:27]
    v_cvt_pk_bf16_f32 v180, v180, v181
    v_add_f32 v228, v228, v174
    v_mfma_f32_16x16x32_bf16 v[56:59], v[220:223], v[164:167], v[56:59]
    ds_read_b128 v[216:219], v243 offset:25600
    v_add_f32 v230, v230, v182
    v_add_f32 v229, v229, v175
    v_mfma_f32_16x16x32_bf16 v[28:31], v[224:227], v[156:159], v[28:31]
    v_add_f32 v231, v231, v183
    v_mfma_f32_16x16x32_bf16 v[60:63], v[224:227], v[164:167], v[60:63]
    ds_read_b128 v[220:223], v244 offset:25600
    v_cvt_pk_bf16_f32 v173, v174, v175
    v_cvt_pk_bf16_f32 v181, v182, v183
VAR_46_j:
    s_cmp_eq_u32 s24, 1
    s_cbranch_scc1 VAR_47_t
VAR_47_j:
    s_cmp_eq_u32 s24, 2
    s_cbranch_scc1 VAR_48_t
    s_waitcnt lgkmcnt(6)
    v_mfma_f32_16x16x32_bf16 v[156:159], v[196:199], v[96:99], v[144:147]
    v_exp_f32 v176, v176
    v_mfma_f32_16x16x32_bf16 v[164:167], v[196:199], v[112:115], v[148:151]
    ds_read_b128 v[224:227], v245 offset:25600
    v_exp_f32 v184, v184
    s_waitcnt lgkmcnt(6)
    v_mfma_f32_16x16x32_bf16 v[156:159], v[200:203], v[100:103], v[156:159]
    v_exp_f32 v177, v177
    v_mfma_f32_16x16x32_bf16 v[164:167], v[200:203], v[116:119], v[164:167]
    ds_read_b64_tr_b16 v[196:197], v234 offset:24576
    ds_read_b64_tr_b16 v[198:199], v234 offset:25600
    v_exp_f32 v185, v185
    s_waitcnt lgkmcnt(7)
    v_mfma_f32_16x16x32_bf16 v[156:159], v[204:207], v[104:107], v[156:159]
    v_add_f32 v228, v228, v176
    v_mfma_f32_16x16x32_bf16 v[164:167], v[204:207], v[120:123], v[164:167]
    ds_read_b64_tr_b16 v[200:201], v235 offset:24576
    ds_read_b64_tr_b16 v[202:203], v235 offset:25600
    v_add_f32 v230, v230, v184
    s_waitcnt lgkmcnt(8)
    v_mfma_f32_16x16x32_bf16 v[156:159], v[208:211], v[108:111], v[156:159]
    v_exp_f32 v178, v178
    v_mfma_f32_16x16x32_bf16 v[164:167], v[208:211], v[124:127], v[164:167]
    ds_read_b64_tr_b16 v[204:205], v236 offset:24576
    ds_read_b64_tr_b16 v[206:207], v236 offset:25600
    v_exp_f32 v186, v186
    s_waitcnt lgkmcnt(9)
    v_mfma_f32_16x16x32_bf16 v[160:163], v[212:215], v[96:99], v[144:147]
    v_add_f32 v229, v229, v177
    v_add_f32 v231, v231, v185
    v_mfma_f32_16x16x32_bf16 v[168:171], v[212:215], v[112:115], v[148:151]
    ds_read_b64_tr_b16 v[208:209], v237 offset:24576
    ds_read_b64_tr_b16 v[210:211], v237 offset:25600
    v_exp_f32 v179, v179
    s_waitcnt lgkmcnt(10)
    v_mfma_f32_16x16x32_bf16 v[160:163], v[216:219], v[100:103], v[160:163]
    v_exp_f32 v187, v187
    v_mfma_f32_16x16x32_bf16 v[168:171], v[216:219], v[116:119], v[168:171]
    ds_read_b64_tr_b16 v[212:213], v238 offset:24576
    ds_read_b64_tr_b16 v[214:215], v238 offset:25600
    v_cvt_pk_bf16_f32 v174, v176, v177
    s_waitcnt lgkmcnt(11)
    v_mfma_f32_16x16x32_bf16 v[160:163], v[220:223], v[104:107], v[160:163]
    v_cvt_pk_bf16_f32 v182, v184, v185
    v_add_f32 v228, v228, v178
    v_mfma_f32_16x16x32_bf16 v[168:171], v[220:223], v[120:123], v[168:171]
    ds_read_b64_tr_b16 v[216:217], v239 offset:24576
    ds_read_b64_tr_b16 v[218:219], v239 offset:25600
    v_add_f32 v230, v230, v186
    v_add_f32 v229, v229, v179
    s_waitcnt lgkmcnt(12)
    v_mfma_f32_16x16x32_bf16 v[160:163], v[224:227], v[108:111], v[160:163]
    v_add_f32 v231, v231, v187
    v_mfma_f32_16x16x32_bf16 v[168:171], v[224:227], v[124:127], v[168:171]
    ds_read_b64_tr_b16 v[220:221], v240 offset:24576
    ds_read_b64_tr_b16 v[222:223], v240 offset:25600
    v_cvt_pk_bf16_f32 v175, v178, v179
    v_cvt_pk_bf16_f32 v183, v186, v187
VAR_48_j:
    s_cmp_eq_u32 s24, 1
    s_cbranch_scc1 VAR_49_t
    s_waitcnt lgkmcnt(12)
    v_mfma_f32_16x16x32_bf16 v[0:3], v[196:199], v[172:175], v[0:3]
    v_exp_f32 v156, v156
    v_mfma_f32_16x16x32_bf16 v[32:35], v[196:199], v[180:183], v[32:35]
    ds_read_b64_tr_b16 v[224:225], v241 offset:24576
    ds_read_b64_tr_b16 v[226:227], v241 offset:25600
    v_exp_f32 v164, v164
    s_waitcnt lgkmcnt(12)
    v_mfma_f32_16x16x32_bf16 v[4:7], v[200:203], v[172:175], v[4:7]
    v_exp_f32 v157, v157
    v_mfma_f32_16x16x32_bf16 v[36:39], v[200:203], v[180:183], v[36:39]
    v_exp_f32 v165, v165
    s_waitcnt lgkmcnt(10)
    v_mfma_f32_16x16x32_bf16 v[8:11], v[204:207], v[172:175], v[8:11]
    v_add_f32 v228, v228, v156
    v_mfma_f32_16x16x32_bf16 v[40:43], v[204:207], v[180:183], v[40:43]
    v_add_f32 v230, v230, v164
    s_waitcnt lgkmcnt(8)
    v_mfma_f32_16x16x32_bf16 v[12:15], v[208:211], v[172:175], v[12:15]
    v_exp_f32 v158, v158
    v_mfma_f32_16x16x32_bf16 v[44:47], v[208:211], v[180:183], v[44:47]
    s_waitcnt vmcnt(2) lgkmcnt(0)
    s_barrier
    ds_read_b128 v[196:199], v242 offset:32768
    ds_read_b128 v[200:203], v243 offset:32768
    ds_read_b128 v[204:207], v244 offset:32768
    v_exp_f32 v166, v166
    v_mfma_f32_16x16x32_bf16 v[16:19], v[212:215], v[172:175], v[16:19]
    v_add_f32 v229, v229, v157
    v_add_f32 v231, v231, v165
    v_mfma_f32_16x16x32_bf16 v[48:51], v[212:215], v[180:183], v[48:51]
    ds_read_b128 v[208:211], v245 offset:32768
    v_exp_f32 v159, v159
    v_mfma_f32_16x16x32_bf16 v[20:23], v[216:219], v[172:175], v[20:23]
    v_exp_f32 v167, v167
    v_mfma_f32_16x16x32_bf16 v[52:55], v[216:219], v[180:183], v[52:55]
    ds_read_b128 v[212:215], v242 offset:33792
    v_cvt_pk_bf16_f32 v156, v156, v157
    v_mfma_f32_16x16x32_bf16 v[24:27], v[220:223], v[172:175], v[24:27]
    v_cvt_pk_bf16_f32 v164, v164, v165
    v_add_f32 v228, v228, v158
    v_mfma_f32_16x16x32_bf16 v[56:59], v[220:223], v[180:183], v[56:59]
    ds_read_b128 v[216:219], v243 offset:33792
    v_add_f32 v230, v230, v166
    v_add_f32 v229, v229, v159
    v_mfma_f32_16x16x32_bf16 v[28:31], v[224:227], v[172:175], v[28:31]
    v_add_f32 v231, v231, v167
    v_mfma_f32_16x16x32_bf16 v[60:63], v[224:227], v[180:183], v[60:63]
    ds_read_b128 v[220:223], v244 offset:33792
    v_cvt_pk_bf16_f32 v157, v158, v159
    v_cvt_pk_bf16_f32 v165, v166, v167
VAR_49_j:
    v_and_b32 v251, 7, v248
    v_lshlrev_b32 v251, 2, v251
    buffer_load_dword v252, v251, s[16:19], s37 offen sc1
    s_cmp_eq_u32 s24, 2
    s_cbranch_scc1 VAR_50_t
VAR_50_j:
    s_cmp_eq_u32 s24, 3
    s_cbranch_scc1 VAR_51_t
    s_waitcnt lgkmcnt(6)
    v_mfma_f32_16x16x32_bf16 v[172:175], v[196:199], v[96:99], v[144:147]
    v_exp_f32 v160, v160
    v_mfma_f32_16x16x32_bf16 v[180:183], v[196:199], v[112:115], v[148:151]
    ds_read_b128 v[224:227], v245 offset:33792
    v_exp_f32 v168, v168
    s_waitcnt lgkmcnt(6)
    v_mfma_f32_16x16x32_bf16 v[172:175], v[200:203], v[100:103], v[172:175]
    v_exp_f32 v161, v161
    v_mfma_f32_16x16x32_bf16 v[180:183], v[200:203], v[116:119], v[180:183]
    ds_read_b64_tr_b16 v[196:197], v234 offset:32768
    ds_read_b64_tr_b16 v[198:199], v234 offset:33792
    v_exp_f32 v169, v169
    s_waitcnt lgkmcnt(7)
    v_mfma_f32_16x16x32_bf16 v[172:175], v[204:207], v[104:107], v[172:175]
    v_add_f32 v228, v228, v160
    v_mfma_f32_16x16x32_bf16 v[180:183], v[204:207], v[120:123], v[180:183]
    ds_read_b64_tr_b16 v[200:201], v235 offset:32768
    ds_read_b64_tr_b16 v[202:203], v235 offset:33792
    v_add_f32 v230, v230, v168
    s_waitcnt lgkmcnt(8)
    v_mfma_f32_16x16x32_bf16 v[172:175], v[208:211], v[108:111], v[172:175]
    v_exp_f32 v162, v162
    v_mfma_f32_16x16x32_bf16 v[180:183], v[208:211], v[124:127], v[180:183]
    ds_read_b64_tr_b16 v[204:205], v236 offset:32768
    ds_read_b64_tr_b16 v[206:207], v236 offset:33792
    v_exp_f32 v170, v170
    s_waitcnt lgkmcnt(9)
    v_mfma_f32_16x16x32_bf16 v[176:179], v[212:215], v[96:99], v[144:147]
    v_add_f32 v229, v229, v161
    v_add_f32 v231, v231, v169
    v_mfma_f32_16x16x32_bf16 v[184:187], v[212:215], v[112:115], v[148:151]
    ds_read_b64_tr_b16 v[208:209], v237 offset:32768
    ds_read_b64_tr_b16 v[210:211], v237 offset:33792
    v_exp_f32 v163, v163
    s_waitcnt lgkmcnt(10)
    v_mfma_f32_16x16x32_bf16 v[176:179], v[216:219], v[100:103], v[176:179]
    v_exp_f32 v171, v171
    v_mfma_f32_16x16x32_bf16 v[184:187], v[216:219], v[116:119], v[184:187]
    ds_read_b64_tr_b16 v[212:213], v238 offset:32768
    ds_read_b64_tr_b16 v[214:215], v238 offset:33792
    v_cvt_pk_bf16_f32 v158, v160, v161
    s_waitcnt lgkmcnt(11)
    v_mfma_f32_16x16x32_bf16 v[176:179], v[220:223], v[104:107], v[176:179]
    v_cvt_pk_bf16_f32 v166, v168, v169
    v_add_f32 v228, v228, v162
    v_mfma_f32_16x16x32_bf16 v[184:187], v[220:223], v[120:123], v[184:187]
    ds_read_b64_tr_b16 v[216:217], v239 offset:32768
    ds_read_b64_tr_b16 v[218:219], v239 offset:33792
    v_add_f32 v230, v230, v170
    v_add_f32 v229, v229, v163
    s_waitcnt lgkmcnt(12)
    v_mfma_f32_16x16x32_bf16 v[176:179], v[224:227], v[108:111], v[176:179]
    v_add_f32 v231, v231, v171
    v_mfma_f32_16x16x32_bf16 v[184:187], v[224:227], v[124:127], v[184:187]
    ds_read_b64_tr_b16 v[220:221], v240 offset:32768
    ds_read_b64_tr_b16 v[222:223], v240 offset:33792
    v_cvt_pk_bf16_f32 v159, v162, v163
    v_cvt_pk_bf16_f32 v167, v170, v171
VAR_51_j:
    s_cmp_eq_u32 s24, 2
    s_cbranch_scc1 VAR_52_t
    s_waitcnt lgkmcnt(12)
    v_mfma_f32_16x16x32_bf16 v[0:3], v[196:199], v[156:159], v[0:3]
    v_exp_f32 v172, v172
    v_mfma_f32_16x16x32_bf16 v[32:35], v[196:199], v[164:167], v[32:35]
    ds_read_b64_tr_b16 v[224:225], v241 offset:32768
    ds_read_b64_tr_b16 v[226:227], v241 offset:33792
    v_exp_f32 v180, v180
    s_waitcnt lgkmcnt(12)
    v_mfma_f32_16x16x32_bf16 v[4:7], v[200:203], v[156:159], v[4:7]
    v_exp_f32 v173, v173
    v_mfma_f32_16x16x32_bf16 v[36:39], v[200:203], v[164:167], v[36:39]
    v_exp_f32 v181, v181
    s_waitcnt lgkmcnt(10)
    v_mfma_f32_16x16x32_bf16 v[8:11], v[204:207], v[156:159], v[8:11]
    v_add_f32 v228, v228, v172
    v_mfma_f32_16x16x32_bf16 v[40:43], v[204:207], v[164:167], v[40:43]
    v_add_f32 v230, v230, v180
    s_waitcnt lgkmcnt(8)
    v_mfma_f32_16x16x32_bf16 v[12:15], v[208:211], v[156:159], v[12:15]
    v_exp_f32 v174, v174
    v_mfma_f32_16x16x32_bf16 v[44:47], v[208:211], v[164:167], v[44:47]
    s_waitcnt vmcnt(1) lgkmcnt(0)
    s_barrier
    ds_read_b64_tr_b16 v[196:197], v234
    ds_read_b64_tr_b16 v[198:199], v234 offset:1024
    ds_read_b64_tr_b16 v[200:201], v235
    ds_read_b64_tr_b16 v[202:203], v235 offset:1024
    ds_read_b64_tr_b16 v[204:205], v236
    ds_read_b64_tr_b16 v[206:207], v236 offset:1024
    v_exp_f32 v182, v182
    v_mfma_f32_16x16x32_bf16 v[16:19], v[212:215], v[156:159], v[16:19]
    v_add_f32 v229, v229, v173
    v_add_f32 v231, v231, v181
    v_mfma_f32_16x16x32_bf16 v[48:51], v[212:215], v[164:167], v[48:51]
    ds_read_b64_tr_b16 v[208:209], v237
    ds_read_b64_tr_b16 v[210:211], v237 offset:1024
    v_exp_f32 v175, v175
    v_mfma_f32_16x16x32_bf16 v[20:23], v[216:219], v[156:159], v[20:23]
    v_exp_f32 v183, v183
    v_mfma_f32_16x16x32_bf16 v[52:55], v[216:219], v[164:167], v[52:55]
    ds_read_b64_tr_b16 v[212:213], v238
    ds_read_b64_tr_b16 v[214:215], v238 offset:1024
    v_cvt_pk_bf16_f32 v172, v172, v173
    v_mfma_f32_16x16x32_bf16 v[24:27], v[220:223], v[156:159], v[24:27]
    v_cvt_pk_bf16_f32 v180, v180, v181
    v_add_f32 v228, v228, v174
    v_mfma_f32_16x16x32_bf16 v[56:59], v[220:223], v[164:167], v[56:59]
    ds_read_b64_tr_b16 v[216:217], v239
    ds_read_b64_tr_b16 v[218:219], v239 offset:1024
    v_add_f32 v230, v230, v182
    v_add_f32 v229, v229, v175
    v_mfma_f32_16x16x32_bf16 v[28:31], v[224:227], v[156:159], v[28:31]
    v_add_f32 v231, v231, v183
    v_mfma_f32_16x16x32_bf16 v[60:63], v[224:227], v[164:167], v[60:63]
    ds_read_b64_tr_b16 v[220:221], v240
    ds_read_b64_tr_b16 v[222:223], v240 offset:1024
    v_cvt_pk_bf16_f32 v173, v174, v175
    v_cvt_pk_bf16_f32 v181, v182, v183
VAR_52_j:
    s_cmp_eq_u32 s24, 3
    s_cbranch_scc1 VAR_53_t
VAR_53_j:
    v_exp_f32 v176, v176
    v_exp_f32 v184, v184
    v_exp_f32 v177, v177
    v_exp_f32 v185, v185
    v_add_f32 v228, v228, v176
    v_add_f32 v230, v230, v184
    v_exp_f32 v178, v178
    v_exp_f32 v186, v186
    v_add_f32 v229, v229, v177
    v_add_f32 v231, v231, v185
    v_exp_f32 v179, v179
    v_exp_f32 v187, v187
    v_cvt_pk_bf16_f32 v174, v176, v177
    v_cvt_pk_bf16_f32 v182, v184, v185
    v_add_f32 v228, v228, v178
    v_add_f32 v230, v230, v186
    v_add_f32 v229, v229, v179
    v_add_f32 v231, v231, v187
    v_cvt_pk_bf16_f32 v175, v178, v179
    v_cvt_pk_bf16_f32 v183, v186, v187
    s_cmp_eq_u32 s24, 3
    s_cbranch_scc1 VAR_54_t
    s_waitcnt lgkmcnt(12)
    v_mfma_f32_16x16x32_bf16 v[0:3], v[196:199], v[172:175], v[0:3]
    v_mfma_f32_16x16x32_bf16 v[32:35], v[196:199], v[180:183], v[32:35]
    ds_read_b64_tr_b16 v[224:225], v241
    ds_read_b64_tr_b16 v[226:227], v241 offset:1024
    s_waitcnt lgkmcnt(12)
    v_mfma_f32_16x16x32_bf16 v[4:7], v[200:203], v[172:175], v[4:7]
    v_mfma_f32_16x16x32_bf16 v[36:39], v[200:203], v[180:183], v[36:39]
    s_waitcnt lgkmcnt(10)
    v_mfma_f32_16x16x32_bf16 v[8:11], v[204:207], v[172:175], v[8:11]
    v_mfma_f32_16x16x32_bf16 v[40:43], v[204:207], v[180:183], v[40:43]
    s_waitcnt lgkmcnt(8)
    v_mfma_f32_16x16x32_bf16 v[12:15], v[208:211], v[172:175], v[12:15]
    v_mfma_f32_16x16x32_bf16 v[44:47], v[208:211], v[180:183], v[44:47]
    s_waitcnt lgkmcnt(6)
    v_mfma_f32_16x16x32_bf16 v[16:19], v[212:215], v[172:175], v[16:19]
    v_mfma_f32_16x16x32_bf16 v[48:51], v[212:215], v[180:183], v[48:51]
    s_waitcnt lgkmcnt(4)
    v_mfma_f32_16x16x32_bf16 v[20:23], v[216:219], v[172:175], v[20:23]
    v_mfma_f32_16x16x32_bf16 v[52:55], v[216:219], v[180:183], v[52:55]
    s_waitcnt lgkmcnt(2)
    v_mfma_f32_16x16x32_bf16 v[24:27], v[220:223], v[172:175], v[24:27]
    v_mfma_f32_16x16x32_bf16 v[56:59], v[220:223], v[180:183], v[56:59]
    s_waitcnt lgkmcnt(0)
    v_mfma_f32_16x16x32_bf16 v[28:31], v[224:227], v[172:175], v[28:31]
    v_mfma_f32_16x16x32_bf16 v[60:63], v[224:227], v[180:183], v[60:63]
VAR_54_j:
    s_waitcnt vmcnt(0)
    v_cmp_ne_u32 vcc, s36, v252
    s_nop 0
    s_cmp_eq_u64 vcc, 0
    s_cselect_b32 s38, 1, 0
    s_and_b32 s61, s24, 1
    s_lshl_b32 s61, s61, 13
    s_lshr_b32 s62, s24, 1
    s_mul_i32 s62, s62, 40960
    s_add_u32 s61, s61, s62
    v_lshlrev_b32 v251, 4, v248
    v_add_f32 v228, v228, v229
    v_add_f32 v230, v230, v231
    v_add_f32 v232, v232, v233
    s_lshl_b32 s62, s32, 5
    s_add_u32 s62, s62, s61
    v_add_u32 v156, s62, v251
    s_lshl_b32 s62, s33, 5
    s_add_u32 s62, s62, s61
    v_add_u32 v157, s62, v251
    s_lshl_b32 s62, s34, 5
    s_add_u32 s62, s62, s61
    v_add_u32 v158, s62, v251
    s_lshl_b32 s62, s35, 5
    s_add_u32 s62, s62, s61
    v_add_u32 v159, s62, v251
    v_mov_b32 v164, v228
    v_mov_b32 v165, v230
    v_mov_b32 v166, v232
    v_permlane16_swap_b32 v228, v164
    v_permlane16_swap_b32 v230, v165
    v_permlane16_swap_b32 v232, v166
    v_add_f32 v228, v228, v164
    v_add_f32 v230, v230, v165
    v_add_f32 v232, v232, v166
    v_mov_b32 v164, v228
    v_mov_b32 v165, v230
    v_mov_b32 v166, v232
    v_permlane32_swap_b32 v228, v164
    v_permlane32_swap_b32 v230, v165
    v_permlane32_swap_b32 v232, v166
    v_add_f32 v228, v228, v164
    v_add_f32 v230, v230, v165
    v_add_f32 v232, v232, v166
    ds_write_b128 v156, v[64:67] offset:16384
    ds_write_b128 v156, v[68:71] offset:17408
    ds_write_b128 v157, v[72:75] offset:16384
    ds_write_b128 v157, v[76:79] offset:17408
    ds_write_b128 v158, v[80:83] offset:16384
    ds_write_b128 v158, v[84:87] offset:17408
    ds_write_b128 v159, v[88:91] offset:16384
    ds_write_b128 v159, v[92:95] offset:17408
    v_mov_b32 v188, v152
    v_mov_b32 v189, v232
    s_lshl_b32 s62, s24, 9
    v_lshlrev_b32 v252, 3, v248
    v_add_u32 v254, s62, v252
    ds_write_b64 v254, v[188:189] offset:8192
    s_lshl_b32 s61, s32, 4
    v_add_u32 v180, s61, v251
    s_lshl_b32 s61, s33, 4
    v_add_u32 v181, s61, v251
    s_lshl_b32 s61, s34, 4
    v_add_u32 v182, s61, v251
    s_lshl_b32 s61, s35, 4
    v_add_u32 v183, s61, v251
    s_mul_i32 s65, s60, 9437184
    s_lshl_b32 s61, s59, 12
    s_add_u32 s65, s65, s61
    v_rcp_f32 v172, v228
    v_rcp_f32 v174, v230
    v_mov_b32 v176, 0
    v_mov_b32 v177, 0
    v_mov_b32 v178, 0
    v_mov_b32 v179, 0
    v_mov_b32 v173, v172
    v_mov_b32 v175, v174
    s_lshl_b32 s61, s29, 3
    s_add_u32 s61, s61, s65
    v_pk_mul_f32 v[0:1], v[0:1], v[172:173]
    v_pk_mul_f32 v[2:3], v[2:3], v[172:173]
    v_pk_mul_f32 v[4:5], v[4:5], v[172:173]
    v_pk_mul_f32 v[6:7], v[6:7], v[172:173]
    v_cvt_pk_bf16_f32 v0, v0, v1
    v_cvt_pk_bf16_f32 v1, v2, v3
    v_cvt_pk_bf16_f32 v2, v4, v5
    v_cvt_pk_bf16_f32 v3, v6, v7
    s_cmp_eq_u32 s38, 0
    s_cbranch_scc1 VAR_55_t
    buffer_store_dwordx4 v[0:3], v180, s[20:23], s61 offen
VAR_55_j:
    v_mfma_f32_16x16x32_bf16 v[196:199], v[176:179], v[0:3], 0
    v_pk_mul_f32 v[8:9], v[8:9], v[172:173]
    v_pk_mul_f32 v[10:11], v[10:11], v[172:173]
    v_pk_mul_f32 v[12:13], v[12:13], v[172:173]
    v_pk_mul_f32 v[14:15], v[14:15], v[172:173]
    v_cvt_pk_bf16_f32 v8, v8, v9
    v_cvt_pk_bf16_f32 v9, v10, v11
    v_cvt_pk_bf16_f32 v10, v12, v13
    v_cvt_pk_bf16_f32 v11, v14, v15
    s_cmp_eq_u32 s38, 0
    s_cbranch_scc1 VAR_56_t
    buffer_store_dwordx4 v[8:11], v181, s[20:23], s61 offen
VAR_56_j:
    v_mfma_f32_16x16x32_bf16 v[196:199], v[176:179], v[8:11], v[196:199]
    v_pk_mul_f32 v[16:17], v[16:17], v[172:173]
    v_pk_mul_f32 v[18:19], v[18:19], v[172:173]
    v_pk_mul_f32 v[20:21], v[20:21], v[172:173]
    v_pk_mul_f32 v[22:23], v[22:23], v[172:173]
    v_cvt_pk_bf16_f32 v16, v16, v17
    v_cvt_pk_bf16_f32 v17, v18, v19
    v_cvt_pk_bf16_f32 v18, v20, v21
    v_cvt_pk_bf16_f32 v19, v22, v23
    s_cmp_eq_u32 s38, 0
    s_cbranch_scc1 VAR_57_t
    buffer_store_dwordx4 v[16:19], v182, s[20:23], s61 offen
VAR_57_j:
    v_mfma_f32_16x16x32_bf16 v[196:199], v[176:179], v[16:19], v[196:199]
    v_pk_mul_f32 v[24:25], v[24:25], v[172:173]
    v_pk_mul_f32 v[26:27], v[26:27], v[172:173]
    v_pk_mul_f32 v[28:29], v[28:29], v[172:173]
    v_pk_mul_f32 v[30:31], v[30:31], v[172:173]
    v_cvt_pk_bf16_f32 v24, v24, v25
    v_cvt_pk_bf16_f32 v25, v26, v27
    v_cvt_pk_bf16_f32 v26, v28, v29
    v_cvt_pk_bf16_f32 v27, v30, v31
    s_cmp_eq_u32 s38, 0
    s_cbranch_scc1 VAR_58_t
    buffer_store_dwordx4 v[24:27], v183, s[20:23], s61 offen
VAR_58_j:
    v_mfma_f32_16x16x32_bf16 v[196:199], v[176:179], v[24:27], v[196:199]
    s_lshl_b32 s61, s30, 3
    s_add_u32 s61, s61, s65
    v_pk_mul_f32 v[32:33], v[32:33], v[174:175]
    v_pk_mul_f32 v[34:35], v[34:35], v[174:175]
    v_pk_mul_f32 v[36:37], v[36:37], v[174:175]
    v_pk_mul_f32 v[38:39], v[38:39], v[174:175]
    v_cvt_pk_bf16_f32 v32, v32, v33
    v_cvt_pk_bf16_f32 v33, v34, v35
    v_cvt_pk_bf16_f32 v34, v36, v37
    v_cvt_pk_bf16_f32 v35, v38, v39
    s_cmp_eq_u32 s38, 0
    s_cbranch_scc1 VAR_59_t
    buffer_store_dwordx4 v[32:35], v180, s[20:23], s61 offen
VAR_59_j:
    v_mfma_f32_16x16x32_bf16 v[196:199], v[176:179], v[32:35], v[196:199]
    v_pk_mul_f32 v[40:41], v[40:41], v[174:175]
    v_pk_mul_f32 v[42:43], v[42:43], v[174:175]
    v_pk_mul_f32 v[44:45], v[44:45], v[174:175]
    v_pk_mul_f32 v[46:47], v[46:47], v[174:175]
    v_cvt_pk_bf16_f32 v40, v40, v41
    v_cvt_pk_bf16_f32 v41, v42, v43
    v_cvt_pk_bf16_f32 v42, v44, v45
    v_cvt_pk_bf16_f32 v43, v46, v47
    s_cmp_eq_u32 s38, 0
    s_cbranch_scc1 VAR_60_t
    buffer_store_dwordx4 v[40:43], v181, s[20:23], s61 offen
VAR_60_j:
    v_mfma_f32_16x16x32_bf16 v[196:199], v[176:179], v[40:43], v[196:199]
    v_pk_mul_f32 v[48:49], v[48:49], v[174:175]
    v_pk_mul_f32 v[50:51], v[50:51], v[174:175]
    v_pk_mul_f32 v[52:53], v[52:53], v[174:175]
    v_pk_mul_f32 v[54:55], v[54:55], v[174:175]
    v_cvt_pk_bf16_f32 v48, v48, v49
    v_cvt_pk_bf16_f32 v49, v50, v51
    v_cvt_pk_bf16_f32 v50, v52, v53
    v_cvt_pk_bf16_f32 v51, v54, v55
    s_cmp_eq_u32 s38, 0
    s_cbranch_scc1 VAR_61_t
    buffer_store_dwordx4 v[48:51], v182, s[20:23], s61 offen
VAR_61_j:
    v_mfma_f32_16x16x32_bf16 v[196:199], v[176:179], v[48:51], v[196:199]
    v_pk_mul_f32 v[56:57], v[56:57], v[174:175]
    v_pk_mul_f32 v[58:59], v[58:59], v[174:175]
    v_pk_mul_f32 v[60:61], v[60:61], v[174:175]
    v_pk_mul_f32 v[62:63], v[62:63], v[174:175]
    v_cvt_pk_bf16_f32 v56, v56, v57
    v_cvt_pk_bf16_f32 v57, v58, v59
    v_cvt_pk_bf16_f32 v58, v60, v61
    v_cvt_pk_bf16_f32 v59, v62, v63
    s_cmp_eq_u32 s38, 0
    s_cbranch_scc1 VAR_62_t
    buffer_store_dwordx4 v[56:59], v183, s[20:23], s61 offen
VAR_62_j:
    v_mfma_f32_16x16x32_bf16 v[196:199], v[176:179], v[56:59], v[196:199]
    v_pk_mul_f32 v[200:201], v[64:65], v[176:177]
    v_pk_fma_f32 v[200:201], v[66:67], v[176:177], v[200:201]
    v_pk_fma_f32 v[200:201], v[68:69], v[176:177], v[200:201]
    v_pk_fma_f32 v[200:201], v[70:71], v[176:177], v[200:201]
    v_pk_fma_f32 v[200:201], v[72:73], v[176:177], v[200:201]
    v_pk_fma_f32 v[200:201], v[74:75], v[176:177], v[200:201]
    v_pk_fma_f32 v[200:201], v[76:77], v[176:177], v[200:201]
    v_pk_fma_f32 v[200:201], v[78:79], v[176:177], v[200:201]
    v_pk_fma_f32 v[200:201], v[80:81], v[176:177], v[200:201]
    v_pk_fma_f32 v[200:201], v[82:83], v[176:177], v[200:201]
    v_pk_fma_f32 v[200:201], v[84:85], v[176:177], v[200:201]
    v_pk_fma_f32 v[200:201], v[86:87], v[176:177], v[200:201]
    v_pk_fma_f32 v[200:201], v[88:89], v[176:177], v[200:201]
    v_pk_fma_f32 v[200:201], v[90:91], v[176:177], v[200:201]
    v_pk_fma_f32 v[200:201], v[92:93], v[176:177], v[200:201]
    v_pk_fma_f32 v[200:201], v[94:95], v[176:177], v[200:201]
    v_add_f32 v200, v200, v201
    v_add_f32 v200, v200, v228
    v_add_f32 v200, v200, v230
    v_add_f32 v200, v200, v232
    v_add_f32 v200, v200, v196
    s_mov_b32 s61, 0x4e800000
    v_cmp_ngt_f32 vcc, s61, v200
    s_lshl_b32 s62, s24, 2
    v_mov_b32 v254, s62
    s_cmp_lg_u64 vcc, 0
    s_cselect_b32 s61, 1, 0
    v_mov_b32 v190, s61
    ds_write_b32 v254, v190 offset:10240
    v_mov_b32 v191, s70
    ds_write_b32 v254, v191 offset:10256
    s_waitcnt lgkmcnt(0)
    s_barrier
    v_mov_b32 v254, 0
    ds_read_b128 v[196:199], v254 offset:10240
    ds_read_b32 v212, v254 offset:10256
    ds_read_b64 v[200:201], v252 offset:8192
    ds_read_b64 v[202:203], v252 offset:8704
    ds_read_b64 v[204:205], v252 offset:9216
    ds_read_b64 v[206:207], v252 offset:9728
    s_add_u32 s62, s25, 16384
    v_add_u32 v254, s62, v251
    ds_read_b128 v[64:67], v254
    ds_read_b128 v[68:71], v254 offset:1024
    ds_read_b128 v[72:75], v254 offset:8192
    ds_read_b128 v[76:79], v254 offset:9216
    ds_read_b128 v[80:83], v254 offset:40960
    ds_read_b128 v[84:87], v254 offset:41984
    ds_read_b128 v[88:91], v254 offset:49152
    ds_read_b128 v[92:95], v254 offset:50176
    s_waitcnt lgkmcnt(13)
    v_or3_b32 v196, v196, v197, v198
    v_or_b32 v196, v196, v199
    s_waitcnt lgkmcnt(12)
    v_readfirstlane_b32 s70, v212
    v_readfirstlane_b32 s61, v196
    s_nop 0
    s_sub_u32 s61, s61, s63
    s_cmp_eq_u32 s61, 1
    s_cbranch_scc1 K1_FALLBACK
    s_waitcnt lgkmcnt(9)
    v_min3_f32 v208, v200, v202, v204
    s_waitcnt lgkmcnt(8)
    v_min_f32 v208, v208, v206
    v_sub_f32 v200, v208, v200
    v_sub_f32 v202, v208, v202
    v_sub_f32 v204, v208, v204
    v_sub_f32 v206, v208, v206
    v_exp_f32 v200, v200
    v_exp_f32 v202, v202
    v_exp_f32 v204, v204
    v_exp_f32 v206, v206
    v_mul_f32 v209, v200, v201
    v_fmac_f32 v209, v202, v203
    v_fmac_f32 v209, v204, v205
    v_fmac_f32 v209, v206, v207
    v_rcp_f32 v209, v209
    s_waitcnt lgkmcnt(7)
    v_mul_f32 v64, v200, v64
    s_waitcnt lgkmcnt(5)
    v_fmac_f32 v64, v202, v72
    s_waitcnt lgkmcnt(3)
    v_fmac_f32 v64, v204, v80
    s_waitcnt lgkmcnt(1)
    v_fmac_f32 v64, v206, v88
    v_mul_f32 v65, v200, v65
    v_fmac_f32 v65, v202, v73
    v_fmac_f32 v65, v204, v81
    v_fmac_f32 v65, v206, v89
    v_mul_f32 v66, v200, v66
    v_fmac_f32 v66, v202, v74
    v_fmac_f32 v66, v204, v82
    v_fmac_f32 v66, v206, v90
    v_mul_f32 v67, v200, v67
    v_fmac_f32 v67, v202, v75
    v_fmac_f32 v67, v204, v83
    v_fmac_f32 v67, v206, v91
    v_mul_f32 v68, v200, v68
    v_fmac_f32 v68, v202, v76
    v_fmac_f32 v68, v204, v84
    s_waitcnt lgkmcnt(0)
    v_fmac_f32 v68, v206, v92
    v_mul_f32 v69, v200, v69
    v_fmac_f32 v69, v202, v77
    v_fmac_f32 v69, v204, v85
    v_fmac_f32 v69, v206, v93
    v_mul_f32 v70, v200, v70
    v_fmac_f32 v70, v202, v78
    v_fmac_f32 v70, v204, v86
    v_fmac_f32 v70, v206, v94
    v_mul_f32 v71, v200, v71
    v_fmac_f32 v71, v202, v79
    v_fmac_f32 v71, v204, v87
    v_fmac_f32 v71, v206, v95
    v_mul_f32 v64, v209, v64
    v_mul_f32 v65, v209, v65
    v_mul_f32 v66, v209, v66
    v_mul_f32 v67, v209, v67
    v_mul_f32 v68, v209, v68
    v_mul_f32 v69, v209, v69
    v_mul_f32 v70, v209, v70
    v_mul_f32 v71, v209, v71
    v_cvt_pk_bf16_f32 v64, v64, v65
    v_cvt_pk_bf16_f32 v65, v66, v67
    v_cvt_pk_bf16_f32 v66, v68, v69
    v_cvt_pk_bf16_f32 v67, v70, v71
    s_lshl_b32 s61, s31, 3
    s_add_u32 s61, s61, s65
    s_cmp_eq_u32 s38, 0
    s_cbranch_scc1 VAR_63_t
    buffer_store_dwordx4 v[64:67], v180, s[20:23], s61 offen
VAR_63_j:
    s_lshl_b32 s61, s60, 3
    s_add_u32 s63, s58, s61
    s_cmp_eq_u32 s60, 1
    s_cselect_b32 s4, s54, s44
    s_cselect_b32 s5, s55, s45
    s_mov_b32 s6, 4194304
    s_mov_b32 s7, 0x20000
    s_mov_b32 s8, s56
    s_and_b32 s9, s57, 0xffff
    s_mov_b32 s10, 18874368
    s_mov_b32 s11, 0x20000
    s_mov_b32 s12, s56
    s_and_b32 s13, s57, 0xffff
    s_mov_b32 s14, 268435456
    s_mov_b32 s15, 0x20000
    s_mov_b32 s16, s72
    s_and_b32 s17, s73, 0xffff
    s_mov_b32 s18, 2359296
    s_mov_b32 s19, 0x20000
    s_lshl_b32 s28, s63, 2
    s_add_u32 s28, s28, s76
    s_lshl_b32 s28, s28, 6
    s_add_u32 s28, s28, 67108864
    s_lshl_b32 s61, s77, 2
    s_add_u32 s62, s28, s61
    s_waitcnt vmcnt(0)
    s_barrier
    v_mov_b32 v253, s70
    v_mov_b32 v254, 0
    s_cmp_eq_u32 s24, 0
    s_cselect_b32 exec_lo, 1, 0
    s_mov_b32 exec_hi, 0
    buffer_store_dword v253, v254, s[12:15], s62 offen sc1
    s_mov_b64 exec, -1
    s_setprio 0
    s_lshl_b32 s26, s76, 20
    s_lshl_b32 s61, s77, 7
    s_add_u32 s26, s26, s61
    s_lshl_b32 s66, s24, 12
    s_lshl_b32 s67, s58, 1
    s_mov_b32 s67, 0
    s_add_u32 s67, s67, s77
    v_lshrrev_b32 v251, 3, v248
    v_bfe_u32 v252, v248, 4, 1
    s_and_b32 s61, s24, 1
    s_lshl_b32 s61, s61, 2
    v_or_b32 v252, s61, v252
    v_and_b32 v253, 7, v248
    v_xor_b32 v252, v252, v253
    v_lshlrev_b32 v252, 4, v252
    v_lshl_add_u32 v252, v251, 10, v252
    s_lshl_b32 s61, s24, 13
    v_add_u32 v172, s61, v252
    v_add_u32 v173, 31744, v172
    v_add_u32 v174, 63488, v172
    v_add_u32 v175, 95232, v172
    s_add_u32 s61, s67, 0
    s_and_b32 s61, s61, 7
    s_lshl_b32 s27, s61, 17
    s_add_u32 s27, s27, s26
    s_add_u32 m0, s66, 0
    s_nop 0
    buffer_load_dwordx4 v172, s[4:7], s27 offen lds
    buffer_load_dwordx4 v173, s[4:7], s27 offen offset:1024 lds
    buffer_load_dwordx4 v174, s[4:7], s27 offen offset:2048 lds
    buffer_load_dwordx4 v175, s[4:7], s27 offen offset:3072 lds
    s_add_u32 s61, s67, 1
    s_and_b32 s61, s61, 7
    s_lshl_b32 s27, s61, 17
    s_add_u32 s27, s27, s26
    s_add_u32 m0, s66, 16384
    s_nop 0
    buffer_load_dwordx4 v172, s[4:7], s27 offen lds
    buffer_load_dwordx4 v173, s[4:7], s27 offen offset:1024 lds
    buffer_load_dwordx4 v174, s[4:7], s27 offen offset:2048 lds
    buffer_load_dwordx4 v175, s[4:7], s27 offen offset:3072 lds
    s_add_u32 s61, s67, 2
    s_and_b32 s61, s61, 7
    s_lshl_b32 s27, s61, 17
    s_add_u32 s27, s27, s26
    s_add_u32 m0, s66, 32768
    s_nop 0
    buffer_load_dwordx4 v172, s[4:7], s27 offen lds
    buffer_load_dwordx4 v173, s[4:7], s27 offen offset:1024 lds
    buffer_load_dwordx4 v174, s[4:7], s27 offen offset:2048 lds
    buffer_load_dwordx4 v175, s[4:7], s27 offen offset:3072 lds
    s_mul_i32 s61, s63, 9
    s_lshl_b32 s62, s24, 1
    s_add_u32 s29, s61, s62
    s_add_u32 s30, s29, 1
    s_add_u32 s31, s61, 8
    s_lshl_b32 s61, s76, 15
    s_lshl_b32 s29, s29, 17
    s_add_u32 s29, s29, s61
    s_lshl_b32 s30, s30, 17
    s_add_u32 s30, s30, s61
    s_lshl_b32 s31, s31, 17
    s_add_u32 s31, s31, s61
    s_lshr_b32 s62, s25, 1
    s_add_u32 s31, s31, s62
    v_lshlrev_b32 v176, 4, v248
    v_add_u32 v177, 65536, v176
    v_lshrrev_b32 v251, 2, v250
    v_and_b32 v252, 3, v250
    v_lshrrev_b32 v253, 1, v251
    v_and_b32 v254, 1, v249
    v_lshl_or_b32 v253, v254, 2, v253
    v_xor_b32 v253, v253, v252
    v_lshlrev_b32 v253, 4, v253
    v_and_b32 v252, 1, v252
    v_lshl_or_b32 v253, v252, 3, v253
    v_lshl_or_b32 v253, v251, 7, v253
    v_lshl_or_b32 v253, v249, 12, v253
    v_lshl_or_b32 v253, v254, 9, v253
    s_add_u32 s32, s24, s76
    s_add_u32 s32, s32, 0
    s_and_b32 s32, s32, 3
    s_lshr_b32 s61, s32, 1
    s_lshl_b32 s61, s61, 6
    s_and_b32 s62, s32, 1
    s_lshl_b32 s62, s62, 3
    s_or_b32 s61, s61, s62
    v_xor_b32 v164, s61, v253
    v_xor_b32 v168, 0x200, v164
    s_add_u32 s33, s24, s76
    s_add_u32 s33, s33, 1
    s_and_b32 s33, s33, 3
    s_lshr_b32 s61, s33, 1
    s_lshl_b32 s61, s61, 6
    s_and_b32 s62, s33, 1
    s_lshl_b32 s62, s62, 3
    s_or_b32 s61, s61, s62
    v_xor_b32 v165, s61, v253
    v_xor_b32 v169, 0x200, v165
    s_add_u32 s34, s24, s76
    s_add_u32 s34, s34, 2
    s_and_b32 s34, s34, 3
    s_lshr_b32 s61, s34, 1
    s_lshl_b32 s61, s61, 6
    s_and_b32 s62, s34, 1
    s_lshl_b32 s62, s62, 3
    s_or_b32 s61, s61, s62
    v_xor_b32 v166, s61, v253
    v_xor_b32 v170, 0x200, v166
    s_add_u32 s35, s24, s76
    s_add_u32 s35, s35, 3
    s_and_b32 s35, s35, 3
    s_lshr_b32 s61, s35, 1
    s_lshl_b32 s61, s61, 6
    s_and_b32 s62, s35, 1
    s_lshl_b32 s62, s62, 3
    s_or_b32 s61, s61, s62
    v_xor_b32 v167, s61, v253
    v_xor_b32 v171, 0x200, v167
    v_add_u32 v178, s77, v248
    v_and_b32 v178, 7, v178
    v_lshlrev_b32 v178, 2, v178
    s_mov_b32 s59, 0
    s_add_u32 s61, s67, 0
    s_and_b32 s61, s61, 7
    s_lshl_b32 s61, s61, 12
    s_add_u32 s61, s61, s31
    s_lshr_b32 s62, s25, 1
    s_add_u32 m0, s62, 65536
    s_nop 0
    buffer_load_dwordx4 v176, s[8:11], s61 offen sc1 lds
    s_add_u32 s64, s67, 0
    s_and_b32 s64, s64, 7
    s_lshl_b32 s64, s64, 12
    s_add_u32 s3, s64, s29
    buffer_load_dwordx4 v[68:71], v176, s[8:11], s3 offen sc1
    buffer_load_dwordx4 v[76:79], v176, s[8:11], s3 offen offset:1024 sc1
    buffer_load_dwordx4 v[84:87], v176, s[8:11], s3 offen offset:2048 sc1
    buffer_load_dwordx4 v[92:95], v176, s[8:11], s3 offen offset:3072 sc1
    s_add_u32 s3, s64, s30
    buffer_load_dwordx4 v[72:75], v176, s[8:11], s3 offen sc1
    buffer_load_dwordx4 v[80:83], v176, s[8:11], s3 offen offset:1024 sc1
    buffer_load_dwordx4 v[88:91], v176, s[8:11], s3 offen offset:2048 sc1
    buffer_load_dwordx4 v[96:99], v176, s[8:11], s3 offen offset:3072 sc1
    s_cmp_lg_u32 s24, 0
    s_cbranch_scc1 ENS0_done
    s_mov_b32 s65, 0
ENS0_loop:
    s_and_b32 s61, s59, 6
    s_cmp_eq_u32 s61, 6
    s_cbranch_scc1 ENS0_done
    s_mov_b64 exec, 0xff
    buffer_load_dword v253, v178, s[12:15], s28 offen sc1
    s_waitcnt vmcnt(0)
    v_cmp_eq_u32 vcc, s70, v253
    s_add_u32 s65, s65, 1
    s_mov_b64 exec, -1
    s_nop 1
    s_mov_b32 s59, vcc_lo
    s_sleep 8
    s_cmp_lt_u32 s65, 0x200000
    s_cbranch_scc1 ENS0_loop
ENS0_done:
    s_waitcnt vmcnt(8)
    s_barrier
    s_add_u32 s61, s67, 1
    s_and_b32 s61, s61, 7
    s_lshl_b32 s61, s61, 12
    s_add_u32 s61, s61, s31
    s_lshr_b32 s62, s25, 1
    s_add_u32 m0, s62, 69632
    s_nop 0
    buffer_load_dwordx4 v176, s[8:11], s61 offen sc1 lds
    s_add_u32 s61, s67, 2
    s_and_b32 s61, s61, 7
    s_lshl_b32 s61, s61, 12
    s_add_u32 s61, s61, s31
    s_lshr_b32 s62, s25, 1
    s_add_u32 m0, s62, 73728
    s_nop 0
    buffer_load_dwordx4 v176, s[8:11], s61 offen sc1 lds
    s_add_u32 s64, s67, 1
    s_and_b32 s64, s64, 7
    s_lshl_b32 s64, s64, 12
    s_add_u32 s3, s64, s29
    buffer_load_dwordx4 v[100:103], v176, s[8:11], s3 offen sc1
    buffer_load_dwordx4 v[108:111], v176, s[8:11], s3 offen offset:1024 sc1
    buffer_load_dwordx4 v[116:119], v176, s[8:11], s3 offen offset:2048 sc1
    buffer_load_dwordx4 v[124:127], v176, s[8:11], s3 offen offset:3072 sc1
    s_add_u32 s3, s64, s30
    buffer_load_dwordx4 v[104:107], v176, s[8:11], s3 offen sc1
    buffer_load_dwordx4 v[112:115], v176, s[8:11], s3 offen offset:1024 sc1
    buffer_load_dwordx4 v[120:123], v176, s[8:11], s3 offen offset:2048 sc1
    buffer_load_dwordx4 v[128:131], v176, s[8:11], s3 offen offset:3072 sc1
    ds_read_b128 v[132:135], v177
    ds_read_b128 v[136:139], v177 offset:1024
    ds_read_b128 v[140:143], v177 offset:2048
    ds_read_b128 v[144:147], v177 offset:3072
    ds_read_b64_tr_b16 v[36:37], v164
    ds_read_b64_tr_b16 v[38:39], v168
    ds_read_b64_tr_b16 v[40:41], v165
    ds_read_b64_tr_b16 v[42:43], v169
    ds_read_b64_tr_b16 v[44:45], v166
    ds_read_b64_tr_b16 v[46:47], v170
    ds_read_b64_tr_b16 v[48:49], v167
    ds_read_b64_tr_b16 v[50:51], v171
    ds_read_b64_tr_b16 v[52:53], v164 offset:1024
    ds_read_b64_tr_b16 v[54:55], v168 offset:1024
    ds_read_b64_tr_b16 v[56:57], v165 offset:1024
    s_waitcnt lgkmcnt(14)
    ds_read_b64_tr_b16 v[58:59], v169 offset:1024
    s_waitcnt lgkmcnt(14)
    ds_read_b64_tr_b16 v[60:61], v166 offset:1024
    s_waitcnt lgkmcnt(14)
    ds_read_b64_tr_b16 v[62:63], v170 offset:1024
    s_waitcnt vmcnt(17) lgkmcnt(12)
    v_mfma_f32_16x16x32_bf16 v[0:3], v[36:39], v[68:71], 0
    s_waitcnt vmcnt(13)
    v_mfma_f32_16x16x32_bf16 v[16:19], v[36:39], v[72:75], 0
    v_mfma_f32_16x16x32_bf16 v[32:35], v[36:39], v[132:135], 0
    ds_read_b64_tr_b16 v[64:65], v167 offset:1024
    ds_read_b64_tr_b16 v[66:67], v171 offset:1024
    s_waitcnt lgkmcnt(12)
    v_mfma_f32_16x16x32_bf16 v[4:7], v[40:43], v[68:71], 0
    v_mfma_f32_16x16x32_bf16 v[20:23], v[40:43], v[72:75], 0
    ds_read_b64_tr_b16 v[36:37], v164 offset:2048
    ds_read_b64_tr_b16 v[38:39], v168 offset:2048
    s_waitcnt lgkmcnt(12)
    v_mfma_f32_16x16x32_bf16 v[8:11], v[44:47], v[68:71], 0
    v_mfma_f32_16x16x32_bf16 v[24:27], v[44:47], v[72:75], 0
    ds_read_b64_tr_b16 v[40:41], v165 offset:2048
    ds_read_b64_tr_b16 v[42:43], v169 offset:2048
    s_waitcnt lgkmcnt(12)
    v_mfma_f32_16x16x32_bf16 v[12:15], v[48:51], v[68:71], 0
    v_mfma_f32_16x16x32_bf16 v[28:31], v[48:51], v[72:75], 0
    ds_read_b64_tr_b16 v[44:45], v166 offset:2048
    ds_read_b64_tr_b16 v[46:47], v170 offset:2048
    s_waitcnt lgkmcnt(12)
    v_mfma_f32_16x16x32_bf16 v[0:3], v[52:55], v[76:79], v[0:3]
    s_waitcnt vmcnt(12)
    v_mfma_f32_16x16x32_bf16 v[16:19], v[52:55], v[80:83], v[16:19]
    v_mfma_f32_16x16x32_bf16 v[32:35], v[52:55], v[136:139], v[32:35]
    ds_read_b64_tr_b16 v[48:49], v167 offset:2048
    ds_read_b64_tr_b16 v[50:51], v171 offset:2048
    s_waitcnt lgkmcnt(12)
    v_mfma_f32_16x16x32_bf16 v[4:7], v[56:59], v[76:79], v[4:7]
    v_mfma_f32_16x16x32_bf16 v[20:23], v[56:59], v[80:83], v[20:23]
    ds_read_b64_tr_b16 v[52:53], v164 offset:3072
    ds_read_b64_tr_b16 v[54:55], v168 offset:3072
    s_waitcnt lgkmcnt(12)
    v_mfma_f32_16x16x32_bf16 v[8:11], v[60:63], v[76:79], v[8:11]
    v_mfma_f32_16x16x32_bf16 v[24:27], v[60:63], v[80:83], v[24:27]
    ds_read_b64_tr_b16 v[56:57], v165 offset:3072
    ds_read_b64_tr_b16 v[58:59], v169 offset:3072
    s_waitcnt lgkmcnt(12)
    v_mfma_f32_16x16x32_bf16 v[12:15], v[64:67], v[76:79], v[12:15]
    v_mfma_f32_16x16x32_bf16 v[28:31], v[64:67], v[80:83], v[28:31]
    ds_read_b64_tr_b16 v[60:61], v166 offset:3072
    ds_read_b64_tr_b16 v[62:63], v170 offset:3072
    s_waitcnt lgkmcnt(12)
    v_mfma_f32_16x16x32_bf16 v[0:3], v[36:39], v[84:87], v[0:3]
    s_waitcnt vmcnt(11)
    v_mfma_f32_16x16x32_bf16 v[16:19], v[36:39], v[88:91], v[16:19]
    v_mfma_f32_16x16x32_bf16 v[32:35], v[36:39], v[140:143], v[32:35]
    ds_read_b64_tr_b16 v[64:65], v167 offset:3072
    ds_read_b64_tr_b16 v[66:67], v171 offset:3072
    s_waitcnt lgkmcnt(12)
    v_mfma_f32_16x16x32_bf16 v[4:7], v[40:43], v[84:87], v[4:7]
    v_mfma_f32_16x16x32_bf16 v[20:23], v[40:43], v[88:91], v[20:23]
    s_waitcnt lgkmcnt(10)
    v_mfma_f32_16x16x32_bf16 v[8:11], v[44:47], v[84:87], v[8:11]
    v_mfma_f32_16x16x32_bf16 v[24:27], v[44:47], v[88:91], v[24:27]
    s_waitcnt lgkmcnt(8)
    v_mfma_f32_16x16x32_bf16 v[12:15], v[48:51], v[84:87], v[12:15]
    v_mfma_f32_16x16x32_bf16 v[28:31], v[48:51], v[88:91], v[28:31]
    s_cmp_lg_u32 s24, 0
    s_cbranch_scc1 ENS1_done
    s_mov_b32 s65, 0
ENS1_loop:
    s_and_b32 s61, s59, 8
    s_cmp_eq_u32 s61, 8
    s_cbranch_scc1 ENS1_done
    s_mov_b64 exec, 0xff
    buffer_load_dword v253, v178, s[12:15], s28 offen sc1
    s_waitcnt vmcnt(0)
    v_cmp_eq_u32 vcc, s70, v253
    s_add_u32 s65, s65, 1
    s_mov_b64 exec, -1
    s_nop 1
    s_mov_b32 s59, vcc_lo
    s_sleep 8
    s_cmp_lt_u32 s65, 0x200000
    s_cbranch_scc1 ENS1_loop
ENS1_done:
    s_waitcnt vmcnt(9) lgkmcnt(0)
    s_barrier
    ds_read_b64_tr_b16 v[36:37], v164 offset:16384
    ds_read_b64_tr_b16 v[38:39], v168 offset:16384
    ds_read_b64_tr_b16 v[40:41], v165 offset:16384
    ds_read_b64_tr_b16 v[42:43], v169 offset:16384
    ds_read_b64_tr_b16 v[44:45], v166 offset:16384
    ds_read_b64_tr_b16 v[46:47], v170 offset:16384
    v_mfma_f32_16x16x32_bf16 v[0:3], v[52:55], v[92:95], v[0:3]
    ds_read_b128 v[148:151], v177 offset:4096
    ds_read_b128 v[152:155], v177 offset:5120
    ds_read_b128 v[156:159], v177 offset:6144
    ds_read_b128 v[160:163], v177 offset:7168
    v_mfma_f32_16x16x32_bf16 v[16:19], v[52:55], v[96:99], v[16:19]
    s_add_u32 s61, s67, 3
    s_and_b32 s61, s61, 7
    s_lshl_b32 s61, s61, 12
    s_add_u32 s61, s61, s31
    s_lshr_b32 s62, s25, 1
    s_add_u32 m0, s62, 65536
    s_nop 0
    buffer_load_dwordx4 v176, s[8:11], s61 offen sc1 lds
    v_mfma_f32_16x16x32_bf16 v[32:35], v[52:55], v[144:147], v[32:35]
    s_add_u32 s61, s67, 3
    s_and_b32 s61, s61, 7
    s_lshl_b32 s27, s61, 17
    s_add_u32 s27, s27, s26
    s_add_u32 m0, s66, 0
    s_nop 0
    buffer_load_dwordx4 v172, s[4:7], s27 offen lds
    buffer_load_dwordx4 v173, s[4:7], s27 offen offset:1024 lds
    ds_read_b64_tr_b16 v[48:49], v167 offset:16384
    ds_read_b64_tr_b16 v[50:51], v171 offset:16384
    v_mfma_f32_16x16x32_bf16 v[4:7], v[56:59], v[92:95], v[4:7]
    buffer_load_dwordx4 v174, s[4:7], s27 offen offset:2048 lds
    buffer_load_dwordx4 v175, s[4:7], s27 offen offset:3072 lds
    v_mfma_f32_16x16x32_bf16 v[20:23], v[56:59], v[96:99], v[20:23]
    ds_read_b64_tr_b16 v[52:53], v164 offset:17408
    ds_read_b64_tr_b16 v[54:55], v168 offset:17408
    v_mfma_f32_16x16x32_bf16 v[8:11], v[60:63], v[92:95], v[8:11]
    v_mfma_f32_16x16x32_bf16 v[24:27], v[60:63], v[96:99], v[24:27]
    ds_read_b64_tr_b16 v[56:57], v165 offset:17408
    s_waitcnt lgkmcnt(14)
    ds_read_b64_tr_b16 v[58:59], v169 offset:17408
    v_mfma_f32_16x16x32_bf16 v[12:15], v[64:67], v[92:95], v[12:15]
    v_mfma_f32_16x16x32_bf16 v[28:31], v[64:67], v[96:99], v[28:31]
    s_waitcnt lgkmcnt(14)
    ds_read_b64_tr_b16 v[60:61], v166 offset:17408
    s_waitcnt lgkmcnt(14)
    ds_read_b64_tr_b16 v[62:63], v170 offset:17408
    s_waitcnt vmcnt(12)
    v_mfma_f32_16x16x32_bf16 v[0:3], v[36:39], v[100:103], v[0:3]
    s_waitcnt vmcnt(8)
    v_mfma_f32_16x16x32_bf16 v[16:19], v[36:39], v[104:107], v[16:19]
    s_waitcnt lgkmcnt(11)
    v_mfma_f32_16x16x32_bf16 v[32:35], v[36:39], v[148:151], v[32:35]
    ds_read_b64_tr_b16 v[64:65], v167 offset:17408
    ds_read_b64_tr_b16 v[66:67], v171 offset:17408
    v_mfma_f32_16x16x32_bf16 v[4:7], v[40:43], v[100:103], v[4:7]
    v_mfma_f32_16x16x32_bf16 v[20:23], v[40:43], v[104:107], v[20:23]
    ds_read_b64_tr_b16 v[36:37], v164 offset:18432
    ds_read_b64_tr_b16 v[38:39], v168 offset:18432
    s_add_u32 s64, s67, 2
    s_and_b32 s64, s64, 7
    s_lshl_b32 s64, s64, 12
    s_add_u32 s3, s64, s29
    buffer_load_dwordx4 v[68:71], v176, s[8:11], s3 offen sc1
    buffer_load_dwordx4 v[76:79], v176, s[8:11], s3 offen offset:1024 sc1
    buffer_load_dwordx4 v[84:87], v176, s[8:11], s3 offen offset:2048 sc1
    buffer_load_dwordx4 v[92:95], v176, s[8:11], s3 offen offset:3072 sc1
    v_mfma_f32_16x16x32_bf16 v[8:11], v[44:47], v[100:103], v[8:11]
    v_mfma_f32_16x16x32_bf16 v[24:27], v[44:47], v[104:107], v[24:27]
    s_waitcnt lgkmcnt(14)
    ds_read_b64_tr_b16 v[40:41], v165 offset:18432
    s_waitcnt lgkmcnt(14)
    ds_read_b64_tr_b16 v[42:43], v169 offset:18432
    s_waitcnt lgkmcnt(12)
    v_mfma_f32_16x16x32_bf16 v[12:15], v[48:51], v[100:103], v[12:15]
    v_mfma_f32_16x16x32_bf16 v[28:31], v[48:51], v[104:107], v[28:31]
    ds_read_b64_tr_b16 v[44:45], v166 offset:18432
    ds_read_b64_tr_b16 v[46:47], v170 offset:18432
    s_waitcnt lgkmcnt(12)
    v_mfma_f32_16x16x32_bf16 v[0:3], v[52:55], v[108:111], v[0:3]
    s_waitcnt vmcnt(11)
    v_mfma_f32_16x16x32_bf16 v[16:19], v[52:55], v[112:115], v[16:19]
    v_mfma_f32_16x16x32_bf16 v[32:35], v[52:55], v[152:155], v[32:35]
    ds_read_b64_tr_b16 v[48:49], v167 offset:18432
    ds_read_b64_tr_b16 v[50:51], v171 offset:18432
    s_waitcnt lgkmcnt(12)
    v_mfma_f32_16x16x32_bf16 v[4:7], v[56:59], v[108:111], v[4:7]
    v_mfma_f32_16x16x32_bf16 v[20:23], v[56:59], v[112:115], v[20:23]
    ds_read_b64_tr_b16 v[52:53], v164 offset:19456
    ds_read_b64_tr_b16 v[54:55], v168 offset:19456
    s_add_u32 s3, s64, s30
    buffer_load_dwordx4 v[72:75], v176, s[8:11], s3 offen sc1
    buffer_load_dwordx4 v[80:83], v176, s[8:11], s3 offen offset:1024 sc1
    buffer_load_dwordx4 v[88:91], v176, s[8:11], s3 offen offset:2048 sc1
    buffer_load_dwordx4 v[96:99], v176, s[8:11], s3 offen offset:3072 sc1
    s_waitcnt lgkmcnt(12)
    v_mfma_f32_16x16x32_bf16 v[8:11], v[60:63], v[108:111], v[8:11]
    v_mfma_f32_16x16x32_bf16 v[24:27], v[60:63], v[112:115], v[24:27]
    ds_read_b64_tr_b16 v[56:57], v165 offset:19456
    ds_read_b64_tr_b16 v[58:59], v169 offset:19456
    s_waitcnt lgkmcnt(12)
    v_mfma_f32_16x16x32_bf16 v[12:15], v[64:67], v[108:111], v[12:15]
    v_mfma_f32_16x16x32_bf16 v[28:31], v[64:67], v[112:115], v[28:31]
    ds_read_b64_tr_b16 v[60:61], v166 offset:19456
    ds_read_b64_tr_b16 v[62:63], v170 offset:19456
    s_waitcnt lgkmcnt(12)
    v_mfma_f32_16x16x32_bf16 v[0:3], v[36:39], v[116:119], v[0:3]
    s_waitcnt vmcnt(14)
    v_mfma_f32_16x16x32_bf16 v[16:19], v[36:39], v[120:123], v[16:19]
    v_mfma_f32_16x16x32_bf16 v[32:35], v[36:39], v[156:159], v[32:35]
    ds_read_b64_tr_b16 v[64:65], v167 offset:19456
    ds_read_b64_tr_b16 v[66:67], v171 offset:19456
    s_waitcnt lgkmcnt(12)
    v_mfma_f32_16x16x32_bf16 v[4:7], v[40:43], v[116:119], v[4:7]
    v_mfma_f32_16x16x32_bf16 v[20:23], v[40:43], v[120:123], v[20:23]
    s_waitcnt lgkmcnt(10)
    v_mfma_f32_16x16x32_bf16 v[8:11], v[44:47], v[116:119], v[8:11]
    v_mfma_f32_16x16x32_bf16 v[24:27], v[44:47], v[120:123], v[24:27]
    s_waitcnt lgkmcnt(8)
    v_mfma_f32_16x16x32_bf16 v[12:15], v[48:51], v[116:119], v[12:15]
    v_mfma_f32_16x16x32_bf16 v[28:31], v[48:51], v[120:123], v[28:31]
    s_cmp_lg_u32 s24, 0
    s_cbranch_scc1 ENS2_done
    s_mov_b32 s65, 0
ENS2_loop:
    s_and_b32 s61, s59, 16
    s_cmp_eq_u32 s61, 16
    s_cbranch_scc1 ENS2_done
    s_mov_b64 exec, 0xff
    buffer_load_dword v253, v178, s[12:15], s28 offen sc1
    s_waitcnt vmcnt(0)
    v_cmp_eq_u32 vcc, s70, v253
    s_add_u32 s65, s65, 1
    s_mov_b64 exec, -1
    s_nop 1
    s_mov_b32 s59, vcc_lo
    s_sleep 8
    s_cmp_lt_u32 s65, 0x200000
    s_cbranch_scc1 ENS2_loop
ENS2_done:
    s_waitcnt lgkmcnt(0)
    s_barrier
    ds_read_b64_tr_b16 v[36:37], v164 offset:32768
    ds_read_b64_tr_b16 v[38:39], v168 offset:32768
    ds_read_b64_tr_b16 v[40:41], v165 offset:32768
    ds_read_b64_tr_b16 v[42:43], v169 offset:32768
    ds_read_b64_tr_b16 v[44:45], v166 offset:32768
    ds_read_b64_tr_b16 v[46:47], v170 offset:32768
    v_mfma_f32_16x16x32_bf16 v[0:3], v[52:55], v[124:127], v[0:3]
    ds_read_b128 v[132:135], v177 offset:8192
    ds_read_b128 v[136:139], v177 offset:9216
    ds_read_b128 v[140:143], v177 offset:10240
    ds_read_b128 v[144:147], v177 offset:11264
    s_waitcnt vmcnt(13)
    v_mfma_f32_16x16x32_bf16 v[16:19], v[52:55], v[128:131], v[16:19]
    s_add_u32 s61, s67, 4
    s_and_b32 s61, s61, 7
    s_lshl_b32 s61, s61, 12
    s_add_u32 s61, s61, s31
    s_lshr_b32 s62, s25, 1
    s_add_u32 m0, s62, 69632
    s_nop 0
    buffer_load_dwordx4 v176, s[8:11], s61 offen sc1 lds
    v_mfma_f32_16x16x32_bf16 v[32:35], v[52:55], v[160:163], v[32:35]
    s_add_u32 s61, s67, 4
    s_and_b32 s61, s61, 7
    s_lshl_b32 s27, s61, 17
    s_add_u32 s27, s27, s26
    s_add_u32 m0, s66, 16384
    s_nop 0
    buffer_load_dwordx4 v172, s[4:7], s27 offen lds
    buffer_load_dwordx4 v173, s[4:7], s27 offen offset:1024 lds
    ds_read_b64_tr_b16 v[48:49], v167 offset:32768
    ds_read_b64_tr_b16 v[50:51], v171 offset:32768
    v_mfma_f32_16x16x32_bf16 v[4:7], v[56:59], v[124:127], v[4:7]
    buffer_load_dwordx4 v174, s[4:7], s27 offen offset:2048 lds
    buffer_load_dwordx4 v175, s[4:7], s27 offen offset:3072 lds
    v_mfma_f32_16x16x32_bf16 v[20:23], v[56:59], v[128:131], v[20:23]
    ds_read_b64_tr_b16 v[52:53], v164 offset:33792
    ds_read_b64_tr_b16 v[54:55], v168 offset:33792
    v_mfma_f32_16x16x32_bf16 v[8:11], v[60:63], v[124:127], v[8:11]
    v_mfma_f32_16x16x32_bf16 v[24:27], v[60:63], v[128:131], v[24:27]
    ds_read_b64_tr_b16 v[56:57], v165 offset:33792
    s_waitcnt lgkmcnt(14)
    ds_read_b64_tr_b16 v[58:59], v169 offset:33792
    v_mfma_f32_16x16x32_bf16 v[12:15], v[64:67], v[124:127], v[12:15]
    v_mfma_f32_16x16x32_bf16 v[28:31], v[64:67], v[128:131], v[28:31]
    s_waitcnt lgkmcnt(14)
    ds_read_b64_tr_b16 v[60:61], v166 offset:33792
    s_waitcnt lgkmcnt(14)
    ds_read_b64_tr_b16 v[62:63], v170 offset:33792
    s_waitcnt vmcnt(12)
    v_mfma_f32_16x16x32_bf16 v[0:3], v[36:39], v[68:71], v[0:3]
    s_waitcnt vmcnt(8)
    v_mfma_f32_16x16x32_bf16 v[16:19], v[36:39], v[72:75], v[16:19]
    s_waitcnt lgkmcnt(11)
    v_mfma_f32_16x16x32_bf16 v[32:35], v[36:39], v[132:135], v[32:35]
    ds_read_b64_tr_b16 v[64:65], v167 offset:33792
    ds_read_b64_tr_b16 v[66:67], v171 offset:33792
    v_mfma_f32_16x16x32_bf16 v[4:7], v[40:43], v[68:71], v[4:7]
    v_mfma_f32_16x16x32_bf16 v[20:23], v[40:43], v[72:75], v[20:23]
    ds_read_b64_tr_b16 v[36:37], v164 offset:34816
    ds_read_b64_tr_b16 v[38:39], v168 offset:34816
    s_add_u32 s64, s67, 3
    s_and_b32 s64, s64, 7
    s_lshl_b32 s64, s64, 12
    s_add_u32 s3, s64, s29
    buffer_load_dwordx4 v[100:103], v176, s[8:11], s3 offen sc1
    buffer_load_dwordx4 v[108:111], v176, s[8:11], s3 offen offset:1024 sc1
    buffer_load_dwordx4 v[116:119], v176, s[8:11], s3 offen offset:2048 sc1
    buffer_load_dwordx4 v[124:127], v176, s[8:11], s3 offen offset:3072 sc1
    v_mfma_f32_16x16x32_bf16 v[8:11], v[44:47], v[68:71], v[8:11]
    v_mfma_f32_16x16x32_bf16 v[24:27], v[44:47], v[72:75], v[24:27]
    s_waitcnt lgkmcnt(14)
    ds_read_b64_tr_b16 v[40:41], v165 offset:34816
    s_waitcnt lgkmcnt(14)
    ds_read_b64_tr_b16 v[42:43], v169 offset:34816
    s_waitcnt lgkmcnt(12)
    v_mfma_f32_16x16x32_bf16 v[12:15], v[48:51], v[68:71], v[12:15]
    v_mfma_f32_16x16x32_bf16 v[28:31], v[48:51], v[72:75], v[28:31]
    ds_read_b64_tr_b16 v[44:45], v166 offset:34816
    ds_read_b64_tr_b16 v[46:47], v170 offset:34816
    s_waitcnt lgkmcnt(12)
    v_mfma_f32_16x16x32_bf16 v[0:3], v[52:55], v[76:79], v[0:3]
    s_waitcnt vmcnt(11)
    v_mfma_f32_16x16x32_bf16 v[16:19], v[52:55], v[80:83], v[16:19]
    v_mfma_f32_16x16x32_bf16 v[32:35], v[52:55], v[136:139], v[32:35]
    ds_read_b64_tr_b16 v[48:49], v167 offset:34816
    ds_read_b64_tr_b16 v[50:51], v171 offset:34816
    s_waitcnt lgkmcnt(12)
    v_mfma_f32_16x16x32_bf16 v[4:7], v[56:59], v[76:79], v[4:7]
    v_mfma_f32_16x16x32_bf16 v[20:23], v[56:59], v[80:83], v[20:23]
    ds_read_b64_tr_b16 v[52:53], v164 offset:35840
    ds_read_b64_tr_b16 v[54:55], v168 offset:35840
    s_add_u32 s3, s64, s30
    buffer_load_dwordx4 v[104:107], v176, s[8:11], s3 offen sc1
    buffer_load_dwordx4 v[112:115], v176, s[8:11], s3 offen offset:1024 sc1
    buffer_load_dwordx4 v[120:123], v176, s[8:11], s3 offen offset:2048 sc1
    buffer_load_dwordx4 v[128:131], v176, s[8:11], s3 offen offset:3072 sc1
    s_waitcnt lgkmcnt(12)
    v_mfma_f32_16x16x32_bf16 v[8:11], v[60:63], v[76:79], v[8:11]
    v_mfma_f32_16x16x32_bf16 v[24:27], v[60:63], v[80:83], v[24:27]
    ds_read_b64_tr_b16 v[56:57], v165 offset:35840
    ds_read_b64_tr_b16 v[58:59], v169 offset:35840
    s_waitcnt lgkmcnt(12)
    v_mfma_f32_16x16x32_bf16 v[12:15], v[64:67], v[76:79], v[12:15]
    v_mfma_f32_16x16x32_bf16 v[28:31], v[64:67], v[80:83], v[28:31]
    ds_read_b64_tr_b16 v[60:61], v166 offset:35840
    ds_read_b64_tr_b16 v[62:63], v170 offset:35840
    s_waitcnt lgkmcnt(12)
    v_mfma_f32_16x16x32_bf16 v[0:3], v[36:39], v[84:87], v[0:3]
    s_waitcnt vmcnt(14)
    v_mfma_f32_16x16x32_bf16 v[16:19], v[36:39], v[88:91], v[16:19]
    v_mfma_f32_16x16x32_bf16 v[32:35], v[36:39], v[140:143], v[32:35]
    ds_read_b64_tr_b16 v[64:65], v167 offset:35840
    ds_read_b64_tr_b16 v[66:67], v171 offset:35840
    s_waitcnt lgkmcnt(12)
    v_mfma_f32_16x16x32_bf16 v[4:7], v[40:43], v[84:87], v[4:7]
    v_mfma_f32_16x16x32_bf16 v[20:23], v[40:43], v[88:91], v[20:23]
    s_waitcnt lgkmcnt(10)
    v_mfma_f32_16x16x32_bf16 v[8:11], v[44:47], v[84:87], v[8:11]
    v_mfma_f32_16x16x32_bf16 v[24:27], v[44:47], v[88:91], v[24:27]
    s_waitcnt lgkmcnt(8)
    v_mfma_f32_16x16x32_bf16 v[12:15], v[48:51], v[84:87], v[12:15]
    v_mfma_f32_16x16x32_bf16 v[28:31], v[48:51], v[88:91], v[28:31]
    s_cmp_lg_u32 s24, 0
    s_cbranch_scc1 ENS3_done
    s_mov_b32 s65, 0
ENS3_loop:
    s_and_b32 s61, s59, 32
    s_cmp_eq_u32 s61, 32
    s_cbranch_scc1 ENS3_done
    s_mov_b64 exec, 0xff
    buffer_load_dword v253, v178, s[12:15], s28 offen sc1
    s_waitcnt vmcnt(0)
    v_cmp_eq_u32 vcc, s70, v253
    s_add_u32 s65, s65, 1
    s_mov_b64 exec, -1
    s_nop 1
    s_mov_b32 s59, vcc_lo
    s_sleep 8
    s_cmp_lt_u32 s65, 0x200000
    s_cbranch_scc1 ENS3_loop
ENS3_done:
    s_waitcnt lgkmcnt(0)
    s_barrier
    ds_read_b64_tr_b16 v[36:37], v164
    ds_read_b64_tr_b16 v[38:39], v168
    ds_read_b64_tr_b16 v[40:41], v165
    ds_read_b64_tr_b16 v[42:43], v169
    ds_read_b64_tr_b16 v[44:45], v166
    ds_read_b64_tr_b16 v[46:47], v170
    v_mfma_f32_16x16x32_bf16 v[0:3], v[52:55], v[92:95], v[0:3]
    ds_read_b128 v[148:151], v177
    ds_read_b128 v[152:155], v177 offset:1024
    ds_read_b128 v[156:159], v177 offset:2048
    ds_read_b128 v[160:163], v177 offset:3072
    s_waitcnt vmcnt(13)
    v_mfma_f32_16x16x32_bf16 v[16:19], v[52:55], v[96:99], v[16:19]
    s_add_u32 s61, s67, 5
    s_and_b32 s61, s61, 7
    s_lshl_b32 s61, s61, 12
    s_add_u32 s61, s61, s31
    s_lshr_b32 s62, s25, 1
    s_add_u32 m0, s62, 73728
    s_nop 0
    buffer_load_dwordx4 v176, s[8:11], s61 offen sc1 lds
    v_mfma_f32_16x16x32_bf16 v[32:35], v[52:55], v[144:147], v[32:35]
    s_add_u32 s61, s67, 5
    s_and_b32 s61, s61, 7
    s_lshl_b32 s27, s61, 17
    s_add_u32 s27, s27, s26
    s_add_u32 m0, s66, 32768
    s_nop 0
    buffer_load_dwordx4 v172, s[4:7], s27 offen lds
    buffer_load_dwordx4 v173, s[4:7], s27 offen offset:1024 lds
    ds_read_b64_tr_b16 v[48:49], v167
    ds_read_b64_tr_b16 v[50:51], v171
    v_mfma_f32_16x16x32_bf16 v[4:7], v[56:59], v[92:95], v[4:7]
    buffer_load_dwordx4 v174, s[4:7], s27 offen offset:2048 lds
    buffer_load_dwordx4 v175, s[4:7], s27 offen offset:3072 lds
    v_mfma_f32_16x16x32_bf16 v[20:23], v[56:59], v[96:99], v[20:23]
    ds_read_b64_tr_b16 v[52:53], v164 offset:1024
    ds_read_b64_tr_b16 v[54:55], v168 offset:1024
    v_mfma_f32_16x16x32_bf16 v[8:11], v[60:63], v[92:95], v[8:11]
    v_mfma_f32_16x16x32_bf16 v[24:27], v[60:63], v[96:99], v[24:27]
    ds_read_b64_tr_b16 v[56:57], v165 offset:1024
    s_waitcnt lgkmcnt(14)
    ds_read_b64_tr_b16 v[58:59], v169 offset:1024
    v_mfma_f32_16x16x32_bf16 v[12:15], v[64:67], v[92:95], v[12:15]
    v_mfma_f32_16x16x32_bf16 v[28:31], v[64:67], v[96:99], v[28:31]
    s_waitcnt lgkmcnt(14)
    ds_read_b64_tr_b16 v[60:61], v166 offset:1024
    s_waitcnt lgkmcnt(14)
    ds_read_b64_tr_b16 v[62:63], v170 offset:1024
    s_waitcnt vmcnt(12)
    v_mfma_f32_16x16x32_bf16 v[0:3], v[36:39], v[100:103], v[0:3]
    s_waitcnt vmcnt(8)
    v_mfma_f32_16x16x32_bf16 v[16:19], v[36:39], v[104:107], v[16:19]
    s_waitcnt lgkmcnt(11)
    v_mfma_f32_16x16x32_bf16 v[32:35], v[36:39], v[148:151], v[32:35]
    ds_read_b64_tr_b16 v[64:65], v167 offset:1024
    ds_read_b64_tr_b16 v[66:67], v171 offset:1024
    v_mfma_f32_16x16x32_bf16 v[4:7], v[40:43], v[100:103], v[4:7]
    v_mfma_f32_16x16x32_bf16 v[20:23], v[40:43], v[104:107], v[20:23]
    ds_read_b64_tr_b16 v[36:37], v164 offset:2048
    ds_read_b64_tr_b16 v[38:39], v168 offset:2048
    s_add_u32 s64, s67, 4
    s_and_b32 s64, s64, 7
    s_lshl_b32 s64, s64, 12
    s_add_u32 s3, s64, s29
    buffer_load_dwordx4 v[68:71], v176, s[8:11], s3 offen sc1
    buffer_load_dwordx4 v[76:79], v176, s[8:11], s3 offen offset:1024 sc1
    buffer_load_dwordx4 v[84:87], v176, s[8:11], s3 offen offset:2048 sc1
    buffer_load_dwordx4 v[92:95], v176, s[8:11], s3 offen offset:3072 sc1
    v_mfma_f32_16x16x32_bf16 v[8:11], v[44:47], v[100:103], v[8:11]
    v_mfma_f32_16x16x32_bf16 v[24:27], v[44:47], v[104:107], v[24:27]
    s_waitcnt lgkmcnt(14)
    ds_read_b64_tr_b16 v[40:41], v165 offset:2048
    s_waitcnt lgkmcnt(14)
    ds_read_b64_tr_b16 v[42:43], v169 offset:2048
    s_waitcnt lgkmcnt(12)
    v_mfma_f32_16x16x32_bf16 v[12:15], v[48:51], v[100:103], v[12:15]
    v_mfma_f32_16x16x32_bf16 v[28:31], v[48:51], v[104:107], v[28:31]
    ds_read_b64_tr_b16 v[44:45], v166 offset:2048
    ds_read_b64_tr_b16 v[46:47], v170 offset:2048
    s_waitcnt lgkmcnt(12)
    v_mfma_f32_16x16x32_bf16 v[0:3], v[52:55], v[108:111], v[0:3]
    s_waitcnt vmcnt(11)
    v_mfma_f32_16x16x32_bf16 v[16:19], v[52:55], v[112:115], v[16:19]
    v_mfma_f32_16x16x32_bf16 v[32:35], v[52:55], v[152:155], v[32:35]
    ds_read_b64_tr_b16 v[48:49], v167 offset:2048
    ds_read_b64_tr_b16 v[50:51], v171 offset:2048
    s_waitcnt lgkmcnt(12)
    v_mfma_f32_16x16x32_bf16 v[4:7], v[56:59], v[108:111], v[4:7]
    v_mfma_f32_16x16x32_bf16 v[20:23], v[56:59], v[112:115], v[20:23]
    ds_read_b64_tr_b16 v[52:53], v164 offset:3072
    ds_read_b64_tr_b16 v[54:55], v168 offset:3072
    s_add_u32 s3, s64, s30
    buffer_load_dwordx4 v[72:75], v176, s[8:11], s3 offen sc1
    buffer_load_dwordx4 v[80:83], v176, s[8:11], s3 offen offset:1024 sc1
    buffer_load_dwordx4 v[88:91], v176, s[8:11], s3 offen offset:2048 sc1
    buffer_load_dwordx4 v[96:99], v176, s[8:11], s3 offen offset:3072 sc1
    s_waitcnt lgkmcnt(12)
    v_mfma_f32_16x16x32_bf16 v[8:11], v[60:63], v[108:111], v[8:11]
    v_mfma_f32_16x16x32_bf16 v[24:27], v[60:63], v[112:115], v[24:27]
    ds_read_b64_tr_b16 v[56:57], v165 offset:3072
    ds_read_b64_tr_b16 v[58:59], v169 offset:3072
    s_waitcnt lgkmcnt(12)
    v_mfma_f32_16x16x32_bf16 v[12:15], v[64:67], v[108:111], v[12:15]
    v_mfma_f32_16x16x32_bf16 v[28:31], v[64:67], v[112:115], v[28:31]
    ds_read_b64_tr_b16 v[60:61], v166 offset:3072
    ds_read_b64_tr_b16 v[62:63], v170 offset:3072
    s_waitcnt lgkmcnt(12)
    v_mfma_f32_16x16x32_bf16 v[0:3], v[36:39], v[116:119], v[0:3]
    s_waitcnt vmcnt(14)
    v_mfma_f32_16x16x32_bf16 v[16:19], v[36:39], v[120:123], v[16:19]
    v_mfma_f32_16x16x32_bf16 v[32:35], v[36:39], v[156:159], v[32:35]
    ds_read_b64_tr_b16 v[64:65], v167 offset:3072
    ds_read_b64_tr_b16 v[66:67], v171 offset:3072
    s_waitcnt lgkmcnt(12)
    v_mfma_f32_16x16x32_bf16 v[4:7], v[40:43], v[116:119], v[4:7]
    v_mfma_f32_16x16x32_bf16 v[20:23], v[40:43], v[120:123], v[20:23]
    s_waitcnt lgkmcnt(10)
    v_mfma_f32_16x16x32_bf16 v[8:11], v[44:47], v[116:119], v[8:11]
    v_mfma_f32_16x16x32_bf16 v[24:27], v[44:47], v[120:123], v[24:27]
    s_waitcnt lgkmcnt(8)
    v_mfma_f32_16x16x32_bf16 v[12:15], v[48:51], v[116:119], v[12:15]
    v_mfma_f32_16x16x32_bf16 v[28:31], v[48:51], v[120:123], v[28:31]
    s_cmp_lg_u32 s24, 0
    s_cbranch_scc1 ENS4_done
    s_mov_b32 s65, 0
ENS4_loop:
    s_and_b32 s61, s59, 64
    s_cmp_eq_u32 s61, 64
    s_cbranch_scc1 ENS4_done
    s_mov_b64 exec, 0xff
    buffer_load_dword v253, v178, s[12:15], s28 offen sc1
    s_waitcnt vmcnt(0)
    v_cmp_eq_u32 vcc, s70, v253
    s_add_u32 s65, s65, 1
    s_mov_b64 exec, -1
    s_nop 1
    s_mov_b32 s59, vcc_lo
    s_sleep 8
    s_cmp_lt_u32 s65, 0x200000
    s_cbranch_scc1 ENS4_loop
ENS4_done:
    s_waitcnt lgkmcnt(0)
    s_barrier
    ds_read_b64_tr_b16 v[36:37], v164 offset:16384
    ds_read_b64_tr_b16 v[38:39], v168 offset:16384
    ds_read_b64_tr_b16 v[40:41], v165 offset:16384
    ds_read_b64_tr_b16 v[42:43], v169 offset:16384
    ds_read_b64_tr_b16 v[44:45], v166 offset:16384
    ds_read_b64_tr_b16 v[46:47], v170 offset:16384
    v_mfma_f32_16x16x32_bf16 v[0:3], v[52:55], v[124:127], v[0:3]
    ds_read_b128 v[132:135], v177 offset:4096
    ds_read_b128 v[136:139], v177 offset:5120
    ds_read_b128 v[140:143], v177 offset:6144
    ds_read_b128 v[144:147], v177 offset:7168
    s_waitcnt vmcnt(13)
    v_mfma_f32_16x16x32_bf16 v[16:19], v[52:55], v[128:131], v[16:19]
    s_add_u32 s61, s67, 6
    s_and_b32 s61, s61, 7
    s_lshl_b32 s61, s61, 12
    s_add_u32 s61, s61, s31
    s_lshr_b32 s62, s25, 1
    s_add_u32 m0, s62, 65536
    s_nop 0
    buffer_load_dwordx4 v176, s[8:11], s61 offen sc1 lds
    v_mfma_f32_16x16x32_bf16 v[32:35], v[52:55], v[160:163], v[32:35]
    s_add_u32 s61, s67, 6
    s_and_b32 s61, s61, 7
    s_lshl_b32 s27, s61, 17
    s_add_u32 s27, s27, s26
    s_add_u32 m0, s66, 0
    s_nop 0
    buffer_load_dwordx4 v172, s[4:7], s27 offen lds
    buffer_load_dwordx4 v173, s[4:7], s27 offen offset:1024 lds
    ds_read_b64_tr_b16 v[48:49], v167 offset:16384
    ds_read_b64_tr_b16 v[50:51], v171 offset:16384
    v_mfma_f32_16x16x32_bf16 v[4:7], v[56:59], v[124:127], v[4:7]
    buffer_load_dwordx4 v174, s[4:7], s27 offen offset:2048 lds
    buffer_load_dwordx4 v175, s[4:7], s27 offen offset:3072 lds
    v_mfma_f32_16x16x32_bf16 v[20:23], v[56:59], v[128:131], v[20:23]
    ds_read_b64_tr_b16 v[52:53], v164 offset:17408
    ds_read_b64_tr_b16 v[54:55], v168 offset:17408
    v_mfma_f32_16x16x32_bf16 v[8:11], v[60:63], v[124:127], v[8:11]
    v_mfma_f32_16x16x32_bf16 v[24:27], v[60:63], v[128:131], v[24:27]
    ds_read_b64_tr_b16 v[56:57], v165 offset:17408
    s_waitcnt lgkmcnt(14)
    ds_read_b64_tr_b16 v[58:59], v169 offset:17408
    v_mfma_f32_16x16x32_bf16 v[12:15], v[64:67], v[124:127], v[12:15]
    v_mfma_f32_16x16x32_bf16 v[28:31], v[64:67], v[128:131], v[28:31]
    s_waitcnt lgkmcnt(14)
    ds_read_b64_tr_b16 v[60:61], v166 offset:17408
    s_waitcnt lgkmcnt(14)
    ds_read_b64_tr_b16 v[62:63], v170 offset:17408
    s_waitcnt vmcnt(12)
    v_mfma_f32_16x16x32_bf16 v[0:3], v[36:39], v[68:71], v[0:3]
    s_waitcnt vmcnt(8)
    v_mfma_f32_16x16x32_bf16 v[16:19], v[36:39], v[72:75], v[16:19]
    s_waitcnt lgkmcnt(11)
    v_mfma_f32_16x16x32_bf16 v[32:35], v[36:39], v[132:135], v[32:35]
    ds_read_b64_tr_b16 v[64:65], v167 offset:17408
    ds_read_b64_tr_b16 v[66:67], v171 offset:17408
    v_mfma_f32_16x16x32_bf16 v[4:7], v[40:43], v[68:71], v[4:7]
    v_mfma_f32_16x16x32_bf16 v[20:23], v[40:43], v[72:75], v[20:23]
    ds_read_b64_tr_b16 v[36:37], v164 offset:18432
    ds_read_b64_tr_b16 v[38:39], v168 offset:18432
    s_add_u32 s64, s67, 5
    s_and_b32 s64, s64, 7
    s_lshl_b32 s64, s64, 12
    s_add_u32 s3, s64, s29
    buffer_load_dwordx4 v[100:103], v176, s[8:11], s3 offen sc1
    buffer_load_dwordx4 v[108:111], v176, s[8:11], s3 offen offset:1024 sc1
    buffer_load_dwordx4 v[116:119], v176, s[8:11], s3 offen offset:2048 sc1
    buffer_load_dwordx4 v[124:127], v176, s[8:11], s3 offen offset:3072 sc1
    v_mfma_f32_16x16x32_bf16 v[8:11], v[44:47], v[68:71], v[8:11]
    v_mfma_f32_16x16x32_bf16 v[24:27], v[44:47], v[72:75], v[24:27]
    s_waitcnt lgkmcnt(14)
    ds_read_b64_tr_b16 v[40:41], v165 offset:18432
    s_waitcnt lgkmcnt(14)
    ds_read_b64_tr_b16 v[42:43], v169 offset:18432
    s_waitcnt lgkmcnt(12)
    v_mfma_f32_16x16x32_bf16 v[12:15], v[48:51], v[68:71], v[12:15]
    v_mfma_f32_16x16x32_bf16 v[28:31], v[48:51], v[72:75], v[28:31]
    ds_read_b64_tr_b16 v[44:45], v166 offset:18432
    ds_read_b64_tr_b16 v[46:47], v170 offset:18432
    s_waitcnt lgkmcnt(12)
    v_mfma_f32_16x16x32_bf16 v[0:3], v[52:55], v[76:79], v[0:3]
    s_waitcnt vmcnt(11)
    v_mfma_f32_16x16x32_bf16 v[16:19], v[52:55], v[80:83], v[16:19]
    v_mfma_f32_16x16x32_bf16 v[32:35], v[52:55], v[136:139], v[32:35]
    ds_read_b64_tr_b16 v[48:49], v167 offset:18432
    ds_read_b64_tr_b16 v[50:51], v171 offset:18432
    s_waitcnt lgkmcnt(12)
    v_mfma_f32_16x16x32_bf16 v[4:7], v[56:59], v[76:79], v[4:7]
    v_mfma_f32_16x16x32_bf16 v[20:23], v[56:59], v[80:83], v[20:23]
    ds_read_b64_tr_b16 v[52:53], v164 offset:19456
    ds_read_b64_tr_b16 v[54:55], v168 offset:19456
    s_add_u32 s3, s64, s30
    buffer_load_dwordx4 v[104:107], v176, s[8:11], s3 offen sc1
    buffer_load_dwordx4 v[112:115], v176, s[8:11], s3 offen offset:1024 sc1
    buffer_load_dwordx4 v[120:123], v176, s[8:11], s3 offen offset:2048 sc1
    buffer_load_dwordx4 v[128:131], v176, s[8:11], s3 offen offset:3072 sc1
    s_waitcnt lgkmcnt(12)
    v_mfma_f32_16x16x32_bf16 v[8:11], v[60:63], v[76:79], v[8:11]
    v_mfma_f32_16x16x32_bf16 v[24:27], v[60:63], v[80:83], v[24:27]
    ds_read_b64_tr_b16 v[56:57], v165 offset:19456
    ds_read_b64_tr_b16 v[58:59], v169 offset:19456
    s_waitcnt lgkmcnt(12)
    v_mfma_f32_16x16x32_bf16 v[12:15], v[64:67], v[76:79], v[12:15]
    v_mfma_f32_16x16x32_bf16 v[28:31], v[64:67], v[80:83], v[28:31]
    ds_read_b64_tr_b16 v[60:61], v166 offset:19456
    ds_read_b64_tr_b16 v[62:63], v170 offset:19456
    s_waitcnt lgkmcnt(12)
    v_mfma_f32_16x16x32_bf16 v[0:3], v[36:39], v[84:87], v[0:3]
    s_waitcnt vmcnt(14)
    v_mfma_f32_16x16x32_bf16 v[16:19], v[36:39], v[88:91], v[16:19]
    v_mfma_f32_16x16x32_bf16 v[32:35], v[36:39], v[140:143], v[32:35]
    ds_read_b64_tr_b16 v[64:65], v167 offset:19456
    ds_read_b64_tr_b16 v[66:67], v171 offset:19456
    s_waitcnt lgkmcnt(12)
    v_mfma_f32_16x16x32_bf16 v[4:7], v[40:43], v[84:87], v[4:7]
    v_mfma_f32_16x16x32_bf16 v[20:23], v[40:43], v[88:91], v[20:23]
    s_waitcnt lgkmcnt(10)
    v_mfma_f32_16x16x32_bf16 v[8:11], v[44:47], v[84:87], v[8:11]
    v_mfma_f32_16x16x32_bf16 v[24:27], v[44:47], v[88:91], v[24:27]
    s_waitcnt lgkmcnt(8)
    v_mfma_f32_16x16x32_bf16 v[12:15], v[48:51], v[84:87], v[12:15]
    v_mfma_f32_16x16x32_bf16 v[28:31], v[48:51], v[88:91], v[28:31]
    s_cmp_lg_u32 s24, 0
    s_cbranch_scc1 ENS5_done
    s_mov_b32 s65, 0
ENS5_loop:
    s_and_b32 s61, s59, 128
    s_cmp_eq_u32 s61, 128
    s_cbranch_scc1 ENS5_done
    s_mov_b64 exec, 0xff
    buffer_load_dword v253, v178, s[12:15], s28 offen sc1
    s_waitcnt vmcnt(0)
    v_cmp_eq_u32 vcc, s70, v253
    s_add_u32 s65, s65, 1
    s_mov_b64 exec, -1
    s_nop 1
    s_mov_b32 s59, vcc_lo
    s_sleep 8
    s_cmp_lt_u32 s65, 0x200000
    s_cbranch_scc1 ENS5_loop
ENS5_done:
    s_waitcnt lgkmcnt(0)
    s_barrier
    ds_read_b64_tr_b16 v[36:37], v164 offset:32768
    ds_read_b64_tr_b16 v[38:39], v168 offset:32768
    ds_read_b64_tr_b16 v[40:41], v165 offset:32768
    ds_read_b64_tr_b16 v[42:43], v169 offset:32768
    ds_read_b64_tr_b16 v[44:45], v166 offset:32768
    ds_read_b64_tr_b16 v[46:47], v170 offset:32768
    v_mfma_f32_16x16x32_bf16 v[0:3], v[52:55], v[92:95], v[0:3]
    ds_read_b128 v[148:151], v177 offset:8192
    ds_read_b128 v[152:155], v177 offset:9216
    ds_read_b128 v[156:159], v177 offset:10240
    ds_read_b128 v[160:163], v177 offset:11264
    s_waitcnt vmcnt(13)
    v_mfma_f32_16x16x32_bf16 v[16:19], v[52:55], v[96:99], v[16:19]
    s_add_u32 s61, s67, 7
    s_and_b32 s61, s61, 7
    s_lshl_b32 s61, s61, 12
    s_add_u32 s61, s61, s31
    s_lshr_b32 s62, s25, 1
    s_add_u32 m0, s62, 69632
    s_nop 0
    buffer_load_dwordx4 v176, s[8:11], s61 offen sc1 lds
    v_mfma_f32_16x16x32_bf16 v[32:35], v[52:55], v[144:147], v[32:35]
    s_add_u32 s61, s67, 7
    s_and_b32 s61, s61, 7
    s_lshl_b32 s27, s61, 17
    s_add_u32 s27, s27, s26
    s_add_u32 m0, s66, 16384
    s_nop 0
    buffer_load_dwordx4 v172, s[4:7], s27 offen lds
    buffer_load_dwordx4 v173, s[4:7], s27 offen offset:1024 lds
    ds_read_b64_tr_b16 v[48:49], v167 offset:32768
    ds_read_b64_tr_b16 v[50:51], v171 offset:32768
    v_mfma_f32_16x16x32_bf16 v[4:7], v[56:59], v[92:95], v[4:7]
    buffer_load_dwordx4 v174, s[4:7], s27 offen offset:2048 lds
    buffer_load_dwordx4 v175, s[4:7], s27 offen offset:3072 lds
    v_mfma_f32_16x16x32_bf16 v[20:23], v[56:59], v[96:99], v[20:23]
    ds_read_b64_tr_b16 v[52:53], v164 offset:33792
    ds_read_b64_tr_b16 v[54:55], v168 offset:33792
    v_mfma_f32_16x16x32_bf16 v[8:11], v[60:63], v[92:95], v[8:11]
    v_mfma_f32_16x16x32_bf16 v[24:27], v[60:63], v[96:99], v[24:27]
    ds_read_b64_tr_b16 v[56:57], v165 offset:33792
    s_waitcnt lgkmcnt(14)
    ds_read_b64_tr_b16 v[58:59], v169 offset:33792
    v_mfma_f32_16x16x32_bf16 v[12:15], v[64:67], v[92:95], v[12:15]
    v_mfma_f32_16x16x32_bf16 v[28:31], v[64:67], v[96:99], v[28:31]
    s_waitcnt lgkmcnt(14)
    ds_read_b64_tr_b16 v[60:61], v166 offset:33792
    s_waitcnt lgkmcnt(14)
    ds_read_b64_tr_b16 v[62:63], v170 offset:33792
    s_waitcnt vmcnt(12)
    v_mfma_f32_16x16x32_bf16 v[0:3], v[36:39], v[100:103], v[0:3]
    s_waitcnt vmcnt(8)
    v_mfma_f32_16x16x32_bf16 v[16:19], v[36:39], v[104:107], v[16:19]
    s_waitcnt lgkmcnt(11)
    v_mfma_f32_16x16x32_bf16 v[32:35], v[36:39], v[148:151], v[32:35]
    ds_read_b64_tr_b16 v[64:65], v167 offset:33792
    ds_read_b64_tr_b16 v[66:67], v171 offset:33792
    v_mfma_f32_16x16x32_bf16 v[4:7], v[40:43], v[100:103], v[4:7]
    v_mfma_f32_16x16x32_bf16 v[20:23], v[40:43], v[104:107], v[20:23]
    ds_read_b64_tr_b16 v[36:37], v164 offset:34816
    ds_read_b64_tr_b16 v[38:39], v168 offset:34816
    s_add_u32 s64, s67, 6
    s_and_b32 s64, s64, 7
    s_lshl_b32 s64, s64, 12
    s_add_u32 s3, s64, s29
    buffer_load_dwordx4 v[68:71], v176, s[8:11], s3 offen sc1
    buffer_load_dwordx4 v[76:79], v176, s[8:11], s3 offen offset:1024 sc1
    buffer_load_dwordx4 v[84:87], v176, s[8:11], s3 offen offset:2048 sc1
    buffer_load_dwordx4 v[92:95], v176, s[8:11], s3 offen offset:3072 sc1
    v_mfma_f32_16x16x32_bf16 v[8:11], v[44:47], v[100:103], v[8:11]
    v_mfma_f32_16x16x32_bf16 v[24:27], v[44:47], v[104:107], v[24:27]
    s_waitcnt lgkmcnt(14)
    ds_read_b64_tr_b16 v[40:41], v165 offset:34816
    s_waitcnt lgkmcnt(14)
    ds_read_b64_tr_b16 v[42:43], v169 offset:34816
    s_waitcnt lgkmcnt(12)
    v_mfma_f32_16x16x32_bf16 v[12:15], v[48:51], v[100:103], v[12:15]
    v_mfma_f32_16x16x32_bf16 v[28:31], v[48:51], v[104:107], v[28:31]
    ds_read_b64_tr_b16 v[44:45], v166 offset:34816
    ds_read_b64_tr_b16 v[46:47], v170 offset:34816
    s_waitcnt lgkmcnt(12)
    v_mfma_f32_16x16x32_bf16 v[0:3], v[52:55], v[108:111], v[0:3]
    s_waitcnt vmcnt(11)
    v_mfma_f32_16x16x32_bf16 v[16:19], v[52:55], v[112:115], v[16:19]
    v_mfma_f32_16x16x32_bf16 v[32:35], v[52:55], v[152:155], v[32:35]
    ds_read_b64_tr_b16 v[48:49], v167 offset:34816
    ds_read_b64_tr_b16 v[50:51], v171 offset:34816
    s_waitcnt lgkmcnt(12)
    v_mfma_f32_16x16x32_bf16 v[4:7], v[56:59], v[108:111], v[4:7]
    v_mfma_f32_16x16x32_bf16 v[20:23], v[56:59], v[112:115], v[20:23]
    ds_read_b64_tr_b16 v[52:53], v164 offset:35840
    ds_read_b64_tr_b16 v[54:55], v168 offset:35840
    s_add_u32 s3, s64, s30
    buffer_load_dwordx4 v[72:75], v176, s[8:11], s3 offen sc1
    buffer_load_dwordx4 v[80:83], v176, s[8:11], s3 offen offset:1024 sc1
    buffer_load_dwordx4 v[88:91], v176, s[8:11], s3 offen offset:2048 sc1
    buffer_load_dwordx4 v[96:99], v176, s[8:11], s3 offen offset:3072 sc1
    s_waitcnt lgkmcnt(12)
    v_mfma_f32_16x16x32_bf16 v[8:11], v[60:63], v[108:111], v[8:11]
    v_mfma_f32_16x16x32_bf16 v[24:27], v[60:63], v[112:115], v[24:27]
    ds_read_b64_tr_b16 v[56:57], v165 offset:35840
    ds_read_b64_tr_b16 v[58:59], v169 offset:35840
    s_waitcnt lgkmcnt(12)
    v_mfma_f32_16x16x32_bf16 v[12:15], v[64:67], v[108:111], v[12:15]
    v_mfma_f32_16x16x32_bf16 v[28:31], v[64:67], v[112:115], v[28:31]
    ds_read_b64_tr_b16 v[60:61], v166 offset:35840
    ds_read_b64_tr_b16 v[62:63], v170 offset:35840
    s_waitcnt lgkmcnt(12)
    v_mfma_f32_16x16x32_bf16 v[0:3], v[36:39], v[116:119], v[0:3]
    s_waitcnt vmcnt(14)
    v_mfma_f32_16x16x32_bf16 v[16:19], v[36:39], v[120:123], v[16:19]
    v_mfma_f32_16x16x32_bf16 v[32:35], v[36:39], v[156:159], v[32:35]
    ds_read_b64_tr_b16 v[64:65], v167 offset:35840
    ds_read_b64_tr_b16 v[66:67], v171 offset:35840
    s_waitcnt lgkmcnt(12)
    v_mfma_f32_16x16x32_bf16 v[4:7], v[40:43], v[116:119], v[4:7]
    v_mfma_f32_16x16x32_bf16 v[20:23], v[40:43], v[120:123], v[20:23]
    s_waitcnt lgkmcnt(10)
    v_mfma_f32_16x16x32_bf16 v[8:11], v[44:47], v[116:119], v[8:11]
    v_mfma_f32_16x16x32_bf16 v[24:27], v[44:47], v[120:123], v[24:27]
    s_waitcnt lgkmcnt(8)
    v_mfma_f32_16x16x32_bf16 v[12:15], v[48:51], v[116:119], v[12:15]
    v_mfma_f32_16x16x32_bf16 v[28:31], v[48:51], v[120:123], v[28:31]
    s_waitcnt lgkmcnt(0)
    s_barrier
    ds_read_b64_tr_b16 v[36:37], v164
    ds_read_b64_tr_b16 v[38:39], v168
    ds_read_b64_tr_b16 v[40:41], v165
    ds_read_b64_tr_b16 v[42:43], v169
    ds_read_b64_tr_b16 v[44:45], v166
    ds_read_b64_tr_b16 v[46:47], v170
    v_mfma_f32_16x16x32_bf16 v[0:3], v[52:55], v[124:127], v[0:3]
    ds_read_b128 v[132:135], v177
    ds_read_b128 v[136:139], v177 offset:1024
    ds_read_b128 v[140:143], v177 offset:2048
    ds_read_b128 v[144:147], v177 offset:3072
    s_waitcnt vmcnt(13)
    v_mfma_f32_16x16x32_bf16 v[16:19], v[52:55], v[128:131], v[16:19]
    v_mfma_f32_16x16x32_bf16 v[32:35], v[52:55], v[160:163], v[32:35]
    ds_read_b64_tr_b16 v[48:49], v167
    ds_read_b64_tr_b16 v[50:51], v171
    v_mfma_f32_16x16x32_bf16 v[4:7], v[56:59], v[124:127], v[4:7]
    v_mfma_f32_16x16x32_bf16 v[20:23], v[56:59], v[128:131], v[20:23]
    ds_read_b64_tr_b16 v[52:53], v164 offset:1024
    ds_read_b64_tr_b16 v[54:55], v168 offset:1024
    v_mfma_f32_16x16x32_bf16 v[8:11], v[60:63], v[124:127], v[8:11]
    v_mfma_f32_16x16x32_bf16 v[24:27], v[60:63], v[128:131], v[24:27]
    ds_read_b64_tr_b16 v[56:57], v165 offset:1024
    s_waitcnt lgkmcnt(14)
    ds_read_b64_tr_b16 v[58:59], v169 offset:1024
    v_mfma_f32_16x16x32_bf16 v[12:15], v[64:67], v[124:127], v[12:15]
    v_mfma_f32_16x16x32_bf16 v[28:31], v[64:67], v[128:131], v[28:31]
    s_waitcnt lgkmcnt(14)
    ds_read_b64_tr_b16 v[60:61], v166 offset:1024
    s_waitcnt lgkmcnt(14)
    ds_read_b64_tr_b16 v[62:63], v170 offset:1024
    s_waitcnt vmcnt(7)
    v_mfma_f32_16x16x32_bf16 v[0:3], v[36:39], v[68:71], v[0:3]
    s_waitcnt vmcnt(3)
    v_mfma_f32_16x16x32_bf16 v[16:19], v[36:39], v[72:75], v[16:19]
    s_waitcnt lgkmcnt(11)
    v_mfma_f32_16x16x32_bf16 v[32:35], v[36:39], v[132:135], v[32:35]
    ds_read_b64_tr_b16 v[64:65], v167 offset:1024
    ds_read_b64_tr_b16 v[66:67], v171 offset:1024
    v_mfma_f32_16x16x32_bf16 v[4:7], v[40:43], v[68:71], v[4:7]
    v_mfma_f32_16x16x32_bf16 v[20:23], v[40:43], v[72:75], v[20:23]
    ds_read_b64_tr_b16 v[36:37], v164 offset:2048
    ds_read_b64_tr_b16 v[38:39], v168 offset:2048
    s_add_u32 s64, s67, 7
    s_and_b32 s64, s64, 7
    s_lshl_b32 s64, s64, 12
    s_add_u32 s3, s64, s29
    buffer_load_dwordx4 v[100:103], v176, s[8:11], s3 offen sc1
    buffer_load_dwordx4 v[108:111], v176, s[8:11], s3 offen offset:1024 sc1
    buffer_load_dwordx4 v[116:119], v176, s[8:11], s3 offen offset:2048 sc1
    buffer_load_dwordx4 v[124:127], v176, s[8:11], s3 offen offset:3072 sc1
    v_mfma_f32_16x16x32_bf16 v[8:11], v[44:47], v[68:71], v[8:11]
    v_mfma_f32_16x16x32_bf16 v[24:27], v[44:47], v[72:75], v[24:27]
    s_waitcnt lgkmcnt(14)
    ds_read_b64_tr_b16 v[40:41], v165 offset:2048
    s_waitcnt lgkmcnt(14)
    ds_read_b64_tr_b16 v[42:43], v169 offset:2048
    s_waitcnt lgkmcnt(12)
    v_mfma_f32_16x16x32_bf16 v[12:15], v[48:51], v[68:71], v[12:15]
    v_mfma_f32_16x16x32_bf16 v[28:31], v[48:51], v[72:75], v[28:31]
    ds_read_b64_tr_b16 v[44:45], v166 offset:2048
    ds_read_b64_tr_b16 v[46:47], v170 offset:2048
    s_waitcnt lgkmcnt(12)
    v_mfma_f32_16x16x32_bf16 v[0:3], v[52:55], v[76:79], v[0:3]
    s_waitcnt vmcnt(6)
    v_mfma_f32_16x16x32_bf16 v[16:19], v[52:55], v[80:83], v[16:19]
    v_mfma_f32_16x16x32_bf16 v[32:35], v[52:55], v[136:139], v[32:35]
    ds_read_b64_tr_b16 v[48:49], v167 offset:2048
    ds_read_b64_tr_b16 v[50:51], v171 offset:2048
    s_waitcnt lgkmcnt(12)
    v_mfma_f32_16x16x32_bf16 v[4:7], v[56:59], v[76:79], v[4:7]
    v_mfma_f32_16x16x32_bf16 v[20:23], v[56:59], v[80:83], v[20:23]
    ds_read_b64_tr_b16 v[52:53], v164 offset:3072
    ds_read_b64_tr_b16 v[54:55], v168 offset:3072
    s_add_u32 s3, s64, s30
    buffer_load_dwordx4 v[104:107], v176, s[8:11], s3 offen sc1
    buffer_load_dwordx4 v[112:115], v176, s[8:11], s3 offen offset:1024 sc1
    buffer_load_dwordx4 v[120:123], v176, s[8:11], s3 offen offset:2048 sc1
    buffer_load_dwordx4 v[128:131], v176, s[8:11], s3 offen offset:3072 sc1
    s_waitcnt lgkmcnt(12)
    v_mfma_f32_16x16x32_bf16 v[8:11], v[60:63], v[76:79], v[8:11]
    v_mfma_f32_16x16x32_bf16 v[24:27], v[60:63], v[80:83], v[24:27]
    ds_read_b64_tr_b16 v[56:57], v165 offset:3072
    ds_read_b64_tr_b16 v[58:59], v169 offset:3072
    s_waitcnt lgkmcnt(12)
    v_mfma_f32_16x16x32_bf16 v[12:15], v[64:67], v[76:79], v[12:15]
    v_mfma_f32_16x16x32_bf16 v[28:31], v[64:67], v[80:83], v[28:31]
    ds_read_b64_tr_b16 v[60:61], v166 offset:3072
    ds_read_b64_tr_b16 v[62:63], v170 offset:3072
    s_waitcnt lgkmcnt(12)
    v_mfma_f32_16x16x32_bf16 v[0:3], v[36:39], v[84:87], v[0:3]
    s_waitcnt vmcnt(9)
    v_mfma_f32_16x16x32_bf16 v[16:19], v[36:39], v[88:91], v[16:19]
    v_mfma_f32_16x16x32_bf16 v[32:35], v[36:39], v[140:143], v[32:35]
    ds_read_b64_tr_b16 v[64:65], v167 offset:3072
    ds_read_b64_tr_b16 v[66:67], v171 offset:3072
    s_waitcnt lgkmcnt(12)
    v_mfma_f32_16x16x32_bf16 v[4:7], v[40:43], v[84:87], v[4:7]
    v_mfma_f32_16x16x32_bf16 v[20:23], v[40:43], v[88:91], v[20:23]
    s_waitcnt lgkmcnt(10)
    v_mfma_f32_16x16x32_bf16 v[8:11], v[44:47], v[84:87], v[8:11]
    v_mfma_f32_16x16x32_bf16 v[24:27], v[44:47], v[88:91], v[24:27]
    s_waitcnt lgkmcnt(8)
    v_mfma_f32_16x16x32_bf16 v[12:15], v[48:51], v[84:87], v[12:15]
    v_mfma_f32_16x16x32_bf16 v[28:31], v[48:51], v[88:91], v[28:31]
    s_waitcnt lgkmcnt(0)
    s_barrier
    ds_read_b64_tr_b16 v[36:37], v164 offset:16384
    ds_read_b64_tr_b16 v[38:39], v168 offset:16384
    ds_read_b64_tr_b16 v[40:41], v165 offset:16384
    ds_read_b64_tr_b16 v[42:43], v169 offset:16384
    ds_read_b64_tr_b16 v[44:45], v166 offset:16384
    ds_read_b64_tr_b16 v[46:47], v170 offset:16384
    v_mfma_f32_16x16x32_bf16 v[0:3], v[52:55], v[92:95], v[0:3]
    ds_read_b128 v[148:151], v177 offset:4096
    ds_read_b128 v[152:155], v177 offset:5120
    ds_read_b128 v[156:159], v177 offset:6144
    ds_read_b128 v[160:163], v177 offset:7168
    s_waitcnt vmcnt(8)
    v_mfma_f32_16x16x32_bf16 v[16:19], v[52:55], v[96:99], v[16:19]
    v_mfma_f32_16x16x32_bf16 v[32:35], v[52:55], v[144:147], v[32:35]
    ds_read_b64_tr_b16 v[48:49], v167 offset:16384
    ds_read_b64_tr_b16 v[50:51], v171 offset:16384
    v_mfma_f32_16x16x32_bf16 v[4:7], v[56:59], v[92:95], v[4:7]
    v_mfma_f32_16x16x32_bf16 v[20:23], v[56:59], v[96:99], v[20:23]
    ds_read_b64_tr_b16 v[52:53], v164 offset:17408
    ds_read_b64_tr_b16 v[54:55], v168 offset:17408
    v_mfma_f32_16x16x32_bf16 v[8:11], v[60:63], v[92:95], v[8:11]
    v_mfma_f32_16x16x32_bf16 v[24:27], v[60:63], v[96:99], v[24:27]
    ds_read_b64_tr_b16 v[56:57], v165 offset:17408
    s_waitcnt lgkmcnt(14)
    ds_read_b64_tr_b16 v[58:59], v169 offset:17408
    v_mfma_f32_16x16x32_bf16 v[12:15], v[64:67], v[92:95], v[12:15]
    v_mfma_f32_16x16x32_bf16 v[28:31], v[64:67], v[96:99], v[28:31]
    s_waitcnt lgkmcnt(14)
    ds_read_b64_tr_b16 v[60:61], v166 offset:17408
    s_waitcnt lgkmcnt(14)
    ds_read_b64_tr_b16 v[62:63], v170 offset:17408
    s_waitcnt vmcnt(7)
    v_mfma_f32_16x16x32_bf16 v[0:3], v[36:39], v[100:103], v[0:3]
    s_waitcnt vmcnt(3)
    v_mfma_f32_16x16x32_bf16 v[16:19], v[36:39], v[104:107], v[16:19]
    s_waitcnt lgkmcnt(11)
    v_mfma_f32_16x16x32_bf16 v[32:35], v[36:39], v[148:151], v[32:35]
    ds_read_b64_tr_b16 v[64:65], v167 offset:17408
    ds_read_b64_tr_b16 v[66:67], v171 offset:17408
    v_mfma_f32_16x16x32_bf16 v[4:7], v[40:43], v[100:103], v[4:7]
    v_mfma_f32_16x16x32_bf16 v[20:23], v[40:43], v[104:107], v[20:23]
    ds_read_b64_tr_b16 v[36:37], v164 offset:18432
    ds_read_b64_tr_b16 v[38:39], v168 offset:18432
    v_mfma_f32_16x16x32_bf16 v[8:11], v[44:47], v[100:103], v[8:11]
    v_mfma_f32_16x16x32_bf16 v[24:27], v[44:47], v[104:107], v[24:27]
    s_waitcnt lgkmcnt(14)
    ds_read_b64_tr_b16 v[40:41], v165 offset:18432
    s_waitcnt lgkmcnt(14)
    ds_read_b64_tr_b16 v[42:43], v169 offset:18432
    s_waitcnt lgkmcnt(12)
    v_mfma_f32_16x16x32_bf16 v[12:15], v[48:51], v[100:103], v[12:15]
    v_mfma_f32_16x16x32_bf16 v[28:31], v[48:51], v[104:107], v[28:31]
    ds_read_b64_tr_b16 v[44:45], v166 offset:18432
    ds_read_b64_tr_b16 v[46:47], v170 offset:18432
    s_waitcnt lgkmcnt(12)
    v_mfma_f32_16x16x32_bf16 v[0:3], v[52:55], v[108:111], v[0:3]
    s_waitcnt vmcnt(2)
    v_mfma_f32_16x16x32_bf16 v[16:19], v[52:55], v[112:115], v[16:19]
    v_mfma_f32_16x16x32_bf16 v[32:35], v[52:55], v[152:155], v[32:35]
    ds_read_b64_tr_b16 v[48:49], v167 offset:18432
    ds_read_b64_tr_b16 v[50:51], v171 offset:18432
    s_waitcnt lgkmcnt(12)
    v_mfma_f32_16x16x32_bf16 v[4:7], v[56:59], v[108:111], v[4:7]
    v_mfma_f32_16x16x32_bf16 v[20:23], v[56:59], v[112:115], v[20:23]
    ds_read_b64_tr_b16 v[52:53], v164 offset:19456
    ds_read_b64_tr_b16 v[54:55], v168 offset:19456
    s_waitcnt lgkmcnt(12)
    v_mfma_f32_16x16x32_bf16 v[8:11], v[60:63], v[108:111], v[8:11]
    v_mfma_f32_16x16x32_bf16 v[24:27], v[60:63], v[112:115], v[24:27]
    ds_read_b64_tr_b16 v[56:57], v165 offset:19456
    ds_read_b64_tr_b16 v[58:59], v169 offset:19456
    s_waitcnt lgkmcnt(12)
    v_mfma_f32_16x16x32_bf16 v[12:15], v[64:67], v[108:111], v[12:15]
    v_mfma_f32_16x16x32_bf16 v[28:31], v[64:67], v[112:115], v[28:31]
    ds_read_b64_tr_b16 v[60:61], v166 offset:19456
    ds_read_b64_tr_b16 v[62:63], v170 offset:19456
    s_waitcnt lgkmcnt(12)
    v_mfma_f32_16x16x32_bf16 v[0:3], v[36:39], v[116:119], v[0:3]
    s_waitcnt vmcnt(1)
    v_mfma_f32_16x16x32_bf16 v[16:19], v[36:39], v[120:123], v[16:19]
    v_mfma_f32_16x16x32_bf16 v[32:35], v[36:39], v[156:159], v[32:35]
    ds_read_b64_tr_b16 v[64:65], v167 offset:19456
    ds_read_b64_tr_b16 v[66:67], v171 offset:19456
    s_waitcnt lgkmcnt(12)
    v_mfma_f32_16x16x32_bf16 v[4:7], v[40:43], v[116:119], v[4:7]
    v_mfma_f32_16x16x32_bf16 v[20:23], v[40:43], v[120:123], v[20:23]
    s_waitcnt lgkmcnt(10)
    v_mfma_f32_16x16x32_bf16 v[8:11], v[44:47], v[116:119], v[8:11]
    v_mfma_f32_16x16x32_bf16 v[24:27], v[44:47], v[120:123], v[24:27]
    s_waitcnt lgkmcnt(8)
    v_mfma_f32_16x16x32_bf16 v[12:15], v[48:51], v[116:119], v[12:15]
    v_mfma_f32_16x16x32_bf16 v[28:31], v[48:51], v[120:123], v[28:31]
    s_waitcnt lgkmcnt(6)
    v_mfma_f32_16x16x32_bf16 v[0:3], v[52:55], v[124:127], v[0:3]
    s_waitcnt vmcnt(0)
    v_mfma_f32_16x16x32_bf16 v[16:19], v[52:55], v[128:131], v[16:19]
    v_mfma_f32_16x16x32_bf16 v[32:35], v[52:55], v[160:163], v[32:35]
    s_waitcnt lgkmcnt(4)
    v_mfma_f32_16x16x32_bf16 v[4:7], v[56:59], v[124:127], v[4:7]
    v_mfma_f32_16x16x32_bf16 v[20:23], v[56:59], v[128:131], v[20:23]
    s_waitcnt lgkmcnt(2)
    v_mfma_f32_16x16x32_bf16 v[8:11], v[60:63], v[124:127], v[8:11]
    v_mfma_f32_16x16x32_bf16 v[24:27], v[60:63], v[128:131], v[24:27]
    s_waitcnt lgkmcnt(0)
    v_mfma_f32_16x16x32_bf16 v[12:15], v[64:67], v[124:127], v[12:15]
    v_mfma_f32_16x16x32_bf16 v[28:31], v[64:67], v[128:131], v[28:31]
    s_lshl_b32 s26, s63, 3
    s_add_u32 s26, s26, s77
    s_lshl_b32 s28, s26, 6
    s_add_u32 s28, s28, 67174400
    s_mul_i32 s26, s26, 147456
    s_add_u32 s26, s26, 18874368
    s_mul_i32 s27, s76, 36864
    s_add_u32 s27, s27, s26
    v_add_u32 v68, s25, v176
    v_mov_b32 v70, 0xfffff000
    s_bfe_u32 s61, s70, 0xc0001
    s_bfe_u32 s62, s70, 0xc000d
    v_mov_b32 v71, s61
    v_mov_b32 v132, s62
    s_mul_i32 s61, s33, 9216
    s_add_u32 s61, s61, s27
    v_and_or_b32 v4, v4, v70, v71
    v_and_or_b32 v5, v5, v70, v132
    v_and_or_b32 v6, v6, v70, v71
    v_and_or_b32 v7, v7, v70, v132
    buffer_store_dwordx4 v[4:7], v68, s[12:15], s61 offen sc1
    v_and_or_b32 v20, v20, v70, v71
    v_and_or_b32 v21, v21, v70, v132
    v_and_or_b32 v22, v22, v70, v71
    v_and_or_b32 v23, v23, v70, v132
    buffer_store_dwordx4 v[20:23], v68, s[12:15], s61 offen offset:1024 sc1
    s_mul_i32 s61, s34, 9216
    s_add_u32 s61, s61, s27
    v_and_or_b32 v8, v8, v70, v71
    v_and_or_b32 v9, v9, v70, v132
    v_and_or_b32 v10, v10, v70, v71
    v_and_or_b32 v11, v11, v70, v132
    buffer_store_dwordx4 v[8:11], v68, s[12:15], s61 offen sc1
    v_and_or_b32 v24, v24, v70, v71
    v_and_or_b32 v25, v25, v70, v132
    v_and_or_b32 v26, v26, v70, v71
    v_and_or_b32 v27, v27, v70, v132
    buffer_store_dwordx4 v[24:27], v68, s[12:15], s61 offen offset:1024 sc1
    s_mul_i32 s61, s35, 9216
    s_add_u32 s61, s61, s27
    v_and_or_b32 v12, v12, v70, v71
    v_and_or_b32 v13, v13, v70, v132
    v_and_or_b32 v14, v14, v70, v71
    v_and_or_b32 v15, v15, v70, v132
    buffer_store_dwordx4 v[12:15], v68, s[12:15], s61 offen sc1
    v_and_or_b32 v28, v28, v70, v71
    v_and_or_b32 v29, v29, v70, v132
    v_and_or_b32 v30, v30, v70, v71
    v_and_or_b32 v31, v31, v70, v132
    buffer_store_dwordx4 v[28:31], v68, s[12:15], s61 offen offset:1024 sc1
    s_mul_i32 s64, s32, 9216
    s_add_u32 s61, s64, s27
    s_add_u32 s61, s61, 8192
    v_and_or_b32 v32, v32, v70, v71
    v_and_or_b32 v33, v33, v70, v132
    v_and_or_b32 v34, v34, v70, v71
    v_and_or_b32 v35, v35, v70, v132
    buffer_store_dwordx4 v[32:35], v176, s[12:15], s61 offen sc1
    s_and_b32 s61, s32, 1
    v_and_b32 v251, 1, v249
    v_xor_b32 v251, s61, v251
    v_lshlrev_b32 v251, 3, v251
    v_lshl_or_b32 v251, v249, 4, v251
    v_lshl_or_b32 v69, v250, 11, v251
    s_mul_i32 s67, s58, 294912
    s_lshl_b32 s61, s60, 10
    s_add_u32 s67, s67, s61
    s_lshl_b32 s61, s77, 7
    s_add_u32 s67, s67, s61
    s_lshr_b32 s61, s32, 1
    s_lshl_b32 s61, s61, 6
    s_add_u32 s67, s67, s61
    v_add_u32 v136, s76, v248
    v_add_u32 v136, 1, v136
    v_and_b32 v136, 3, v136
    v_add_u32 v137, s24, v136
    v_and_b32 v137, 3, v137
    v_lshl_add_u32 v136, v136, 2, v137
    v_mul_u32_u24 v136, 9216, v136
    v_add_u32 v136, 9200, v136
    v_and_b32 v32, v32, v70
    v_and_b32 v33, v33, v70
    v_and_b32 v34, v34, v70
    v_and_b32 v35, v35, v70
    v_mov_b32 v80, v71
    v_mov_b32 v81, v132
    v_mov_b32 v82, v71
    v_mov_b32 v83, v132
    v_mov_b32 v92, v71
    v_mov_b32 v93, v132
    v_mov_b32 v94, v71
    v_mov_b32 v95, v132
    v_mov_b32 v104, v71
    v_mov_b32 v105, v132
    v_mov_b32 v106, v71
    v_mov_b32 v107, v132
    s_mov_b32 s65, 0
    s_mov_b64 exec, 7
QLOOP:
    buffer_load_dword v137, v136, s[12:15], s26 offen sc1
    s_waitcnt vmcnt(0)
    v_xor_b32 v137, v137, v71
    v_and_b32 v137, 0xfff, v137
    v_cmp_ne_u32 vcc, 0, v137
    s_add_u32 s65, s65, 1
    s_nop 3
    s_cbranch_vccz QDONE
    s_sleep 8
    s_cmp_lt_u32 s65, 0x100000
    s_cbranch_scc1 QLOOP
QDONE:
    s_mov_b64 exec, -1
    s_waitcnt vmcnt(0) lgkmcnt(0)
PLOOP:
    s_add_u32 s61, s76, 1
    s_and_b32 s61, s61, 3
    s_mul_i32 s61, s61, 36864
    s_add_u32 s61, s61, s26
    s_add_u32 s61, s61, s64
    buffer_load_dwordx4 v[72:75], v68, s[12:15], s61 offen sc1
    buffer_load_dwordx4 v[76:79], v68, s[12:15], s61 offen offset:1024 sc1
    s_add_u32 s61, s61, 8192
    s_cmp_eq_u32 s24, 0
    s_cselect_b64 exec, -1, 0
    buffer_load_dwordx4 v[80:83], v176, s[12:15], s61 offen sc1
    s_mov_b64 exec, -1
    s_add_u32 s61, s76, 2
    s_and_b32 s61, s61, 3
    s_mul_i32 s61, s61, 36864
    s_add_u32 s61, s61, s26
    s_add_u32 s61, s61, s64
    buffer_load_dwordx4 v[84:87], v68, s[12:15], s61 offen sc1
    buffer_load_dwordx4 v[88:91], v68, s[12:15], s61 offen offset:1024 sc1
    s_add_u32 s61, s61, 8192
    s_cmp_eq_u32 s24, 0
    s_cselect_b64 exec, -1, 0
    buffer_load_dwordx4 v[92:95], v176, s[12:15], s61 offen sc1
    s_mov_b64 exec, -1
    s_add_u32 s61, s76, 3
    s_and_b32 s61, s61, 3
    s_mul_i32 s61, s61, 36864
    s_add_u32 s61, s61, s26
    s_add_u32 s61, s61, s64
    buffer_load_dwordx4 v[96:99], v68, s[12:15], s61 offen sc1
    buffer_load_dwordx4 v[100:103], v68, s[12:15], s61 offen offset:1024 sc1
    s_add_u32 s61, s61, 8192
    s_cmp_eq_u32 s24, 0
    s_cselect_b64 exec, -1, 0
    buffer_load_dwordx4 v[104:107], v176, s[12:15], s61 offen sc1
    s_mov_b64 exec, -1
    s_waitcnt vmcnt(8)
    v_xor_b32 v134, v72, v71
    v_xor_b32 v135, v73, v132
    v_or_b32 v133, v134, v135
    v_xor_b32 v134, v74, v71
    v_xor_b32 v135, v75, v132
    v_or3_b32 v133, v133, v134, v135
    s_waitcnt vmcnt(7)
    v_xor_b32 v134, v76, v71
    v_xor_b32 v135, v77, v132
    v_or3_b32 v133, v133, v134, v135
    v_xor_b32 v134, v78, v71
    v_xor_b32 v135, v79, v132
    v_or3_b32 v133, v133, v134, v135
    s_waitcnt vmcnt(6)
    v_xor_b32 v134, v80, v71
    v_xor_b32 v135, v81, v132
    v_or3_b32 v133, v133, v134, v135
    v_xor_b32 v134, v82, v71
    v_xor_b32 v135, v83, v132
    v_or3_b32 v133, v133, v134, v135
    s_waitcnt vmcnt(5)
    v_xor_b32 v134, v84, v71
    v_xor_b32 v135, v85, v132
    v_or3_b32 v133, v133, v134, v135
    v_xor_b32 v134, v86, v71
    v_xor_b32 v135, v87, v132
    v_or3_b32 v133, v133, v134, v135
    s_waitcnt vmcnt(4)
    v_xor_b32 v134, v88, v71
    v_xor_b32 v135, v89, v132
    v_or3_b32 v133, v133, v134, v135
    v_xor_b32 v134, v90, v71
    v_xor_b32 v135, v91, v132
    v_or3_b32 v133, v133, v134, v135
    s_waitcnt vmcnt(3)
    v_xor_b32 v134, v92, v71
    v_xor_b32 v135, v93, v132
    v_or3_b32 v133, v133, v134, v135
    v_xor_b32 v134, v94, v71
    v_xor_b32 v135, v95, v132
    v_or3_b32 v133, v133, v134, v135
    s_waitcnt vmcnt(2)
    v_xor_b32 v134, v96, v71
    v_xor_b32 v135, v97, v132
    v_or3_b32 v133, v133, v134, v135
    v_xor_b32 v134, v98, v71
    v_xor_b32 v135, v99, v132
    v_or3_b32 v133, v133, v134, v135
    s_waitcnt vmcnt(1)
    v_xor_b32 v134, v100, v71
    v_xor_b32 v135, v101, v132
    v_or3_b32 v133, v133, v134, v135
    v_xor_b32 v134, v102, v71
    v_xor_b32 v135, v103, v132
    v_or3_b32 v133, v133, v134, v135
    s_waitcnt vmcnt(0)
    v_xor_b32 v134, v104, v71
    v_xor_b32 v135, v105, v132
    v_or3_b32 v133, v133, v134, v135
    v_xor_b32 v134, v106, v71
    v_xor_b32 v135, v107, v132
    v_or3_b32 v133, v133, v134, v135
    v_and_b32 v133, 0xfff, v133
    v_cmp_ne_u32 vcc, 0, v133
    s_add_u32 s65, s65, 1
    s_nop 2
    s_cbranch_vccz PDONE
    s_cmp_lt_u32 s65, 0x100000
    s_cbranch_scc1 PLOOP
PDONE:
    v_and_b32 v72, v72, v70
    v_add_f32 v0, v0, v72
    v_and_b32 v73, v73, v70
    v_add_f32 v1, v1, v73
    v_and_b32 v74, v74, v70
    v_add_f32 v2, v2, v74
    v_and_b32 v75, v75, v70
    v_add_f32 v3, v3, v75
    v_and_b32 v84, v84, v70
    v_add_f32 v0, v0, v84
    v_and_b32 v85, v85, v70
    v_add_f32 v1, v1, v85
    v_and_b32 v86, v86, v70
    v_add_f32 v2, v2, v86
    v_and_b32 v87, v87, v70
    v_add_f32 v3, v3, v87
    v_and_b32 v96, v96, v70
    v_add_f32 v0, v0, v96
    v_and_b32 v97, v97, v70
    v_add_f32 v1, v1, v97
    v_and_b32 v98, v98, v70
    v_add_f32 v2, v2, v98
    v_and_b32 v99, v99, v70
    v_add_f32 v3, v3, v99
    v_cvt_pk_bf16_f32 v0, v0, v1
    v_cvt_pk_bf16_f32 v1, v2, v3
    s_lshl_b32 s61, s24, 16
    s_add_u32 s61, s61, s67
    buffer_store_dwordx2 v[0:1], v69, s[16:19], s61 offen
    v_and_b32 v76, v76, v70
    v_add_f32 v16, v16, v76
    v_and_b32 v77, v77, v70
    v_add_f32 v17, v17, v77
    v_and_b32 v78, v78, v70
    v_add_f32 v18, v18, v78
    v_and_b32 v79, v79, v70
    v_add_f32 v19, v19, v79
    v_and_b32 v88, v88, v70
    v_add_f32 v16, v16, v88
    v_and_b32 v89, v89, v70
    v_add_f32 v17, v17, v89
    v_and_b32 v90, v90, v70
    v_add_f32 v18, v18, v90
    v_and_b32 v91, v91, v70
    v_add_f32 v19, v19, v91
    v_and_b32 v100, v100, v70
    v_add_f32 v16, v16, v100
    v_and_b32 v101, v101, v70
    v_add_f32 v17, v17, v101
    v_and_b32 v102, v102, v70
    v_add_f32 v18, v18, v102
    v_and_b32 v103, v103, v70
    v_add_f32 v19, v19, v103
    v_cvt_pk_bf16_f32 v16, v16, v17
    v_cvt_pk_bf16_f32 v17, v18, v19
    s_lshl_b32 s61, s24, 16
    s_add_u32 s61, s61, s67
    s_add_u32 s61, s61, 32768
    buffer_store_dwordx2 v[16:17], v69, s[16:19], s61 offen
    v_and_b32 v80, v80, v70
    v_add_f32 v32, v32, v80
    v_and_b32 v81, v81, v70
    v_add_f32 v33, v33, v81
    v_and_b32 v82, v82, v70
    v_add_f32 v34, v34, v82
    v_and_b32 v83, v83, v70
    v_add_f32 v35, v35, v83
    v_and_b32 v92, v92, v70
    v_add_f32 v32, v32, v92
    v_and_b32 v93, v93, v70
    v_add_f32 v33, v33, v93
    v_and_b32 v94, v94, v70
    v_add_f32 v34, v34, v94
    v_and_b32 v95, v95, v70
    v_add_f32 v35, v35, v95
    v_and_b32 v104, v104, v70
    v_add_f32 v32, v32, v104
    v_and_b32 v105, v105, v70
    v_add_f32 v33, v33, v105
    v_and_b32 v106, v106, v70
    v_add_f32 v34, v34, v106
    v_and_b32 v107, v107, v70
    v_add_f32 v35, v35, v107
    v_cvt_pk_bf16_f32 v32, v32, v33
    v_cvt_pk_bf16_f32 v33, v34, v35
    s_add_u32 s61, s67, 262144
    s_cmp_eq_u32 s24, 0
    s_cselect_b64 exec, -1, 0
    buffer_store_dwordx2 v[32:33], v69, s[16:19], s61 offen
    s_mov_b64 exec, -1
K1_END:
    s_endpgm
K1_FALLBACK:
    s_waitcnt vmcnt(0) lgkmcnt(0)
    s_barrier
    s_mov_b32 s63, 1
    s_mov_b32 s26, s64
    s_mov_b32 s27, s64
    s_add_u32 m0, s25, 73728
    s_nop 0
    buffer_load_dwordx4 v246, s[8:11], s26 offen nt lds
    buffer_load_dwordx4 v246, s[8:11], s26 offen offset:1024 nt lds
    s_add_u32 s26, s26, 8192
    s_add_u32 m0, s25, 40960
    s_nop 0
    buffer_load_dwordx4 v246, s[8:11], s26 offen nt lds
    buffer_load_dwordx4 v246, s[8:11], s26 offen offset:1024 nt lds
    s_add_u32 s26, s26, 8192
    s_add_u32 m0, s25, 0
    s_nop 0
    buffer_load_dwordx4 v247, s[12:15], s27 offen nt lds
    buffer_load_dwordx4 v247, s[12:15], s27 offen offset:1024 nt lds
    s_add_u32 s27, s27, 8192
    s_add_u32 m0, s25, 49152
    s_nop 0
    buffer_load_dwordx4 v246, s[8:11], s26 offen nt lds
    buffer_load_dwordx4 v246, s[8:11], s26 offen offset:1024 nt lds
    s_add_u32 s26, s26, 8192
    s_add_u32 m0, s25, 8192
    s_nop 0
    buffer_load_dwordx4 v247, s[12:15], s27 offen nt lds
    buffer_load_dwordx4 v247, s[12:15], s27 offen offset:1024 nt lds
    s_add_u32 s27, s27, 8192
    v_lshlrev_b32 v254, 8, v250
    v_lshl_add_u32 v254, v249, 4, v254
    v_add_u32 v180, s32, v254
    v_add_u32 v181, s33, v254
    v_add_u32 v182, s34, v254
    v_add_u32 v183, s35, v254
    v_mov_b32 v228, 0xff800000
    v_mov_b32 v230, 0xff800000
    v_mov_b32 v232, 0xff800000
    s_mov_b32 s61, s64
    s_add_u32 s62, s64, 131072
K1_FB_LOOP:
    buffer_load_dwordx4 v[196:199], v180, s[8:11], s61 offen
    buffer_load_dwordx4 v[200:203], v181, s[8:11], s61 offen
    buffer_load_dwordx4 v[204:207], v182, s[8:11], s61 offen
    buffer_load_dwordx4 v[208:211], v183, s[8:11], s61 offen
    s_waitcnt vmcnt(3)
    v_mfma_f32_16x16x32_bf16 v[156:159], v[196:199], v[96:99], 0
    v_mfma_f32_16x16x32_bf16 v[160:163], v[196:199], v[112:115], 0
    v_mfma_f32_16x16x32_bf16 v[164:167], v[196:199], v[128:131], 0
    s_waitcnt vmcnt(2)
    v_mfma_f32_16x16x32_bf16 v[156:159], v[200:203], v[100:103], v[156:159]
    v_mfma_f32_16x16x32_bf16 v[160:163], v[200:203], v[116:119], v[160:163]
    v_mfma_f32_16x16x32_bf16 v[164:167], v[200:203], v[132:135], v[164:167]
    s_waitcnt vmcnt(1)
    v_mfma_f32_16x16x32_bf16 v[156:159], v[204:207], v[104:107], v[156:159]
    v_mfma_f32_16x16x32_bf16 v[160:163], v[204:207], v[120:123], v[160:163]
    v_mfma_f32_16x16x32_bf16 v[164:167], v[204:207], v[136:139], v[164:167]
    s_waitcnt vmcnt(0)
    v_mfma_f32_16x16x32_bf16 v[156:159], v[208:211], v[108:111], v[156:159]
    v_mfma_f32_16x16x32_bf16 v[160:163], v[208:211], v[124:127], v[160:163]
    v_mfma_f32_16x16x32_bf16 v[164:167], v[208:211], v[140:143], v[164:167]
    s_nop 5
    v_max3_f32 v228, v228, v156, v157
    v_max3_f32 v228, v228, v158, v159
    v_max3_f32 v230, v230, v160, v161
    v_max3_f32 v230, v230, v162, v163
    v_max3_f32 v232, v232, v164, v165
    v_max3_f32 v232, v232, v166, v167
    s_add_u32 s61, s61, 4096
    s_cmp_lt_u32 s61, s62
    s_nop 7
    s_cbranch_scc1 K1_FB_LOOP
    v_mov_b32 v254, v228
    s_nop 1
    v_permlane16_swap_b32 v228, v254
    v_max_f32 v228, v228, v254
    v_mov_b32 v254, v228
    s_nop 1
    v_permlane32_swap_b32 v228, v254
    v_max_f32 v228, v228, v254
    v_sub_f32 v144, 0, v228
    v_sub_f32 v145, 0, v228
    v_sub_f32 v146, 0, v228
    v_sub_f32 v147, 0, v228
    v_mov_b32 v254, v230
    s_nop 1
    v_permlane16_swap_b32 v230, v254
    v_max_f32 v230, v230, v254
    v_mov_b32 v254, v230
    s_nop 1
    v_permlane32_swap_b32 v230, v254
    v_max_f32 v230, v230, v254
    v_sub_f32 v148, 0, v230
    v_sub_f32 v149, 0, v230
    v_sub_f32 v150, 0, v230
    v_sub_f32 v151, 0, v230
    v_mov_b32 v254, v232
    s_nop 1
    v_permlane16_swap_b32 v232, v254
    v_max_f32 v232, v232, v254
    v_mov_b32 v254, v232
    s_nop 1
    v_permlane32_swap_b32 v232, v254
    v_max_f32 v232, v232, v254
    v_sub_f32 v152, 0, v232
    v_sub_f32 v153, 0, v232
    v_sub_f32 v154, 0, v232
    v_sub_f32 v155, 0, v232
    s_waitcnt vmcnt(0) lgkmcnt(0)
    s_barrier
    s_nop 7
    s_branch ATT_ENTRY
VAR_1_t:
    s_waitcnt lgkmcnt(6)
    v_mfma_f32_16x16x32_bf16 v[156:159], v[196:199], v[96:99], 0
    v_mfma_f32_16x16x32_bf16 v[164:167], v[196:199], v[112:115], 0
    v_mfma_f32_16x16x32_bf16 v[188:191], v[196:199], v[128:131], 0
    ds_read_b128 v[224:227], v245 offset:33792
    s_waitcnt lgkmcnt(6)
    v_mfma_f32_16x16x32_bf16 v[156:159], v[200:203], v[100:103], v[156:159]
    v_mfma_f32_16x16x32_bf16 v[164:167], v[200:203], v[116:119], v[164:167]
    v_mfma_f32_16x16x32_bf16 v[188:191], v[200:203], v[132:135], v[188:191]
    s_waitcnt lgkmcnt(5)
    v_mfma_f32_16x16x32_bf16 v[156:159], v[204:207], v[104:107], v[156:159]
    v_mfma_f32_16x16x32_bf16 v[164:167], v[204:207], v[120:123], v[164:167]
    v_mfma_f32_16x16x32_bf16 v[188:191], v[204:207], v[136:139], v[188:191]
    s_waitcnt lgkmcnt(4)
    v_mfma_f32_16x16x32_bf16 v[156:159], v[208:211], v[108:111], v[156:159]
    v_mfma_f32_16x16x32_bf16 v[164:167], v[208:211], v[124:127], v[164:167]
    v_mfma_f32_16x16x32_bf16 v[188:191], v[208:211], v[140:143], v[188:191]
    s_waitcnt vmcnt(4) lgkmcnt(0)
    s_barrier
    ds_read_b128 v[196:199], v242
    ds_read_b128 v[200:203], v243
    ds_read_b128 v[204:207], v244
    v_mfma_f32_16x16x32_bf16 v[160:163], v[212:215], v[96:99], 0
    s_add_u32 m0, s25, 57344
    s_nop 0
    buffer_load_dwordx4 v246, s[8:11], s26 offen nt lds
    v_mfma_f32_16x16x32_bf16 v[168:171], v[212:215], v[112:115], 0
    buffer_load_dwordx4 v246, s[8:11], s26 offen offset:1024 nt lds
    s_add_u32 s26, s26, 8192
    v_mfma_f32_16x16x32_bf16 v[192:195], v[212:215], v[128:131], 0
    s_add_u32 m0, s25, 16384
    s_nop 0
    buffer_load_dwordx4 v247, s[12:15], s27 offen nt lds
    ds_read_b128 v[208:211], v245
    v_mfma_f32_16x16x32_bf16 v[160:163], v[216:219], v[100:103], v[160:163]
    buffer_load_dwordx4 v247, s[12:15], s27 offen offset:1024 nt lds
    s_add_u32 s27, s27, 8192
    v_mfma_f32_16x16x32_bf16 v[168:171], v[216:219], v[116:119], v[168:171]
    v_mfma_f32_16x16x32_bf16 v[192:195], v[216:219], v[132:135], v[192:195]
    ds_read_b128 v[212:215], v242 offset:1024
    v_mfma_f32_16x16x32_bf16 v[160:163], v[220:223], v[104:107], v[160:163]
    v_mfma_f32_16x16x32_bf16 v[168:171], v[220:223], v[120:123], v[168:171]
    v_mfma_f32_16x16x32_bf16 v[192:195], v[220:223], v[136:139], v[192:195]
    ds_read_b128 v[216:219], v243 offset:1024
    v_mfma_f32_16x16x32_bf16 v[160:163], v[224:227], v[108:111], v[160:163]
    v_mfma_f32_16x16x32_bf16 v[168:171], v[224:227], v[124:127], v[168:171]
    v_mfma_f32_16x16x32_bf16 v[192:195], v[224:227], v[140:143], v[192:195]
    ds_read_b128 v[220:223], v244 offset:1024
    s_branch VAR_1_j
VAR_4_t:
    v_max3_f32 v253, v188, v189, v190
    v_max3_f32 v253, v253, v191, v192
    v_max3_f32 v253, v253, v193, v194
    v_max_f32 v253, v253, v195
    v_mov_b32 v254, v253
    s_nop 1
    v_permlane16_swap_b32 v253, v254
    v_max_f32 v253, v253, v254
    v_mov_b32 v254, v253
    s_nop 1
    v_permlane32_swap_b32 v253, v254
    v_max_f32 v253, v253, v254
    s_cmp_eq_u32 s63, 1
    s_cbranch_scc1 SKIPM_5
    v_sub_f32 v152, 0, v253
    v_sub_f32 v153, 0, v253
    v_sub_f32 v154, 0, v253
    v_sub_f32 v155, 0, v253
SKIPM_5:
    v_add_f32 v188, v188, v152
    v_add_f32 v189, v189, v152
    v_add_f32 v190, v190, v152
    v_add_f32 v191, v191, v152
    v_add_f32 v192, v192, v152
    v_add_f32 v193, v193, v152
    v_add_f32 v194, v194, v152
    v_add_f32 v195, v195, v152
    v_exp_f32 v188, v188
    v_exp_f32 v189, v189
    v_add_f32 v232, v232, v188
    v_exp_f32 v190, v190
    v_add_f32 v233, v233, v189
    v_exp_f32 v191, v191
    v_cvt_pk_bf16_f32 v188, v188, v189
    v_add_f32 v232, v232, v190
    v_add_f32 v233, v233, v191
    v_cvt_pk_bf16_f32 v189, v190, v191
    v_exp_f32 v192, v192
    v_exp_f32 v193, v193
    v_add_f32 v232, v232, v192
    v_exp_f32 v194, v194
    v_add_f32 v233, v233, v193
    v_exp_f32 v195, v195
    v_cvt_pk_bf16_f32 v190, v192, v193
    v_add_f32 v232, v232, v194
    v_add_f32 v233, v233, v195
    v_cvt_pk_bf16_f32 v191, v194, v195
    s_branch VAR_4_j
VAR_6_t:
    s_waitcnt lgkmcnt(6)
    v_mfma_f32_16x16x32_bf16 v[172:175], v[196:199], v[96:99], v[144:147]
    v_exp_f32 v160, v160
    v_mfma_f32_16x16x32_bf16 v[180:183], v[196:199], v[112:115], v[148:151]
    v_mfma_f32_16x16x32_bf16 v[188:191], v[196:199], v[128:131], 0
    ds_read_b128 v[224:227], v245 offset:1024
    v_exp_f32 v168, v168
    s_waitcnt lgkmcnt(6)
    v_mfma_f32_16x16x32_bf16 v[172:175], v[200:203], v[100:103], v[172:175]
    v_mfma_f32_16x16x32_bf16 v[180:183], v[200:203], v[116:119], v[180:183]
    v_exp_f32 v161, v161
    v_mfma_f32_16x16x32_bf16 v[188:191], v[200:203], v[132:135], v[188:191]
    ds_read_b64_tr_b16 v[196:197], v234
    ds_read_b64_tr_b16 v[198:199], v234 offset:1024
    v_exp_f32 v169, v169
    s_waitcnt lgkmcnt(7)
    v_mfma_f32_16x16x32_bf16 v[172:175], v[204:207], v[104:107], v[172:175]
    v_mfma_f32_16x16x32_bf16 v[180:183], v[204:207], v[120:123], v[180:183]
    v_add_f32 v228, v228, v160
    v_mfma_f32_16x16x32_bf16 v[188:191], v[204:207], v[136:139], v[188:191]
    ds_read_b64_tr_b16 v[200:201], v235
    ds_read_b64_tr_b16 v[202:203], v235 offset:1024
    v_add_f32 v230, v230, v168
    s_waitcnt lgkmcnt(8)
    v_mfma_f32_16x16x32_bf16 v[172:175], v[208:211], v[108:111], v[172:175]
    v_exp_f32 v162, v162
    v_mfma_f32_16x16x32_bf16 v[180:183], v[208:211], v[124:127], v[180:183]
    v_mfma_f32_16x16x32_bf16 v[188:191], v[208:211], v[140:143], v[188:191]
    ds_read_b64_tr_b16 v[204:205], v236
    ds_read_b64_tr_b16 v[206:207], v236 offset:1024
    v_exp_f32 v170, v170
    s_waitcnt lgkmcnt(9)
    v_mfma_f32_16x16x32_bf16 v[176:179], v[212:215], v[96:99], v[144:147]
    v_add_f32 v229, v229, v161
    v_mfma_f32_16x16x32_bf16 v[184:187], v[212:215], v[112:115], v[148:151]
    v_add_f32 v231, v231, v169
    v_mfma_f32_16x16x32_bf16 v[192:195], v[212:215], v[128:131], 0
    ds_read_b64_tr_b16 v[208:209], v237
    ds_read_b64_tr_b16 v[210:211], v237 offset:1024
    v_exp_f32 v163, v163
    s_waitcnt lgkmcnt(10)
    v_mfma_f32_16x16x32_bf16 v[176:179], v[216:219], v[100:103], v[176:179]
    v_mfma_f32_16x16x32_bf16 v[184:187], v[216:219], v[116:119], v[184:187]
    v_exp_f32 v171, v171
    v_mfma_f32_16x16x32_bf16 v[192:195], v[216:219], v[132:135], v[192:195]
    ds_read_b64_tr_b16 v[212:213], v238
    ds_read_b64_tr_b16 v[214:215], v238 offset:1024
    v_cvt_pk_bf16_f32 v158, v160, v161
    s_waitcnt lgkmcnt(11)
    v_mfma_f32_16x16x32_bf16 v[176:179], v[220:223], v[104:107], v[176:179]
    v_cvt_pk_bf16_f32 v166, v168, v169
    v_mfma_f32_16x16x32_bf16 v[184:187], v[220:223], v[120:123], v[184:187]
    v_add_f32 v228, v228, v162
    v_mfma_f32_16x16x32_bf16 v[192:195], v[220:223], v[136:139], v[192:195]
    ds_read_b64_tr_b16 v[216:217], v239
    ds_read_b64_tr_b16 v[218:219], v239 offset:1024
    v_add_f32 v230, v230, v170
    v_add_f32 v229, v229, v163
    s_waitcnt lgkmcnt(12)
    v_mfma_f32_16x16x32_bf16 v[176:179], v[224:227], v[108:111], v[176:179]
    v_add_f32 v231, v231, v171
    v_mfma_f32_16x16x32_bf16 v[184:187], v[224:227], v[124:127], v[184:187]
    v_cvt_pk_bf16_f32 v159, v162, v163
    v_mfma_f32_16x16x32_bf16 v[192:195], v[224:227], v[140:143], v[192:195]
    ds_read_b64_tr_b16 v[220:221], v240
    ds_read_b64_tr_b16 v[222:223], v240 offset:1024
    v_cvt_pk_bf16_f32 v167, v170, v171
    s_branch VAR_6_j
VAR_7_t:
    s_waitcnt lgkmcnt(12)
    v_mfma_f32_16x16x32_bf16 v[0:3], v[196:199], v[156:159], 0
    v_exp_f32 v172, v172
    v_mfma_f32_16x16x32_bf16 v[32:35], v[196:199], v[164:167], 0
    v_mfma_f32_16x16x32_bf16 v[64:67], v[196:199], v[188:191], 0
    ds_read_b64_tr_b16 v[224:225], v241
    ds_read_b64_tr_b16 v[226:227], v241 offset:1024
    v_exp_f32 v180, v180
    s_waitcnt lgkmcnt(12)
    v_mfma_f32_16x16x32_bf16 v[4:7], v[200:203], v[156:159], 0
    v_mfma_f32_16x16x32_bf16 v[36:39], v[200:203], v[164:167], 0
    v_exp_f32 v173, v173
    v_mfma_f32_16x16x32_bf16 v[68:71], v[200:203], v[188:191], 0
    v_exp_f32 v181, v181
    s_waitcnt lgkmcnt(10)
    v_mfma_f32_16x16x32_bf16 v[8:11], v[204:207], v[156:159], 0
    v_mfma_f32_16x16x32_bf16 v[40:43], v[204:207], v[164:167], 0
    v_add_f32 v228, v228, v172
    v_mfma_f32_16x16x32_bf16 v[72:75], v[204:207], v[188:191], 0
    v_add_f32 v230, v230, v180
    s_waitcnt lgkmcnt(8)
    v_mfma_f32_16x16x32_bf16 v[12:15], v[208:211], v[156:159], 0
    v_exp_f32 v174, v174
    v_mfma_f32_16x16x32_bf16 v[44:47], v[208:211], v[164:167], 0
    v_mfma_f32_16x16x32_bf16 v[76:79], v[208:211], v[188:191], 0
    s_waitcnt vmcnt(4) lgkmcnt(0)
    s_barrier
    ds_read_b128 v[196:199], v242 offset:8192
    ds_read_b128 v[200:203], v243 offset:8192
    ds_read_b128 v[204:207], v244 offset:8192
    v_exp_f32 v182, v182
    v_mfma_f32_16x16x32_bf16 v[16:19], v[212:215], v[156:159], 0
    s_add_u32 m0, s25, 65536
    s_nop 0
    buffer_load_dwordx4 v246, s[8:11], s26 offen nt lds
    v_add_f32 v229, v229, v173
    v_mfma_f32_16x16x32_bf16 v[48:51], v[212:215], v[164:167], 0
    buffer_load_dwordx4 v246, s[8:11], s26 offen offset:1024 nt lds
    s_add_u32 s26, s26, 8192
    v_add_f32 v231, v231, v181
    v_mfma_f32_16x16x32_bf16 v[80:83], v[212:215], v[188:191], 0
    s_add_u32 m0, s25, 24576
    s_nop 0
    buffer_load_dwordx4 v247, s[12:15], s27 offen nt lds
    ds_read_b128 v[208:211], v245 offset:8192
    v_exp_f32 v175, v175
    v_mfma_f32_16x16x32_bf16 v[20:23], v[216:219], v[156:159], 0
    buffer_load_dwordx4 v247, s[12:15], s27 offen offset:1024 nt lds
    s_add_u32 s27, s27, 8192
    v_mfma_f32_16x16x32_bf16 v[52:55], v[216:219], v[164:167], 0
    v_exp_f32 v183, v183
    v_mfma_f32_16x16x32_bf16 v[84:87], v[216:219], v[188:191], 0
    ds_read_b128 v[212:215], v242 offset:9216
    v_cvt_pk_bf16_f32 v172, v172, v173
    v_mfma_f32_16x16x32_bf16 v[24:27], v[220:223], v[156:159], 0
    v_cvt_pk_bf16_f32 v180, v180, v181
    v_mfma_f32_16x16x32_bf16 v[56:59], v[220:223], v[164:167], 0
    v_add_f32 v228, v228, v174
    v_mfma_f32_16x16x32_bf16 v[88:91], v[220:223], v[188:191], 0
    ds_read_b128 v[216:219], v243 offset:9216
    v_add_f32 v230, v230, v182
    v_add_f32 v229, v229, v175
    v_mfma_f32_16x16x32_bf16 v[28:31], v[224:227], v[156:159], 0
    v_add_f32 v231, v231, v183
    v_mfma_f32_16x16x32_bf16 v[60:63], v[224:227], v[164:167], 0
    v_cvt_pk_bf16_f32 v173, v174, v175
    v_mfma_f32_16x16x32_bf16 v[92:95], v[224:227], v[188:191], 0
    ds_read_b128 v[220:223], v244 offset:9216
    v_cvt_pk_bf16_f32 v181, v182, v183
    s_branch VAR_7_j
VAR_8_t:
    v_max3_f32 v253, v188, v189, v190
    v_max3_f32 v253, v253, v191, v192
    v_max3_f32 v253, v253, v193, v194
    v_max_f32 v253, v253, v195
    v_mov_b32 v254, v253
    s_nop 1
    v_permlane16_swap_b32 v253, v254
    v_max_f32 v253, v253, v254
    v_mov_b32 v254, v253
    s_nop 1
    v_permlane32_swap_b32 v253, v254
    v_max_f32 v253, v253, v254
    s_cmp_eq_u32 s63, 1
    s_cbranch_scc1 SKIPM_9
    v_sub_f32 v152, 0, v253
    v_sub_f32 v153, 0, v253
    v_sub_f32 v154, 0, v253
    v_sub_f32 v155, 0, v253
SKIPM_9:
    v_add_f32 v188, v188, v152
    v_add_f32 v189, v189, v152
    v_add_f32 v190, v190, v152
    v_add_f32 v191, v191, v152
    v_add_f32 v192, v192, v152
    v_add_f32 v193, v193, v152
    v_add_f32 v194, v194, v152
    v_add_f32 v195, v195, v152
    v_exp_f32 v188, v188
    v_exp_f32 v189, v189
    v_add_f32 v232, v232, v188
    v_exp_f32 v190, v190
    v_add_f32 v233, v233, v189
    v_exp_f32 v191, v191
    v_cvt_pk_bf16_f32 v188, v188, v189
    v_add_f32 v232, v232, v190
    v_add_f32 v233, v233, v191
    v_cvt_pk_bf16_f32 v189, v190, v191
    v_exp_f32 v192, v192
    v_exp_f32 v193, v193
    v_add_f32 v232, v232, v192
    v_exp_f32 v194, v194
    v_add_f32 v233, v233, v193
    v_exp_f32 v195, v195
    v_cvt_pk_bf16_f32 v190, v192, v193
    v_add_f32 v232, v232, v194
    v_add_f32 v233, v233, v195
    v_cvt_pk_bf16_f32 v191, v194, v195
    s_branch VAR_8_j
VAR_10_t:
    s_waitcnt lgkmcnt(6)
    v_mfma_f32_16x16x32_bf16 v[156:159], v[196:199], v[96:99], v[144:147]
    v_exp_f32 v176, v176
    v_mfma_f32_16x16x32_bf16 v[164:167], v[196:199], v[112:115], v[148:151]
    v_mfma_f32_16x16x32_bf16 v[188:191], v[196:199], v[128:131], 0
    ds_read_b128 v[224:227], v245 offset:9216
    v_exp_f32 v184, v184
    s_waitcnt lgkmcnt(6)
    v_mfma_f32_16x16x32_bf16 v[156:159], v[200:203], v[100:103], v[156:159]
    v_mfma_f32_16x16x32_bf16 v[164:167], v[200:203], v[116:119], v[164:167]
    v_exp_f32 v177, v177
    v_mfma_f32_16x16x32_bf16 v[188:191], v[200:203], v[132:135], v[188:191]
    ds_read_b64_tr_b16 v[196:197], v234 offset:8192
    ds_read_b64_tr_b16 v[198:199], v234 offset:9216
    v_exp_f32 v185, v185
    s_waitcnt lgkmcnt(7)
    v_mfma_f32_16x16x32_bf16 v[156:159], v[204:207], v[104:107], v[156:159]
    v_mfma_f32_16x16x32_bf16 v[164:167], v[204:207], v[120:123], v[164:167]
    v_add_f32 v228, v228, v176
    v_mfma_f32_16x16x32_bf16 v[188:191], v[204:207], v[136:139], v[188:191]
    ds_read_b64_tr_b16 v[200:201], v235 offset:8192
    ds_read_b64_tr_b16 v[202:203], v235 offset:9216
    v_add_f32 v230, v230, v184
    s_waitcnt lgkmcnt(8)
    v_mfma_f32_16x16x32_bf16 v[156:159], v[208:211], v[108:111], v[156:159]
    v_exp_f32 v178, v178
    v_mfma_f32_16x16x32_bf16 v[164:167], v[208:211], v[124:127], v[164:167]
    v_mfma_f32_16x16x32_bf16 v[188:191], v[208:211], v[140:143], v[188:191]
    ds_read_b64_tr_b16 v[204:205], v236 offset:8192
    ds_read_b64_tr_b16 v[206:207], v236 offset:9216
    v_exp_f32 v186, v186
    s_waitcnt lgkmcnt(9)
    v_mfma_f32_16x16x32_bf16 v[160:163], v[212:215], v[96:99], v[144:147]
    v_add_f32 v229, v229, v177
    v_mfma_f32_16x16x32_bf16 v[168:171], v[212:215], v[112:115], v[148:151]
    v_add_f32 v231, v231, v185
    v_mfma_f32_16x16x32_bf16 v[192:195], v[212:215], v[128:131], 0
    ds_read_b64_tr_b16 v[208:209], v237 offset:8192
    ds_read_b64_tr_b16 v[210:211], v237 offset:9216
    v_exp_f32 v179, v179
    s_waitcnt lgkmcnt(10)
    v_mfma_f32_16x16x32_bf16 v[160:163], v[216:219], v[100:103], v[160:163]
    v_mfma_f32_16x16x32_bf16 v[168:171], v[216:219], v[116:119], v[168:171]
    v_exp_f32 v187, v187
    v_mfma_f32_16x16x32_bf16 v[192:195], v[216:219], v[132:135], v[192:195]
    ds_read_b64_tr_b16 v[212:213], v238 offset:8192
    ds_read_b64_tr_b16 v[214:215], v238 offset:9216
    v_cvt_pk_bf16_f32 v174, v176, v177
    s_waitcnt lgkmcnt(11)
    v_mfma_f32_16x16x32_bf16 v[160:163], v[220:223], v[104:107], v[160:163]
    v_cvt_pk_bf16_f32 v182, v184, v185
    v_mfma_f32_16x16x32_bf16 v[168:171], v[220:223], v[120:123], v[168:171]
    v_add_f32 v228, v228, v178
    v_mfma_f32_16x16x32_bf16 v[192:195], v[220:223], v[136:139], v[192:195]
    ds_read_b64_tr_b16 v[216:217], v239 offset:8192
    ds_read_b64_tr_b16 v[218:219], v239 offset:9216
    v_add_f32 v230, v230, v186
    v_add_f32 v229, v229, v179
    s_waitcnt lgkmcnt(12)
    v_mfma_f32_16x16x32_bf16 v[160:163], v[224:227], v[108:111], v[160:163]
    v_add_f32 v231, v231, v187
    v_mfma_f32_16x16x32_bf16 v[168:171], v[224:227], v[124:127], v[168:171]
    v_cvt_pk_bf16_f32 v175, v178, v179
    v_mfma_f32_16x16x32_bf16 v[192:195], v[224:227], v[140:143], v[192:195]
    ds_read_b64_tr_b16 v[220:221], v240 offset:8192
    ds_read_b64_tr_b16 v[222:223], v240 offset:9216
    v_cvt_pk_bf16_f32 v183, v186, v187
    s_branch VAR_10_j
VAR_11_t:
    s_waitcnt lgkmcnt(12)
    v_mfma_f32_16x16x32_bf16 v[0:3], v[196:199], v[172:175], v[0:3]
    v_exp_f32 v156, v156
    v_mfma_f32_16x16x32_bf16 v[32:35], v[196:199], v[180:183], v[32:35]
    v_mfma_f32_16x16x32_bf16 v[64:67], v[196:199], v[188:191], 0
    ds_read_b64_tr_b16 v[224:225], v241 offset:8192
    ds_read_b64_tr_b16 v[226:227], v241 offset:9216
    v_exp_f32 v164, v164
    s_waitcnt lgkmcnt(12)
    v_mfma_f32_16x16x32_bf16 v[4:7], v[200:203], v[172:175], v[4:7]
    v_mfma_f32_16x16x32_bf16 v[36:39], v[200:203], v[180:183], v[36:39]
    v_exp_f32 v157, v157
    v_mfma_f32_16x16x32_bf16 v[68:71], v[200:203], v[188:191], 0
    v_exp_f32 v165, v165
    s_waitcnt lgkmcnt(10)
    v_mfma_f32_16x16x32_bf16 v[8:11], v[204:207], v[172:175], v[8:11]
    v_mfma_f32_16x16x32_bf16 v[40:43], v[204:207], v[180:183], v[40:43]
    v_add_f32 v228, v228, v156
    v_mfma_f32_16x16x32_bf16 v[72:75], v[204:207], v[188:191], 0
    v_add_f32 v230, v230, v164
    s_waitcnt lgkmcnt(8)
    v_mfma_f32_16x16x32_bf16 v[12:15], v[208:211], v[172:175], v[12:15]
    v_exp_f32 v158, v158
    v_mfma_f32_16x16x32_bf16 v[44:47], v[208:211], v[180:183], v[44:47]
    v_mfma_f32_16x16x32_bf16 v[76:79], v[208:211], v[188:191], 0
    s_waitcnt vmcnt(4) lgkmcnt(0)
    s_barrier
    ds_read_b128 v[196:199], v242 offset:16384
    ds_read_b128 v[200:203], v243 offset:16384
    ds_read_b128 v[204:207], v244 offset:16384
    v_exp_f32 v166, v166
    v_mfma_f32_16x16x32_bf16 v[16:19], v[212:215], v[172:175], v[16:19]
    s_add_u32 m0, s25, 73728
    s_nop 0
    buffer_load_dwordx4 v246, s[8:11], s26 offen nt lds
    v_add_f32 v229, v229, v157
    v_mfma_f32_16x16x32_bf16 v[48:51], v[212:215], v[180:183], v[48:51]
    buffer_load_dwordx4 v246, s[8:11], s26 offen offset:1024 nt lds
    s_add_u32 s26, s26, 8192
    v_add_f32 v231, v231, v165
    v_mfma_f32_16x16x32_bf16 v[80:83], v[212:215], v[188:191], 0
    s_add_u32 m0, s25, 32768
    s_nop 0
    buffer_load_dwordx4 v247, s[12:15], s27 offen nt lds
    ds_read_b128 v[208:211], v245 offset:16384
    v_exp_f32 v159, v159
    v_mfma_f32_16x16x32_bf16 v[20:23], v[216:219], v[172:175], v[20:23]
    buffer_load_dwordx4 v247, s[12:15], s27 offen offset:1024 nt lds
    s_add_u32 s27, s27, 8192
    v_mfma_f32_16x16x32_bf16 v[52:55], v[216:219], v[180:183], v[52:55]
    v_exp_f32 v167, v167
    v_mfma_f32_16x16x32_bf16 v[84:87], v[216:219], v[188:191], 0
    ds_read_b128 v[212:215], v242 offset:17408
    v_cvt_pk_bf16_f32 v156, v156, v157
    v_mfma_f32_16x16x32_bf16 v[24:27], v[220:223], v[172:175], v[24:27]
    v_cvt_pk_bf16_f32 v164, v164, v165
    v_mfma_f32_16x16x32_bf16 v[56:59], v[220:223], v[180:183], v[56:59]
    v_add_f32 v228, v228, v158
    v_mfma_f32_16x16x32_bf16 v[88:91], v[220:223], v[188:191], 0
    ds_read_b128 v[216:219], v243 offset:17408
    v_add_f32 v230, v230, v166
    v_add_f32 v229, v229, v159
    v_mfma_f32_16x16x32_bf16 v[28:31], v[224:227], v[172:175], v[28:31]
    v_add_f32 v231, v231, v167
    v_mfma_f32_16x16x32_bf16 v[60:63], v[224:227], v[180:183], v[60:63]
    v_cvt_pk_bf16_f32 v157, v158, v159
    v_mfma_f32_16x16x32_bf16 v[92:95], v[224:227], v[188:191], 0
    ds_read_b128 v[220:223], v244 offset:17408
    v_cvt_pk_bf16_f32 v165, v166, v167
    s_branch VAR_11_j
VAR_12_t:
    v_max3_f32 v253, v188, v189, v190
    v_max3_f32 v253, v253, v191, v192
    v_max3_f32 v253, v253, v193, v194
    v_max_f32 v253, v253, v195
    v_mov_b32 v254, v253
    s_nop 1
    v_permlane16_swap_b32 v253, v254
    v_max_f32 v253, v253, v254
    v_mov_b32 v254, v253
    s_nop 1
    v_permlane32_swap_b32 v253, v254
    v_max_f32 v253, v253, v254
    s_cmp_eq_u32 s63, 1
    s_cbranch_scc1 SKIPM_13
    v_sub_f32 v152, 0, v253
    v_sub_f32 v153, 0, v253
    v_sub_f32 v154, 0, v253
    v_sub_f32 v155, 0, v253
SKIPM_13:
    v_add_f32 v188, v188, v152
    v_add_f32 v189, v189, v152
    v_add_f32 v190, v190, v152
    v_add_f32 v191, v191, v152
    v_add_f32 v192, v192, v152
    v_add_f32 v193, v193, v152
    v_add_f32 v194, v194, v152
    v_add_f32 v195, v195, v152
    v_exp_f32 v188, v188
    v_exp_f32 v189, v189
    v_add_f32 v232, v232, v188
    v_exp_f32 v190, v190
    v_add_f32 v233, v233, v189
    v_exp_f32 v191, v191
    v_cvt_pk_bf16_f32 v188, v188, v189
    v_add_f32 v232, v232, v190
    v_add_f32 v233, v233, v191
    v_cvt_pk_bf16_f32 v189, v190, v191
    v_exp_f32 v192, v192
    v_exp_f32 v193, v193
    v_add_f32 v232, v232, v192
    v_exp_f32 v194, v194
    v_add_f32 v233, v233, v193
    v_exp_f32 v195, v195
    v_cvt_pk_bf16_f32 v190, v192, v193
    v_add_f32 v232, v232, v194
    v_add_f32 v233, v233, v195
    v_cvt_pk_bf16_f32 v191, v194, v195
    s_branch VAR_12_j
VAR_14_t:
    s_waitcnt lgkmcnt(6)
    v_mfma_f32_16x16x32_bf16 v[172:175], v[196:199], v[96:99], v[144:147]
    v_exp_f32 v160, v160
    v_mfma_f32_16x16x32_bf16 v[180:183], v[196:199], v[112:115], v[148:151]
    v_mfma_f32_16x16x32_bf16 v[188:191], v[196:199], v[128:131], 0
    ds_read_b128 v[224:227], v245 offset:17408
    v_exp_f32 v168, v168
    s_waitcnt lgkmcnt(6)
    v_mfma_f32_16x16x32_bf16 v[172:175], v[200:203], v[100:103], v[172:175]
    v_mfma_f32_16x16x32_bf16 v[180:183], v[200:203], v[116:119], v[180:183]
    v_exp_f32 v161, v161
    v_mfma_f32_16x16x32_bf16 v[188:191], v[200:203], v[132:135], v[188:191]
    ds_read_b64_tr_b16 v[196:197], v234 offset:16384
    ds_read_b64_tr_b16 v[198:199], v234 offset:17408
    v_exp_f32 v169, v169
    s_waitcnt lgkmcnt(7)
    v_mfma_f32_16x16x32_bf16 v[172:175], v[204:207], v[104:107], v[172:175]
    v_mfma_f32_16x16x32_bf16 v[180:183], v[204:207], v[120:123], v[180:183]
    v_add_f32 v228, v228, v160
    v_mfma_f32_16x16x32_bf16 v[188:191], v[204:207], v[136:139], v[188:191]
    ds_read_b64_tr_b16 v[200:201], v235 offset:16384
    ds_read_b64_tr_b16 v[202:203], v235 offset:17408
    v_add_f32 v230, v230, v168
    s_waitcnt lgkmcnt(8)
    v_mfma_f32_16x16x32_bf16 v[172:175], v[208:211], v[108:111], v[172:175]
    v_exp_f32 v162, v162
    v_mfma_f32_16x16x32_bf16 v[180:183], v[208:211], v[124:127], v[180:183]
    v_mfma_f32_16x16x32_bf16 v[188:191], v[208:211], v[140:143], v[188:191]
    ds_read_b64_tr_b16 v[204:205], v236 offset:16384
    ds_read_b64_tr_b16 v[206:207], v236 offset:17408
    v_exp_f32 v170, v170
    s_waitcnt lgkmcnt(9)
    v_mfma_f32_16x16x32_bf16 v[176:179], v[212:215], v[96:99], v[144:147]
    v_add_f32 v229, v229, v161
    v_mfma_f32_16x16x32_bf16 v[184:187], v[212:215], v[112:115], v[148:151]
    v_add_f32 v231, v231, v169
    v_mfma_f32_16x16x32_bf16 v[192:195], v[212:215], v[128:131], 0
    ds_read_b64_tr_b16 v[208:209], v237 offset:16384
    ds_read_b64_tr_b16 v[210:211], v237 offset:17408
    v_exp_f32 v163, v163
    s_waitcnt lgkmcnt(10)
    v_mfma_f32_16x16x32_bf16 v[176:179], v[216:219], v[100:103], v[176:179]
    v_mfma_f32_16x16x32_bf16 v[184:187], v[216:219], v[116:119], v[184:187]
    v_exp_f32 v171, v171
    v_mfma_f32_16x16x32_bf16 v[192:195], v[216:219], v[132:135], v[192:195]
    ds_read_b64_tr_b16 v[212:213], v238 offset:16384
    ds_read_b64_tr_b16 v[214:215], v238 offset:17408
    v_cvt_pk_bf16_f32 v158, v160, v161
    s_waitcnt lgkmcnt(11)
    v_mfma_f32_16x16x32_bf16 v[176:179], v[220:223], v[104:107], v[176:179]
    v_cvt_pk_bf16_f32 v166, v168, v169
    v_mfma_f32_16x16x32_bf16 v[184:187], v[220:223], v[120:123], v[184:187]
    v_add_f32 v228, v228, v162
    v_mfma_f32_16x16x32_bf16 v[192:195], v[220:223], v[136:139], v[192:195]
    ds_read_b64_tr_b16 v[216:217], v239 offset:16384
    ds_read_b64_tr_b16 v[218:219], v239 offset:17408
    v_add_f32 v230, v230, v170
    v_add_f32 v229, v229, v163
    s_waitcnt lgkmcnt(12)
    v_mfma_f32_16x16x32_bf16 v[176:179], v[224:227], v[108:111], v[176:179]
    v_add_f32 v231, v231, v171
    v_mfma_f32_16x16x32_bf16 v[184:187], v[224:227], v[124:127], v[184:187]
    v_cvt_pk_bf16_f32 v159, v162, v163
    v_mfma_f32_16x16x32_bf16 v[192:195], v[224:227], v[140:143], v[192:195]
    ds_read_b64_tr_b16 v[220:221], v240 offset:16384
    ds_read_b64_tr_b16 v[222:223], v240 offset:17408
    v_cvt_pk_bf16_f32 v167, v170, v171
    s_branch VAR_14_j
VAR_15_t:
    s_waitcnt lgkmcnt(12)
    v_mfma_f32_16x16x32_bf16 v[0:3], v[196:199], v[156:159], v[0:3]
    v_exp_f32 v172, v172
    v_mfma_f32_16x16x32_bf16 v[32:35], v[196:199], v[164:167], v[32:35]
    v_mfma_f32_16x16x32_bf16 v[64:67], v[196:199], v[188:191], 0
    ds_read_b64_tr_b16 v[224:225], v241 offset:16384
    ds_read_b64_tr_b16 v[226:227], v241 offset:17408
    v_exp_f32 v180, v180
    s_waitcnt lgkmcnt(12)
    v_mfma_f32_16x16x32_bf16 v[4:7], v[200:203], v[156:159], v[4:7]
    v_mfma_f32_16x16x32_bf16 v[36:39], v[200:203], v[164:167], v[36:39]
    v_exp_f32 v173, v173
    v_mfma_f32_16x16x32_bf16 v[68:71], v[200:203], v[188:191], 0
    v_exp_f32 v181, v181
    s_waitcnt lgkmcnt(10)
    v_mfma_f32_16x16x32_bf16 v[8:11], v[204:207], v[156:159], v[8:11]
    v_mfma_f32_16x16x32_bf16 v[40:43], v[204:207], v[164:167], v[40:43]
    v_add_f32 v228, v228, v172
    v_mfma_f32_16x16x32_bf16 v[72:75], v[204:207], v[188:191], 0
    v_add_f32 v230, v230, v180
    s_waitcnt lgkmcnt(8)
    v_mfma_f32_16x16x32_bf16 v[12:15], v[208:211], v[156:159], v[12:15]
    v_exp_f32 v174, v174
    v_mfma_f32_16x16x32_bf16 v[44:47], v[208:211], v[164:167], v[44:47]
    v_mfma_f32_16x16x32_bf16 v[76:79], v[208:211], v[188:191], 0
    s_waitcnt vmcnt(4) lgkmcnt(0)
    s_barrier
    ds_read_b128 v[196:199], v242 offset:24576
    ds_read_b128 v[200:203], v243 offset:24576
    ds_read_b128 v[204:207], v244 offset:24576
    v_exp_f32 v182, v182
    v_mfma_f32_16x16x32_bf16 v[16:19], v[212:215], v[156:159], v[16:19]
    s_add_u32 m0, s25, 40960
    s_nop 0
    buffer_load_dwordx4 v246, s[8:11], s26 offen nt lds
    v_add_f32 v229, v229, v173
    v_mfma_f32_16x16x32_bf16 v[48:51], v[212:215], v[164:167], v[48:51]
    buffer_load_dwordx4 v246, s[8:11], s26 offen offset:1024 nt lds
    s_add_u32 s26, s26, 8192
    v_add_f32 v231, v231, v181
    v_mfma_f32_16x16x32_bf16 v[80:83], v[212:215], v[188:191], 0
    s_add_u32 m0, s25, 0
    s_nop 0
    buffer_load_dwordx4 v247, s[12:15], s27 offen nt lds
    ds_read_b128 v[208:211], v245 offset:24576
    v_exp_f32 v175, v175
    v_mfma_f32_16x16x32_bf16 v[20:23], v[216:219], v[156:159], v[20:23]
    buffer_load_dwordx4 v247, s[12:15], s27 offen offset:1024 nt lds
    s_add_u32 s27, s27, 8192
    v_mfma_f32_16x16x32_bf16 v[52:55], v[216:219], v[164:167], v[52:55]
    v_exp_f32 v183, v183
    v_mfma_f32_16x16x32_bf16 v[84:87], v[216:219], v[188:191], 0
    ds_read_b128 v[212:215], v242 offset:25600
    v_cvt_pk_bf16_f32 v172, v172, v173
    v_mfma_f32_16x16x32_bf16 v[24:27], v[220:223], v[156:159], v[24:27]
    v_cvt_pk_bf16_f32 v180, v180, v181
    v_mfma_f32_16x16x32_bf16 v[56:59], v[220:223], v[164:167], v[56:59]
    v_add_f32 v228, v228, v174
    v_mfma_f32_16x16x32_bf16 v[88:91], v[220:223], v[188:191], 0
    ds_read_b128 v[216:219], v243 offset:25600
    v_add_f32 v230, v230, v182
    v_add_f32 v229, v229, v175
    v_mfma_f32_16x16x32_bf16 v[28:31], v[224:227], v[156:159], v[28:31]
    v_add_f32 v231, v231, v183
    v_mfma_f32_16x16x32_bf16 v[60:63], v[224:227], v[164:167], v[60:63]
    v_cvt_pk_bf16_f32 v173, v174, v175
    v_mfma_f32_16x16x32_bf16 v[92:95], v[224:227], v[188:191], 0
    ds_read_b128 v[220:223], v244 offset:25600
    v_cvt_pk_bf16_f32 v181, v182, v183
    s_branch VAR_15_j
VAR_16_t:
    v_max3_f32 v253, v188, v189, v190
    v_max3_f32 v253, v253, v191, v192
    v_max3_f32 v253, v253, v193, v194
    v_max_f32 v253, v253, v195
    v_mov_b32 v254, v253
    s_nop 1
    v_permlane16_swap_b32 v253, v254
    v_max_f32 v253, v253, v254
    v_mov_b32 v254, v253
    s_nop 1
    v_permlane32_swap_b32 v253, v254
    v_max_f32 v253, v253, v254
    s_cmp_eq_u32 s63, 1
    s_cbranch_scc1 SKIPM_17
    v_sub_f32 v152, 0, v253
    v_sub_f32 v153, 0, v253
    v_sub_f32 v154, 0, v253
    v_sub_f32 v155, 0, v253
SKIPM_17:
    v_add_f32 v188, v188, v152
    v_add_f32 v189, v189, v152
    v_add_f32 v190, v190, v152
    v_add_f32 v191, v191, v152
    v_add_f32 v192, v192, v152
    v_add_f32 v193, v193, v152
    v_add_f32 v194, v194, v152
    v_add_f32 v195, v195, v152
    v_exp_f32 v188, v188
    v_exp_f32 v189, v189
    v_add_f32 v232, v232, v188
    v_exp_f32 v190, v190
    v_add_f32 v233, v233, v189
    v_exp_f32 v191, v191
    v_cvt_pk_bf16_f32 v188, v188, v189
    v_add_f32 v232, v232, v190
    v_add_f32 v233, v233, v191
    v_cvt_pk_bf16_f32 v189, v190, v191
    v_exp_f32 v192, v192
    v_exp_f32 v193, v193
    v_add_f32 v232, v232, v192
    v_exp_f32 v194, v194
    v_add_f32 v233, v233, v193
    v_exp_f32 v195, v195
    v_cvt_pk_bf16_f32 v190, v192, v193
    v_add_f32 v232, v232, v194
    v_add_f32 v233, v233, v195
    v_cvt_pk_bf16_f32 v191, v194, v195
    s_branch VAR_16_j
VAR_18_t:
    s_waitcnt lgkmcnt(6)
    v_mfma_f32_16x16x32_bf16 v[156:159], v[196:199], v[96:99], v[144:147]
    v_exp_f32 v176, v176
    v_mfma_f32_16x16x32_bf16 v[164:167], v[196:199], v[112:115], v[148:151]
    v_mfma_f32_16x16x32_bf16 v[188:191], v[196:199], v[128:131], v[152:155]
    ds_read_b128 v[224:227], v245 offset:25600
    v_exp_f32 v184, v184
    s_waitcnt lgkmcnt(6)
    v_mfma_f32_16x16x32_bf16 v[156:159], v[200:203], v[100:103], v[156:159]
    v_mfma_f32_16x16x32_bf16 v[164:167], v[200:203], v[116:119], v[164:167]
    v_exp_f32 v177, v177
    v_mfma_f32_16x16x32_bf16 v[188:191], v[200:203], v[132:135], v[188:191]
    ds_read_b64_tr_b16 v[196:197], v234 offset:24576
    ds_read_b64_tr_b16 v[198:199], v234 offset:25600
    v_exp_f32 v185, v185
    s_waitcnt lgkmcnt(7)
    v_mfma_f32_16x16x32_bf16 v[156:159], v[204:207], v[104:107], v[156:159]
    v_mfma_f32_16x16x32_bf16 v[164:167], v[204:207], v[120:123], v[164:167]
    v_add_f32 v228, v228, v176
    v_mfma_f32_16x16x32_bf16 v[188:191], v[204:207], v[136:139], v[188:191]
    ds_read_b64_tr_b16 v[200:201], v235 offset:24576
    ds_read_b64_tr_b16 v[202:203], v235 offset:25600
    v_add_f32 v230, v230, v184
    s_waitcnt lgkmcnt(8)
    v_mfma_f32_16x16x32_bf16 v[156:159], v[208:211], v[108:111], v[156:159]
    v_exp_f32 v178, v178
    v_mfma_f32_16x16x32_bf16 v[164:167], v[208:211], v[124:127], v[164:167]
    v_mfma_f32_16x16x32_bf16 v[188:191], v[208:211], v[140:143], v[188:191]
    ds_read_b64_tr_b16 v[204:205], v236 offset:24576
    ds_read_b64_tr_b16 v[206:207], v236 offset:25600
    v_exp_f32 v186, v186
    s_waitcnt lgkmcnt(9)
    v_mfma_f32_16x16x32_bf16 v[160:163], v[212:215], v[96:99], v[144:147]
    v_add_f32 v229, v229, v177
    v_mfma_f32_16x16x32_bf16 v[168:171], v[212:215], v[112:115], v[148:151]
    v_add_f32 v231, v231, v185
    v_mfma_f32_16x16x32_bf16 v[192:195], v[212:215], v[128:131], v[152:155]
    ds_read_b64_tr_b16 v[208:209], v237 offset:24576
    ds_read_b64_tr_b16 v[210:211], v237 offset:25600
    v_exp_f32 v179, v179
    s_waitcnt lgkmcnt(10)
    v_mfma_f32_16x16x32_bf16 v[160:163], v[216:219], v[100:103], v[160:163]
    v_mfma_f32_16x16x32_bf16 v[168:171], v[216:219], v[116:119], v[168:171]
    v_exp_f32 v187, v187
    v_mfma_f32_16x16x32_bf16 v[192:195], v[216:219], v[132:135], v[192:195]
    ds_read_b64_tr_b16 v[212:213], v238 offset:24576
    ds_read_b64_tr_b16 v[214:215], v238 offset:25600
    v_cvt_pk_bf16_f32 v174, v176, v177
    s_waitcnt lgkmcnt(11)
    v_mfma_f32_16x16x32_bf16 v[160:163], v[220:223], v[104:107], v[160:163]
    v_cvt_pk_bf16_f32 v182, v184, v185
    v_mfma_f32_16x16x32_bf16 v[168:171], v[220:223], v[120:123], v[168:171]
    v_add_f32 v228, v228, v178
    v_mfma_f32_16x16x32_bf16 v[192:195], v[220:223], v[136:139], v[192:195]
    ds_read_b64_tr_b16 v[216:217], v239 offset:24576
    ds_read_b64_tr_b16 v[218:219], v239 offset:25600
    v_add_f32 v230, v230, v186
    v_add_f32 v229, v229, v179
    s_waitcnt lgkmcnt(12)
    v_mfma_f32_16x16x32_bf16 v[160:163], v[224:227], v[108:111], v[160:163]
    v_add_f32 v231, v231, v187
    v_mfma_f32_16x16x32_bf16 v[168:171], v[224:227], v[124:127], v[168:171]
    v_cvt_pk_bf16_f32 v175, v178, v179
    v_mfma_f32_16x16x32_bf16 v[192:195], v[224:227], v[140:143], v[192:195]
    ds_read_b64_tr_b16 v[220:221], v240 offset:24576
    ds_read_b64_tr_b16 v[222:223], v240 offset:25600
    v_cvt_pk_bf16_f32 v183, v186, v187
    s_branch VAR_18_j
VAR_19_t:
    s_waitcnt lgkmcnt(12)
    v_mfma_f32_16x16x32_bf16 v[0:3], v[196:199], v[172:175], v[0:3]
    v_exp_f32 v156, v156
    v_mfma_f32_16x16x32_bf16 v[32:35], v[196:199], v[180:183], v[32:35]
    v_mfma_f32_16x16x32_bf16 v[64:67], v[196:199], v[188:191], 0
    ds_read_b64_tr_b16 v[224:225], v241 offset:24576
    ds_read_b64_tr_b16 v[226:227], v241 offset:25600
    v_exp_f32 v164, v164
    s_waitcnt lgkmcnt(12)
    v_mfma_f32_16x16x32_bf16 v[4:7], v[200:203], v[172:175], v[4:7]
    v_mfma_f32_16x16x32_bf16 v[36:39], v[200:203], v[180:183], v[36:39]
    v_exp_f32 v157, v157
    v_mfma_f32_16x16x32_bf16 v[68:71], v[200:203], v[188:191], 0
    v_exp_f32 v165, v165
    s_waitcnt lgkmcnt(10)
    v_mfma_f32_16x16x32_bf16 v[8:11], v[204:207], v[172:175], v[8:11]
    v_mfma_f32_16x16x32_bf16 v[40:43], v[204:207], v[180:183], v[40:43]
    v_add_f32 v228, v228, v156
    v_mfma_f32_16x16x32_bf16 v[72:75], v[204:207], v[188:191], 0
    v_add_f32 v230, v230, v164
    s_waitcnt lgkmcnt(8)
    v_mfma_f32_16x16x32_bf16 v[12:15], v[208:211], v[172:175], v[12:15]
    v_exp_f32 v158, v158
    v_mfma_f32_16x16x32_bf16 v[44:47], v[208:211], v[180:183], v[44:47]
    v_mfma_f32_16x16x32_bf16 v[76:79], v[208:211], v[188:191], 0
    s_waitcnt vmcnt(4) lgkmcnt(0)
    s_barrier
    ds_read_b128 v[196:199], v242 offset:32768
    ds_read_b128 v[200:203], v243 offset:32768
    ds_read_b128 v[204:207], v244 offset:32768
    v_exp_f32 v166, v166
    v_mfma_f32_16x16x32_bf16 v[16:19], v[212:215], v[172:175], v[16:19]
    s_add_u32 m0, s25, 49152
    s_nop 0
    buffer_load_dwordx4 v246, s[8:11], s26 offen nt lds
    v_add_f32 v229, v229, v157
    v_mfma_f32_16x16x32_bf16 v[48:51], v[212:215], v[180:183], v[48:51]
    buffer_load_dwordx4 v246, s[8:11], s26 offen offset:1024 nt lds
    s_add_u32 s26, s26, 8192
    v_add_f32 v231, v231, v165
    v_mfma_f32_16x16x32_bf16 v[80:83], v[212:215], v[188:191], 0
    s_add_u32 m0, s25, 8192
    s_nop 0
    buffer_load_dwordx4 v247, s[12:15], s27 offen nt lds
    ds_read_b128 v[208:211], v245 offset:32768
    v_exp_f32 v159, v159
    v_mfma_f32_16x16x32_bf16 v[20:23], v[216:219], v[172:175], v[20:23]
    buffer_load_dwordx4 v247, s[12:15], s27 offen offset:1024 nt lds
    s_add_u32 s27, s27, 8192
    v_mfma_f32_16x16x32_bf16 v[52:55], v[216:219], v[180:183], v[52:55]
    v_exp_f32 v167, v167
    v_mfma_f32_16x16x32_bf16 v[84:87], v[216:219], v[188:191], 0
    ds_read_b128 v[212:215], v242 offset:33792
    v_cvt_pk_bf16_f32 v156, v156, v157
    v_mfma_f32_16x16x32_bf16 v[24:27], v[220:223], v[172:175], v[24:27]
    v_cvt_pk_bf16_f32 v164, v164, v165
    v_mfma_f32_16x16x32_bf16 v[56:59], v[220:223], v[180:183], v[56:59]
    v_add_f32 v228, v228, v158
    v_mfma_f32_16x16x32_bf16 v[88:91], v[220:223], v[188:191], 0
    ds_read_b128 v[216:219], v243 offset:33792
    v_add_f32 v230, v230, v166
    v_add_f32 v229, v229, v159
    v_mfma_f32_16x16x32_bf16 v[28:31], v[224:227], v[172:175], v[28:31]
    v_add_f32 v231, v231, v167
    v_mfma_f32_16x16x32_bf16 v[60:63], v[224:227], v[180:183], v[60:63]
    v_cvt_pk_bf16_f32 v157, v158, v159
    v_mfma_f32_16x16x32_bf16 v[92:95], v[224:227], v[188:191], 0
    ds_read_b128 v[220:223], v244 offset:33792
    v_cvt_pk_bf16_f32 v165, v166, v167
    s_branch VAR_19_j
VAR_20_t:
    v_exp_f32 v188, v188
    v_exp_f32 v189, v189
    v_add_f32 v232, v232, v188
    v_exp_f32 v190, v190
    v_add_f32 v233, v233, v189
    v_exp_f32 v191, v191
    v_cvt_pk_bf16_f32 v188, v188, v189
    v_add_f32 v232, v232, v190
    v_add_f32 v233, v233, v191
    v_cvt_pk_bf16_f32 v189, v190, v191
    v_exp_f32 v192, v192
    v_exp_f32 v193, v193
    v_add_f32 v232, v232, v192
    v_exp_f32 v194, v194
    v_add_f32 v233, v233, v193
    v_exp_f32 v195, v195
    v_cvt_pk_bf16_f32 v190, v192, v193
    v_add_f32 v232, v232, v194
    v_add_f32 v233, v233, v195
    v_cvt_pk_bf16_f32 v191, v194, v195
    s_branch VAR_20_j
VAR_21_t:
    s_waitcnt lgkmcnt(6)
    v_mfma_f32_16x16x32_bf16 v[172:175], v[196:199], v[96:99], v[144:147]
    v_exp_f32 v160, v160
    v_mfma_f32_16x16x32_bf16 v[180:183], v[196:199], v[112:115], v[148:151]
    v_mfma_f32_16x16x32_bf16 v[188:191], v[196:199], v[128:131], v[152:155]
    ds_read_b128 v[224:227], v245 offset:33792
    v_exp_f32 v168, v168
    s_waitcnt lgkmcnt(6)
    v_mfma_f32_16x16x32_bf16 v[172:175], v[200:203], v[100:103], v[172:175]
    v_mfma_f32_16x16x32_bf16 v[180:183], v[200:203], v[116:119], v[180:183]
    v_exp_f32 v161, v161
    v_mfma_f32_16x16x32_bf16 v[188:191], v[200:203], v[132:135], v[188:191]
    ds_read_b64_tr_b16 v[196:197], v234 offset:32768
    ds_read_b64_tr_b16 v[198:199], v234 offset:33792
    v_exp_f32 v169, v169
    s_waitcnt lgkmcnt(7)
    v_mfma_f32_16x16x32_bf16 v[172:175], v[204:207], v[104:107], v[172:175]
    v_mfma_f32_16x16x32_bf16 v[180:183], v[204:207], v[120:123], v[180:183]
    v_add_f32 v228, v228, v160
    v_mfma_f32_16x16x32_bf16 v[188:191], v[204:207], v[136:139], v[188:191]
    ds_read_b64_tr_b16 v[200:201], v235 offset:32768
    ds_read_b64_tr_b16 v[202:203], v235 offset:33792
    v_add_f32 v230, v230, v168
    s_waitcnt lgkmcnt(8)
    v_mfma_f32_16x16x32_bf16 v[172:175], v[208:211], v[108:111], v[172:175]
    v_exp_f32 v162, v162
    v_mfma_f32_16x16x32_bf16 v[180:183], v[208:211], v[124:127], v[180:183]
    v_mfma_f32_16x16x32_bf16 v[188:191], v[208:211], v[140:143], v[188:191]
    ds_read_b64_tr_b16 v[204:205], v236 offset:32768
    ds_read_b64_tr_b16 v[206:207], v236 offset:33792
    v_exp_f32 v170, v170
    s_waitcnt lgkmcnt(9)
    v_mfma_f32_16x16x32_bf16 v[176:179], v[212:215], v[96:99], v[144:147]
    v_add_f32 v229, v229, v161
    v_mfma_f32_16x16x32_bf16 v[184:187], v[212:215], v[112:115], v[148:151]
    v_add_f32 v231, v231, v169
    v_mfma_f32_16x16x32_bf16 v[192:195], v[212:215], v[128:131], v[152:155]
    ds_read_b64_tr_b16 v[208:209], v237 offset:32768
    ds_read_b64_tr_b16 v[210:211], v237 offset:33792
    v_exp_f32 v163, v163
    s_waitcnt lgkmcnt(10)
    v_mfma_f32_16x16x32_bf16 v[176:179], v[216:219], v[100:103], v[176:179]
    v_mfma_f32_16x16x32_bf16 v[184:187], v[216:219], v[116:119], v[184:187]
    v_exp_f32 v171, v171
    v_mfma_f32_16x16x32_bf16 v[192:195], v[216:219], v[132:135], v[192:195]
    ds_read_b64_tr_b16 v[212:213], v238 offset:32768
    ds_read_b64_tr_b16 v[214:215], v238 offset:33792
    v_cvt_pk_bf16_f32 v158, v160, v161
    s_waitcnt lgkmcnt(11)
    v_mfma_f32_16x16x32_bf16 v[176:179], v[220:223], v[104:107], v[176:179]
    v_cvt_pk_bf16_f32 v166, v168, v169
    v_mfma_f32_16x16x32_bf16 v[184:187], v[220:223], v[120:123], v[184:187]
    v_add_f32 v228, v228, v162
    v_mfma_f32_16x16x32_bf16 v[192:195], v[220:223], v[136:139], v[192:195]
    ds_read_b64_tr_b16 v[216:217], v239 offset:32768
    ds_read_b64_tr_b16 v[218:219], v239 offset:33792
    v_add_f32 v230, v230, v170
    v_add_f32 v229, v229, v163
    s_waitcnt lgkmcnt(12)
    v_mfma_f32_16x16x32_bf16 v[176:179], v[224:227], v[108:111], v[176:179]
    v_add_f32 v231, v231, v171
    v_mfma_f32_16x16x32_bf16 v[184:187], v[224:227], v[124:127], v[184:187]
    v_cvt_pk_bf16_f32 v159, v162, v163
    v_mfma_f32_16x16x32_bf16 v[192:195], v[224:227], v[140:143], v[192:195]
    ds_read_b64_tr_b16 v[220:221], v240 offset:32768
    ds_read_b64_tr_b16 v[222:223], v240 offset:33792
    v_cvt_pk_bf16_f32 v167, v170, v171
    s_branch VAR_21_j
VAR_22_t:
    s_waitcnt lgkmcnt(12)
    v_mfma_f32_16x16x32_bf16 v[0:3], v[196:199], v[156:159], v[0:3]
    v_exp_f32 v172, v172
    v_mfma_f32_16x16x32_bf16 v[32:35], v[196:199], v[164:167], v[32:35]
    v_mfma_f32_16x16x32_bf16 v[64:67], v[196:199], v[188:191], v[64:67]
    ds_read_b64_tr_b16 v[224:225], v241 offset:32768
    ds_read_b64_tr_b16 v[226:227], v241 offset:33792
    v_exp_f32 v180, v180
    s_waitcnt lgkmcnt(12)
    v_mfma_f32_16x16x32_bf16 v[4:7], v[200:203], v[156:159], v[4:7]
    v_mfma_f32_16x16x32_bf16 v[36:39], v[200:203], v[164:167], v[36:39]
    v_exp_f32 v173, v173
    v_mfma_f32_16x16x32_bf16 v[68:71], v[200:203], v[188:191], v[68:71]
    v_exp_f32 v181, v181
    s_waitcnt lgkmcnt(10)
    v_mfma_f32_16x16x32_bf16 v[8:11], v[204:207], v[156:159], v[8:11]
    v_mfma_f32_16x16x32_bf16 v[40:43], v[204:207], v[164:167], v[40:43]
    v_add_f32 v228, v228, v172
    v_mfma_f32_16x16x32_bf16 v[72:75], v[204:207], v[188:191], v[72:75]
    v_add_f32 v230, v230, v180
    s_waitcnt lgkmcnt(8)
    v_mfma_f32_16x16x32_bf16 v[12:15], v[208:211], v[156:159], v[12:15]
    v_exp_f32 v174, v174
    v_mfma_f32_16x16x32_bf16 v[44:47], v[208:211], v[164:167], v[44:47]
    v_mfma_f32_16x16x32_bf16 v[76:79], v[208:211], v[188:191], v[76:79]
    s_waitcnt vmcnt(4) lgkmcnt(0)
    s_barrier
    ds_read_b128 v[196:199], v242
    ds_read_b128 v[200:203], v243
    ds_read_b128 v[204:207], v244
    v_exp_f32 v182, v182
    v_mfma_f32_16x16x32_bf16 v[16:19], v[212:215], v[156:159], v[16:19]
    s_add_u32 m0, s25, 57344
    s_nop 0
    buffer_load_dwordx4 v246, s[8:11], s26 offen nt lds
    v_add_f32 v229, v229, v173
    v_mfma_f32_16x16x32_bf16 v[48:51], v[212:215], v[164:167], v[48:51]
    buffer_load_dwordx4 v246, s[8:11], s26 offen offset:1024 nt lds
    s_add_u32 s26, s26, 8192
    v_add_f32 v231, v231, v181
    v_mfma_f32_16x16x32_bf16 v[80:83], v[212:215], v[188:191], v[80:83]
    s_add_u32 m0, s25, 16384
    s_nop 0
    buffer_load_dwordx4 v247, s[12:15], s27 offen nt lds
    ds_read_b128 v[208:211], v245
    v_exp_f32 v175, v175
    v_mfma_f32_16x16x32_bf16 v[20:23], v[216:219], v[156:159], v[20:23]
    buffer_load_dwordx4 v247, s[12:15], s27 offen offset:1024 nt lds
    s_add_u32 s27, s27, 8192
    v_mfma_f32_16x16x32_bf16 v[52:55], v[216:219], v[164:167], v[52:55]
    v_exp_f32 v183, v183
    v_mfma_f32_16x16x32_bf16 v[84:87], v[216:219], v[188:191], v[84:87]
    ds_read_b128 v[212:215], v242 offset:1024
    v_cvt_pk_bf16_f32 v172, v172, v173
    v_mfma_f32_16x16x32_bf16 v[24:27], v[220:223], v[156:159], v[24:27]
    v_cvt_pk_bf16_f32 v180, v180, v181
    v_mfma_f32_16x16x32_bf16 v[56:59], v[220:223], v[164:167], v[56:59]
    v_add_f32 v228, v228, v174
    v_mfma_f32_16x16x32_bf16 v[88:91], v[220:223], v[188:191], v[88:91]
    ds_read_b128 v[216:219], v243 offset:1024
    v_add_f32 v230, v230, v182
    v_add_f32 v229, v229, v175
    v_mfma_f32_16x16x32_bf16 v[28:31], v[224:227], v[156:159], v[28:31]
    v_add_f32 v231, v231, v183
    v_mfma_f32_16x16x32_bf16 v[60:63], v[224:227], v[164:167], v[60:63]
    v_cvt_pk_bf16_f32 v173, v174, v175
    v_mfma_f32_16x16x32_bf16 v[92:95], v[224:227], v[188:191], v[92:95]
    ds_read_b128 v[220:223], v244 offset:1024
    v_cvt_pk_bf16_f32 v181, v182, v183
    s_branch VAR_22_j
VAR_23_t:
    v_exp_f32 v188, v188
    v_exp_f32 v189, v189
    v_add_f32 v232, v232, v188
    v_exp_f32 v190, v190
    v_add_f32 v233, v233, v189
    v_exp_f32 v191, v191
    v_cvt_pk_bf16_f32 v188, v188, v189
    v_add_f32 v232, v232, v190
    v_add_f32 v233, v233, v191
    v_cvt_pk_bf16_f32 v189, v190, v191
    v_exp_f32 v192, v192
    v_exp_f32 v193, v193
    v_add_f32 v232, v232, v192
    v_exp_f32 v194, v194
    v_add_f32 v233, v233, v193
    v_exp_f32 v195, v195
    v_cvt_pk_bf16_f32 v190, v192, v193
    v_add_f32 v232, v232, v194
    v_add_f32 v233, v233, v195
    v_cvt_pk_bf16_f32 v191, v194, v195
    s_branch VAR_23_j
VAR_24_t:
    s_waitcnt lgkmcnt(6)
    v_mfma_f32_16x16x32_bf16 v[156:159], v[196:199], v[96:99], v[144:147]
    v_exp_f32 v176, v176
    v_mfma_f32_16x16x32_bf16 v[164:167], v[196:199], v[112:115], v[148:151]
    v_mfma_f32_16x16x32_bf16 v[188:191], v[196:199], v[128:131], v[152:155]
    ds_read_b128 v[224:227], v245 offset:1024
    v_exp_f32 v184, v184
    s_waitcnt lgkmcnt(6)
    v_mfma_f32_16x16x32_bf16 v[156:159], v[200:203], v[100:103], v[156:159]
    v_mfma_f32_16x16x32_bf16 v[164:167], v[200:203], v[116:119], v[164:167]
    v_exp_f32 v177, v177
    v_mfma_f32_16x16x32_bf16 v[188:191], v[200:203], v[132:135], v[188:191]
    ds_read_b64_tr_b16 v[196:197], v234
    ds_read_b64_tr_b16 v[198:199], v234 offset:1024
    v_exp_f32 v185, v185
    s_waitcnt lgkmcnt(7)
    v_mfma_f32_16x16x32_bf16 v[156:159], v[204:207], v[104:107], v[156:159]
    v_mfma_f32_16x16x32_bf16 v[164:167], v[204:207], v[120:123], v[164:167]
    v_add_f32 v228, v228, v176
    v_mfma_f32_16x16x32_bf16 v[188:191], v[204:207], v[136:139], v[188:191]
    ds_read_b64_tr_b16 v[200:201], v235
    ds_read_b64_tr_b16 v[202:203], v235 offset:1024
    v_add_f32 v230, v230, v184
    s_waitcnt lgkmcnt(8)
    v_mfma_f32_16x16x32_bf16 v[156:159], v[208:211], v[108:111], v[156:159]
    v_exp_f32 v178, v178
    v_mfma_f32_16x16x32_bf16 v[164:167], v[208:211], v[124:127], v[164:167]
    v_mfma_f32_16x16x32_bf16 v[188:191], v[208:211], v[140:143], v[188:191]
    ds_read_b64_tr_b16 v[204:205], v236
    ds_read_b64_tr_b16 v[206:207], v236 offset:1024
    v_exp_f32 v186, v186
    s_waitcnt lgkmcnt(9)
    v_mfma_f32_16x16x32_bf16 v[160:163], v[212:215], v[96:99], v[144:147]
    v_add_f32 v229, v229, v177
    v_mfma_f32_16x16x32_bf16 v[168:171], v[212:215], v[112:115], v[148:151]
    v_add_f32 v231, v231, v185
    v_mfma_f32_16x16x32_bf16 v[192:195], v[212:215], v[128:131], v[152:155]
    ds_read_b64_tr_b16 v[208:209], v237
    ds_read_b64_tr_b16 v[210:211], v237 offset:1024
    v_exp_f32 v179, v179
    s_waitcnt lgkmcnt(10)
    v_mfma_f32_16x16x32_bf16 v[160:163], v[216:219], v[100:103], v[160:163]
    v_mfma_f32_16x16x32_bf16 v[168:171], v[216:219], v[116:119], v[168:171]
    v_exp_f32 v187, v187
    v_mfma_f32_16x16x32_bf16 v[192:195], v[216:219], v[132:135], v[192:195]
    ds_read_b64_tr_b16 v[212:213], v238
    ds_read_b64_tr_b16 v[214:215], v238 offset:1024
    v_cvt_pk_bf16_f32 v174, v176, v177
    s_waitcnt lgkmcnt(11)
    v_mfma_f32_16x16x32_bf16 v[160:163], v[220:223], v[104:107], v[160:163]
    v_cvt_pk_bf16_f32 v182, v184, v185
    v_mfma_f32_16x16x32_bf16 v[168:171], v[220:223], v[120:123], v[168:171]
    v_add_f32 v228, v228, v178
    v_mfma_f32_16x16x32_bf16 v[192:195], v[220:223], v[136:139], v[192:195]
    ds_read_b64_tr_b16 v[216:217], v239
    ds_read_b64_tr_b16 v[218:219], v239 offset:1024
    v_add_f32 v230, v230, v186
    v_add_f32 v229, v229, v179
    s_waitcnt lgkmcnt(12)
    v_mfma_f32_16x16x32_bf16 v[160:163], v[224:227], v[108:111], v[160:163]
    v_add_f32 v231, v231, v187
    v_mfma_f32_16x16x32_bf16 v[168:171], v[224:227], v[124:127], v[168:171]
    v_cvt_pk_bf16_f32 v175, v178, v179
    v_mfma_f32_16x16x32_bf16 v[192:195], v[224:227], v[140:143], v[192:195]
    ds_read_b64_tr_b16 v[220:221], v240
    ds_read_b64_tr_b16 v[222:223], v240 offset:1024
    v_cvt_pk_bf16_f32 v183, v186, v187
    s_branch VAR_24_j
VAR_25_t:
    s_waitcnt lgkmcnt(12)
    v_mfma_f32_16x16x32_bf16 v[0:3], v[196:199], v[172:175], v[0:3]
    v_exp_f32 v156, v156
    v_mfma_f32_16x16x32_bf16 v[32:35], v[196:199], v[180:183], v[32:35]
    v_mfma_f32_16x16x32_bf16 v[64:67], v[196:199], v[188:191], v[64:67]
    ds_read_b64_tr_b16 v[224:225], v241
    ds_read_b64_tr_b16 v[226:227], v241 offset:1024
    v_exp_f32 v164, v164
    s_waitcnt lgkmcnt(12)
    v_mfma_f32_16x16x32_bf16 v[4:7], v[200:203], v[172:175], v[4:7]
    v_mfma_f32_16x16x32_bf16 v[36:39], v[200:203], v[180:183], v[36:39]
    v_exp_f32 v157, v157
    v_mfma_f32_16x16x32_bf16 v[68:71], v[200:203], v[188:191], v[68:71]
    v_exp_f32 v165, v165
    s_waitcnt lgkmcnt(10)
    v_mfma_f32_16x16x32_bf16 v[8:11], v[204:207], v[172:175], v[8:11]
    v_mfma_f32_16x16x32_bf16 v[40:43], v[204:207], v[180:183], v[40:43]
    v_add_f32 v228, v228, v156
    v_mfma_f32_16x16x32_bf16 v[72:75], v[204:207], v[188:191], v[72:75]
    v_add_f32 v230, v230, v164
    s_waitcnt lgkmcnt(8)
    v_mfma_f32_16x16x32_bf16 v[12:15], v[208:211], v[172:175], v[12:15]
    v_exp_f32 v158, v158
    v_mfma_f32_16x16x32_bf16 v[44:47], v[208:211], v[180:183], v[44:47]
    v_mfma_f32_16x16x32_bf16 v[76:79], v[208:211], v[188:191], v[76:79]
    s_waitcnt vmcnt(8) lgkmcnt(0)
    s_barrier
    ds_read_b128 v[196:199], v242 offset:8192
    ds_read_b128 v[200:203], v243 offset:8192
    ds_read_b128 v[204:207], v244 offset:8192
    v_exp_f32 v166, v166
    v_mfma_f32_16x16x32_bf16 v[16:19], v[212:215], v[172:175], v[16:19]
    s_add_u32 m0, s25, 65536
    s_nop 0
    buffer_load_dwordx4 v246, s[8:11], s26 offen nt lds
    v_add_f32 v229, v229, v157
    v_mfma_f32_16x16x32_bf16 v[48:51], v[212:215], v[180:183], v[48:51]
    buffer_load_dwordx4 v246, s[8:11], s26 offen offset:1024 nt lds
    s_add_u32 s26, s26, 8192
    v_add_f32 v231, v231, v165
    v_mfma_f32_16x16x32_bf16 v[80:83], v[212:215], v[188:191], v[80:83]
    s_add_u32 m0, s25, 24576
    s_nop 0
    buffer_load_dwordx4 v247, s[12:15], s27 offen nt lds
    ds_read_b128 v[208:211], v245 offset:8192
    v_exp_f32 v159, v159
    v_mfma_f32_16x16x32_bf16 v[20:23], v[216:219], v[172:175], v[20:23]
    buffer_load_dwordx4 v247, s[12:15], s27 offen offset:1024 nt lds
    s_add_u32 s27, s27, 8192
    v_mfma_f32_16x16x32_bf16 v[52:55], v[216:219], v[180:183], v[52:55]
    v_exp_f32 v167, v167
    v_mfma_f32_16x16x32_bf16 v[84:87], v[216:219], v[188:191], v[84:87]
    ds_read_b128 v[212:215], v242 offset:9216
    v_cvt_pk_bf16_f32 v156, v156, v157
    v_mfma_f32_16x16x32_bf16 v[24:27], v[220:223], v[172:175], v[24:27]
    v_cvt_pk_bf16_f32 v164, v164, v165
    v_mfma_f32_16x16x32_bf16 v[56:59], v[220:223], v[180:183], v[56:59]
    v_add_f32 v228, v228, v158
    v_mfma_f32_16x16x32_bf16 v[88:91], v[220:223], v[188:191], v[88:91]
    ds_read_b128 v[216:219], v243 offset:9216
    v_add_f32 v230, v230, v166
    v_add_f32 v229, v229, v159
    v_mfma_f32_16x16x32_bf16 v[28:31], v[224:227], v[172:175], v[28:31]
    v_add_f32 v231, v231, v167
    v_mfma_f32_16x16x32_bf16 v[60:63], v[224:227], v[180:183], v[60:63]
    v_cvt_pk_bf16_f32 v157, v158, v159
    v_mfma_f32_16x16x32_bf16 v[92:95], v[224:227], v[188:191], v[92:95]
    ds_read_b128 v[220:223], v244 offset:9216
    v_cvt_pk_bf16_f32 v165, v166, v167
    s_branch VAR_25_j
VAR_26_t:
    v_exp_f32 v188, v188
    v_exp_f32 v189, v189
    v_add_f32 v232, v232, v188
    v_exp_f32 v190, v190
    v_add_f32 v233, v233, v189
    v_exp_f32 v191, v191
    v_cvt_pk_bf16_f32 v188, v188, v189
    v_add_f32 v232, v232, v190
    v_add_f32 v233, v233, v191
    v_cvt_pk_bf16_f32 v189, v190, v191
    v_exp_f32 v192, v192
    v_exp_f32 v193, v193
    v_add_f32 v232, v232, v192
    v_exp_f32 v194, v194
    v_add_f32 v233, v233, v193
    v_exp_f32 v195, v195
    v_cvt_pk_bf16_f32 v190, v192, v193
    v_add_f32 v232, v232, v194
    v_add_f32 v233, v233, v195
    v_cvt_pk_bf16_f32 v191, v194, v195
    s_branch VAR_26_j
VAR_27_t:
    s_waitcnt lgkmcnt(6)
    v_mfma_f32_16x16x32_bf16 v[172:175], v[196:199], v[96:99], v[144:147]
    v_exp_f32 v160, v160
    v_mfma_f32_16x16x32_bf16 v[180:183], v[196:199], v[112:115], v[148:151]
    v_mfma_f32_16x16x32_bf16 v[188:191], v[196:199], v[128:131], v[152:155]
    ds_read_b128 v[224:227], v245 offset:9216
    v_exp_f32 v168, v168
    s_waitcnt lgkmcnt(6)
    v_mfma_f32_16x16x32_bf16 v[172:175], v[200:203], v[100:103], v[172:175]
    v_mfma_f32_16x16x32_bf16 v[180:183], v[200:203], v[116:119], v[180:183]
    v_exp_f32 v161, v161
    v_mfma_f32_16x16x32_bf16 v[188:191], v[200:203], v[132:135], v[188:191]
    ds_read_b64_tr_b16 v[196:197], v234 offset:8192
    ds_read_b64_tr_b16 v[198:199], v234 offset:9216
    v_exp_f32 v169, v169
    s_waitcnt lgkmcnt(7)
    v_mfma_f32_16x16x32_bf16 v[172:175], v[204:207], v[104:107], v[172:175]
    v_mfma_f32_16x16x32_bf16 v[180:183], v[204:207], v[120:123], v[180:183]
    v_add_f32 v228, v228, v160
    v_mfma_f32_16x16x32_bf16 v[188:191], v[204:207], v[136:139], v[188:191]
    ds_read_b64_tr_b16 v[200:201], v235 offset:8192
    ds_read_b64_tr_b16 v[202:203], v235 offset:9216
    v_add_f32 v230, v230, v168
    s_waitcnt lgkmcnt(8)
    v_mfma_f32_16x16x32_bf16 v[172:175], v[208:211], v[108:111], v[172:175]
    v_exp_f32 v162, v162
    v_mfma_f32_16x16x32_bf16 v[180:183], v[208:211], v[124:127], v[180:183]
    v_mfma_f32_16x16x32_bf16 v[188:191], v[208:211], v[140:143], v[188:191]
    ds_read_b64_tr_b16 v[204:205], v236 offset:8192
    ds_read_b64_tr_b16 v[206:207], v236 offset:9216
    v_exp_f32 v170, v170
    s_waitcnt lgkmcnt(9)
    v_mfma_f32_16x16x32_bf16 v[176:179], v[212:215], v[96:99], v[144:147]
    v_add_f32 v229, v229, v161
    v_mfma_f32_16x16x32_bf16 v[184:187], v[212:215], v[112:115], v[148:151]
    v_add_f32 v231, v231, v169
    v_mfma_f32_16x16x32_bf16 v[192:195], v[212:215], v[128:131], v[152:155]
    ds_read_b64_tr_b16 v[208:209], v237 offset:8192
    ds_read_b64_tr_b16 v[210:211], v237 offset:9216
    v_exp_f32 v163, v163
    s_waitcnt lgkmcnt(10)
    v_mfma_f32_16x16x32_bf16 v[176:179], v[216:219], v[100:103], v[176:179]
    v_mfma_f32_16x16x32_bf16 v[184:187], v[216:219], v[116:119], v[184:187]
    v_exp_f32 v171, v171
    v_mfma_f32_16x16x32_bf16 v[192:195], v[216:219], v[132:135], v[192:195]
    ds_read_b64_tr_b16 v[212:213], v238 offset:8192
    ds_read_b64_tr_b16 v[214:215], v238 offset:9216
    v_cvt_pk_bf16_f32 v158, v160, v161
    s_waitcnt lgkmcnt(11)
    v_mfma_f32_16x16x32_bf16 v[176:179], v[220:223], v[104:107], v[176:179]
    v_cvt_pk_bf16_f32 v166, v168, v169
    v_mfma_f32_16x16x32_bf16 v[184:187], v[220:223], v[120:123], v[184:187]
    v_add_f32 v228, v228, v162
    v_mfma_f32_16x16x32_bf16 v[192:195], v[220:223], v[136:139], v[192:195]
    ds_read_b64_tr_b16 v[216:217], v239 offset:8192
    ds_read_b64_tr_b16 v[218:219], v239 offset:9216
    v_add_f32 v230, v230, v170
    v_add_f32 v229, v229, v163
    s_waitcnt lgkmcnt(12)
    v_mfma_f32_16x16x32_bf16 v[176:179], v[224:227], v[108:111], v[176:179]
    v_add_f32 v231, v231, v171
    v_mfma_f32_16x16x32_bf16 v[184:187], v[224:227], v[124:127], v[184:187]
    v_cvt_pk_bf16_f32 v159, v162, v163
    v_mfma_f32_16x16x32_bf16 v[192:195], v[224:227], v[140:143], v[192:195]
    ds_read_b64_tr_b16 v[220:221], v240 offset:8192
    ds_read_b64_tr_b16 v[222:223], v240 offset:9216
    v_cvt_pk_bf16_f32 v167, v170, v171
    s_branch VAR_27_j
VAR_28_t:
    s_waitcnt lgkmcnt(12)
    v_mfma_f32_16x16x32_bf16 v[0:3], v[196:199], v[156:159], v[0:3]
    v_exp_f32 v172, v172
    v_mfma_f32_16x16x32_bf16 v[32:35], v[196:199], v[164:167], v[32:35]
    v_mfma_f32_16x16x32_bf16 v[64:67], v[196:199], v[188:191], v[64:67]
    ds_read_b64_tr_b16 v[224:225], v241 offset:8192
    ds_read_b64_tr_b16 v[226:227], v241 offset:9216
    v_exp_f32 v180, v180
    s_waitcnt lgkmcnt(12)
    v_mfma_f32_16x16x32_bf16 v[4:7], v[200:203], v[156:159], v[4:7]
    v_mfma_f32_16x16x32_bf16 v[36:39], v[200:203], v[164:167], v[36:39]
    v_exp_f32 v173, v173
    v_mfma_f32_16x16x32_bf16 v[68:71], v[200:203], v[188:191], v[68:71]
    v_exp_f32 v181, v181
    s_waitcnt lgkmcnt(10)
    v_mfma_f32_16x16x32_bf16 v[8:11], v[204:207], v[156:159], v[8:11]
    v_mfma_f32_16x16x32_bf16 v[40:43], v[204:207], v[164:167], v[40:43]
    v_add_f32 v228, v228, v172
    v_mfma_f32_16x16x32_bf16 v[72:75], v[204:207], v[188:191], v[72:75]
    v_add_f32 v230, v230, v180
    s_waitcnt lgkmcnt(8)
    v_mfma_f32_16x16x32_bf16 v[12:15], v[208:211], v[156:159], v[12:15]
    v_exp_f32 v174, v174
    v_mfma_f32_16x16x32_bf16 v[44:47], v[208:211], v[164:167], v[44:47]
    v_mfma_f32_16x16x32_bf16 v[76:79], v[208:211], v[188:191], v[76:79]
    s_waitcnt vmcnt(8) lgkmcnt(0)
    s_barrier
    ds_read_b128 v[196:199], v242 offset:16384
    ds_read_b128 v[200:203], v243 offset:16384
    ds_read_b128 v[204:207], v244 offset:16384
    v_exp_f32 v182, v182
    v_mfma_f32_16x16x32_bf16 v[16:19], v[212:215], v[156:159], v[16:19]
    s_add_u32 m0, s25, 73728
    s_nop 0
    buffer_load_dwordx4 v246, s[8:11], s26 offen nt lds
    v_add_f32 v229, v229, v173
    v_mfma_f32_16x16x32_bf16 v[48:51], v[212:215], v[164:167], v[48:51]
    buffer_load_dwordx4 v246, s[8:11], s26 offen offset:1024 nt lds
    s_add_u32 s26, s26, 8192
    v_add_f32 v231, v231, v181
    v_mfma_f32_16x16x32_bf16 v[80:83], v[212:215], v[188:191], v[80:83]
    s_add_u32 m0, s25, 32768
    s_nop 0
    buffer_load_dwordx4 v247, s[12:15], s27 offen nt lds
    ds_read_b128 v[208:211], v245 offset:16384
    v_exp_f32 v175, v175
    v_mfma_f32_16x16x32_bf16 v[20:23], v[216:219], v[156:159], v[20:23]
    buffer_load_dwordx4 v247, s[12:15], s27 offen offset:1024 nt lds
    s_add_u32 s27, s27, 8192
    v_mfma_f32_16x16x32_bf16 v[52:55], v[216:219], v[164:167], v[52:55]
    v_exp_f32 v183, v183
    v_mfma_f32_16x16x32_bf16 v[84:87], v[216:219], v[188:191], v[84:87]
    ds_read_b128 v[212:215], v242 offset:17408
    v_cvt_pk_bf16_f32 v172, v172, v173
    v_mfma_f32_16x16x32_bf16 v[24:27], v[220:223], v[156:159], v[24:27]
    v_cvt_pk_bf16_f32 v180, v180, v181
    v_mfma_f32_16x16x32_bf16 v[56:59], v[220:223], v[164:167], v[56:59]
    v_add_f32 v228, v228, v174
    v_mfma_f32_16x16x32_bf16 v[88:91], v[220:223], v[188:191], v[88:91]
    ds_read_b128 v[216:219], v243 offset:17408
    v_add_f32 v230, v230, v182
    v_add_f32 v229, v229, v175
    v_mfma_f32_16x16x32_bf16 v[28:31], v[224:227], v[156:159], v[28:31]
    v_add_f32 v231, v231, v183
    v_mfma_f32_16x16x32_bf16 v[60:63], v[224:227], v[164:167], v[60:63]
    v_cvt_pk_bf16_f32 v173, v174, v175
    v_mfma_f32_16x16x32_bf16 v[92:95], v[224:227], v[188:191], v[92:95]
    ds_read_b128 v[220:223], v244 offset:17408
    v_cvt_pk_bf16_f32 v181, v182, v183
    s_branch VAR_28_j
VAR_29_t:
    v_exp_f32 v188, v188
    v_exp_f32 v189, v189
    v_add_f32 v232, v232, v188
    v_exp_f32 v190, v190
    v_add_f32 v233, v233, v189
    v_exp_f32 v191, v191
    v_cvt_pk_bf16_f32 v188, v188, v189
    v_add_f32 v232, v232, v190
    v_add_f32 v233, v233, v191
    v_cvt_pk_bf16_f32 v189, v190, v191
    v_exp_f32 v192, v192
    v_exp_f32 v193, v193
    v_add_f32 v232, v232, v192
    v_exp_f32 v194, v194
    v_add_f32 v233, v233, v193
    v_exp_f32 v195, v195
    v_cvt_pk_bf16_f32 v190, v192, v193
    v_add_f32 v232, v232, v194
    v_add_f32 v233, v233, v195
    v_cvt_pk_bf16_f32 v191, v194, v195
    s_branch VAR_29_j
VAR_30_t:
    s_waitcnt lgkmcnt(6)
    v_mfma_f32_16x16x32_bf16 v[156:159], v[196:199], v[96:99], v[144:147]
    v_exp_f32 v176, v176
    v_mfma_f32_16x16x32_bf16 v[164:167], v[196:199], v[112:115], v[148:151]
    v_mfma_f32_16x16x32_bf16 v[188:191], v[196:199], v[128:131], v[152:155]
    ds_read_b128 v[224:227], v245 offset:17408
    v_exp_f32 v184, v184
    s_waitcnt lgkmcnt(6)
    v_mfma_f32_16x16x32_bf16 v[156:159], v[200:203], v[100:103], v[156:159]
    v_mfma_f32_16x16x32_bf16 v[164:167], v[200:203], v[116:119], v[164:167]
    v_exp_f32 v177, v177
    v_mfma_f32_16x16x32_bf16 v[188:191], v[200:203], v[132:135], v[188:191]
    ds_read_b64_tr_b16 v[196:197], v234 offset:16384
    ds_read_b64_tr_b16 v[198:199], v234 offset:17408
    v_exp_f32 v185, v185
    s_waitcnt lgkmcnt(7)
    v_mfma_f32_16x16x32_bf16 v[156:159], v[204:207], v[104:107], v[156:159]
    v_mfma_f32_16x16x32_bf16 v[164:167], v[204:207], v[120:123], v[164:167]
    v_add_f32 v228, v228, v176
    v_mfma_f32_16x16x32_bf16 v[188:191], v[204:207], v[136:139], v[188:191]
    ds_read_b64_tr_b16 v[200:201], v235 offset:16384
    ds_read_b64_tr_b16 v[202:203], v235 offset:17408
    v_add_f32 v230, v230, v184
    s_waitcnt lgkmcnt(8)
    v_mfma_f32_16x16x32_bf16 v[156:159], v[208:211], v[108:111], v[156:159]
    v_exp_f32 v178, v178
    v_mfma_f32_16x16x32_bf16 v[164:167], v[208:211], v[124:127], v[164:167]
    v_mfma_f32_16x16x32_bf16 v[188:191], v[208:211], v[140:143], v[188:191]
    ds_read_b64_tr_b16 v[204:205], v236 offset:16384
    ds_read_b64_tr_b16 v[206:207], v236 offset:17408
    v_exp_f32 v186, v186
    s_waitcnt lgkmcnt(9)
    v_mfma_f32_16x16x32_bf16 v[160:163], v[212:215], v[96:99], v[144:147]
    v_add_f32 v229, v229, v177
    v_mfma_f32_16x16x32_bf16 v[168:171], v[212:215], v[112:115], v[148:151]
    v_add_f32 v231, v231, v185
    v_mfma_f32_16x16x32_bf16 v[192:195], v[212:215], v[128:131], v[152:155]
    ds_read_b64_tr_b16 v[208:209], v237 offset:16384
    ds_read_b64_tr_b16 v[210:211], v237 offset:17408
    v_exp_f32 v179, v179
    s_waitcnt lgkmcnt(10)
    v_mfma_f32_16x16x32_bf16 v[160:163], v[216:219], v[100:103], v[160:163]
    v_mfma_f32_16x16x32_bf16 v[168:171], v[216:219], v[116:119], v[168:171]
    v_exp_f32 v187, v187
    v_mfma_f32_16x16x32_bf16 v[192:195], v[216:219], v[132:135], v[192:195]
    ds_read_b64_tr_b16 v[212:213], v238 offset:16384
    ds_read_b64_tr_b16 v[214:215], v238 offset:17408
    v_cvt_pk_bf16_f32 v174, v176, v177
    s_waitcnt lgkmcnt(11)
    v_mfma_f32_16x16x32_bf16 v[160:163], v[220:223], v[104:107], v[160:163]
    v_cvt_pk_bf16_f32 v182, v184, v185
    v_mfma_f32_16x16x32_bf16 v[168:171], v[220:223], v[120:123], v[168:171]
    v_add_f32 v228, v228, v178
    v_mfma_f32_16x16x32_bf16 v[192:195], v[220:223], v[136:139], v[192:195]
    ds_read_b64_tr_b16 v[216:217], v239 offset:16384
    ds_read_b64_tr_b16 v[218:219], v239 offset:17408
    v_add_f32 v230, v230, v186
    v_add_f32 v229, v229, v179
    s_waitcnt lgkmcnt(12)
    v_mfma_f32_16x16x32_bf16 v[160:163], v[224:227], v[108:111], v[160:163]
    v_add_f32 v231, v231, v187
    v_mfma_f32_16x16x32_bf16 v[168:171], v[224:227], v[124:127], v[168:171]
    v_cvt_pk_bf16_f32 v175, v178, v179
    v_mfma_f32_16x16x32_bf16 v[192:195], v[224:227], v[140:143], v[192:195]
    ds_read_b64_tr_b16 v[220:221], v240 offset:16384
    ds_read_b64_tr_b16 v[222:223], v240 offset:17408
    v_cvt_pk_bf16_f32 v183, v186, v187
    s_branch VAR_30_j
VAR_31_t:
    s_waitcnt lgkmcnt(12)
    v_mfma_f32_16x16x32_bf16 v[0:3], v[196:199], v[172:175], v[0:3]
    v_exp_f32 v156, v156
    v_mfma_f32_16x16x32_bf16 v[32:35], v[196:199], v[180:183], v[32:35]
    v_mfma_f32_16x16x32_bf16 v[64:67], v[196:199], v[188:191], v[64:67]
    ds_read_b64_tr_b16 v[224:225], v241 offset:16384
    ds_read_b64_tr_b16 v[226:227], v241 offset:17408
    v_exp_f32 v164, v164
    s_waitcnt lgkmcnt(12)
    v_mfma_f32_16x16x32_bf16 v[4:7], v[200:203], v[172:175], v[4:7]
    v_mfma_f32_16x16x32_bf16 v[36:39], v[200:203], v[180:183], v[36:39]
    v_exp_f32 v157, v157
    v_mfma_f32_16x16x32_bf16 v[68:71], v[200:203], v[188:191], v[68:71]
    v_exp_f32 v165, v165
    s_waitcnt lgkmcnt(10)
    v_mfma_f32_16x16x32_bf16 v[8:11], v[204:207], v[172:175], v[8:11]
    v_mfma_f32_16x16x32_bf16 v[40:43], v[204:207], v[180:183], v[40:43]
    v_add_f32 v228, v228, v156
    v_mfma_f32_16x16x32_bf16 v[72:75], v[204:207], v[188:191], v[72:75]
    v_add_f32 v230, v230, v164
    s_waitcnt lgkmcnt(8)
    v_mfma_f32_16x16x32_bf16 v[12:15], v[208:211], v[172:175], v[12:15]
    v_exp_f32 v158, v158
    v_mfma_f32_16x16x32_bf16 v[44:47], v[208:211], v[180:183], v[44:47]
    v_mfma_f32_16x16x32_bf16 v[76:79], v[208:211], v[188:191], v[76:79]
    s_waitcnt vmcnt(4) lgkmcnt(0)
    s_barrier
    ds_read_b128 v[196:199], v242 offset:24576
    ds_read_b128 v[200:203], v243 offset:24576
    ds_read_b128 v[204:207], v244 offset:24576
    v_exp_f32 v166, v166
    v_mfma_f32_16x16x32_bf16 v[16:19], v[212:215], v[172:175], v[16:19]
    s_add_u32 m0, s25, 40960
    s_nop 0
    buffer_load_dwordx4 v246, s[8:11], s26 offen nt lds
    v_add_f32 v229, v229, v157
    v_mfma_f32_16x16x32_bf16 v[48:51], v[212:215], v[180:183], v[48:51]
    buffer_load_dwordx4 v246, s[8:11], s26 offen offset:1024 nt lds
    s_add_u32 s26, s26, 8192
    v_add_f32 v231, v231, v165
    v_mfma_f32_16x16x32_bf16 v[80:83], v[212:215], v[188:191], v[80:83]
    s_add_u32 m0, s25, 0
    s_nop 0
    buffer_load_dwordx4 v247, s[12:15], s27 offen nt lds
    ds_read_b128 v[208:211], v245 offset:24576
    v_exp_f32 v159, v159
    v_mfma_f32_16x16x32_bf16 v[20:23], v[216:219], v[172:175], v[20:23]
    buffer_load_dwordx4 v247, s[12:15], s27 offen offset:1024 nt lds
    s_add_u32 s27, s27, 8192
    v_mfma_f32_16x16x32_bf16 v[52:55], v[216:219], v[180:183], v[52:55]
    v_exp_f32 v167, v167
    v_mfma_f32_16x16x32_bf16 v[84:87], v[216:219], v[188:191], v[84:87]
    ds_read_b128 v[212:215], v242 offset:25600
    v_cvt_pk_bf16_f32 v156, v156, v157
    v_mfma_f32_16x16x32_bf16 v[24:27], v[220:223], v[172:175], v[24:27]
    v_cvt_pk_bf16_f32 v164, v164, v165
    v_mfma_f32_16x16x32_bf16 v[56:59], v[220:223], v[180:183], v[56:59]
    v_add_f32 v228, v228, v158
    v_mfma_f32_16x16x32_bf16 v[88:91], v[220:223], v[188:191], v[88:91]
    ds_read_b128 v[216:219], v243 offset:25600
    v_add_f32 v230, v230, v166
    v_add_f32 v229, v229, v159
    v_mfma_f32_16x16x32_bf16 v[28:31], v[224:227], v[172:175], v[28:31]
    v_add_f32 v231, v231, v167
    v_mfma_f32_16x16x32_bf16 v[60:63], v[224:227], v[180:183], v[60:63]
    v_cvt_pk_bf16_f32 v157, v158, v159
    v_mfma_f32_16x16x32_bf16 v[92:95], v[224:227], v[188:191], v[92:95]
    ds_read_b128 v[220:223], v244 offset:25600
    v_cvt_pk_bf16_f32 v165, v166, v167
    s_branch VAR_31_j
VAR_32_t:
    v_exp_f32 v188, v188
    v_exp_f32 v189, v189
    v_add_f32 v232, v232, v188
    v_exp_f32 v190, v190
    v_add_f32 v233, v233, v189
    v_exp_f32 v191, v191
    v_cvt_pk_bf16_f32 v188, v188, v189
    v_add_f32 v232, v232, v190
    v_add_f32 v233, v233, v191
    v_cvt_pk_bf16_f32 v189, v190, v191
    v_exp_f32 v192, v192
    v_exp_f32 v193, v193
    v_add_f32 v232, v232, v192
    v_exp_f32 v194, v194
    v_add_f32 v233, v233, v193
    v_exp_f32 v195, v195
    v_cvt_pk_bf16_f32 v190, v192, v193
    v_add_f32 v232, v232, v194
    v_add_f32 v233, v233, v195
    v_cvt_pk_bf16_f32 v191, v194, v195
    s_branch VAR_32_j
VAR_33_t:
    s_waitcnt lgkmcnt(6)
    v_mfma_f32_16x16x32_bf16 v[172:175], v[196:199], v[96:99], v[144:147]
    v_exp_f32 v160, v160
    v_mfma_f32_16x16x32_bf16 v[180:183], v[196:199], v[112:115], v[148:151]
    v_mfma_f32_16x16x32_bf16 v[188:191], v[196:199], v[128:131], v[152:155]
    ds_read_b128 v[224:227], v245 offset:25600
    v_exp_f32 v168, v168
    s_waitcnt lgkmcnt(6)
    v_mfma_f32_16x16x32_bf16 v[172:175], v[200:203], v[100:103], v[172:175]
    v_mfma_f32_16x16x32_bf16 v[180:183], v[200:203], v[116:119], v[180:183]
    v_exp_f32 v161, v161
    v_mfma_f32_16x16x32_bf16 v[188:191], v[200:203], v[132:135], v[188:191]
    ds_read_b64_tr_b16 v[196:197], v234 offset:24576
    ds_read_b64_tr_b16 v[198:199], v234 offset:25600
    v_exp_f32 v169, v169
    s_waitcnt lgkmcnt(7)
    v_mfma_f32_16x16x32_bf16 v[172:175], v[204:207], v[104:107], v[172:175]
    v_mfma_f32_16x16x32_bf16 v[180:183], v[204:207], v[120:123], v[180:183]
    v_add_f32 v228, v228, v160
    v_mfma_f32_16x16x32_bf16 v[188:191], v[204:207], v[136:139], v[188:191]
    ds_read_b64_tr_b16 v[200:201], v235 offset:24576
    ds_read_b64_tr_b16 v[202:203], v235 offset:25600
    v_add_f32 v230, v230, v168
    s_waitcnt lgkmcnt(8)
    v_mfma_f32_16x16x32_bf16 v[172:175], v[208:211], v[108:111], v[172:175]
    v_exp_f32 v162, v162
    v_mfma_f32_16x16x32_bf16 v[180:183], v[208:211], v[124:127], v[180:183]
    v_mfma_f32_16x16x32_bf16 v[188:191], v[208:211], v[140:143], v[188:191]
    ds_read_b64_tr_b16 v[204:205], v236 offset:24576
    ds_read_b64_tr_b16 v[206:207], v236 offset:25600
    v_exp_f32 v170, v170
    s_waitcnt lgkmcnt(9)
    v_mfma_f32_16x16x32_bf16 v[176:179], v[212:215], v[96:99], v[144:147]
    v_add_f32 v229, v229, v161
    v_mfma_f32_16x16x32_bf16 v[184:187], v[212:215], v[112:115], v[148:151]
    v_add_f32 v231, v231, v169
    v_mfma_f32_16x16x32_bf16 v[192:195], v[212:215], v[128:131], v[152:155]
    ds_read_b64_tr_b16 v[208:209], v237 offset:24576
    ds_read_b64_tr_b16 v[210:211], v237 offset:25600
    v_exp_f32 v163, v163
    s_waitcnt lgkmcnt(10)
    v_mfma_f32_16x16x32_bf16 v[176:179], v[216:219], v[100:103], v[176:179]
    v_mfma_f32_16x16x32_bf16 v[184:187], v[216:219], v[116:119], v[184:187]
    v_exp_f32 v171, v171
    v_mfma_f32_16x16x32_bf16 v[192:195], v[216:219], v[132:135], v[192:195]
    ds_read_b64_tr_b16 v[212:213], v238 offset:24576
    ds_read_b64_tr_b16 v[214:215], v238 offset:25600
    v_cvt_pk_bf16_f32 v158, v160, v161
    s_waitcnt lgkmcnt(11)
    v_mfma_f32_16x16x32_bf16 v[176:179], v[220:223], v[104:107], v[176:179]
    v_cvt_pk_bf16_f32 v166, v168, v169
    v_mfma_f32_16x16x32_bf16 v[184:187], v[220:223], v[120:123], v[184:187]
    v_add_f32 v228, v228, v162
    v_mfma_f32_16x16x32_bf16 v[192:195], v[220:223], v[136:139], v[192:195]
    ds_read_b64_tr_b16 v[216:217], v239 offset:24576
    ds_read_b64_tr_b16 v[218:219], v239 offset:25600
    v_add_f32 v230, v230, v170
    v_add_f32 v229, v229, v163
    s_waitcnt lgkmcnt(12)
    v_mfma_f32_16x16x32_bf16 v[176:179], v[224:227], v[108:111], v[176:179]
    v_add_f32 v231, v231, v171
    v_mfma_f32_16x16x32_bf16 v[184:187], v[224:227], v[124:127], v[184:187]
    v_cvt_pk_bf16_f32 v159, v162, v163
    v_mfma_f32_16x16x32_bf16 v[192:195], v[224:227], v[140:143], v[192:195]
    ds_read_b64_tr_b16 v[220:221], v240 offset:24576
    ds_read_b64_tr_b16 v[222:223], v240 offset:25600
    v_cvt_pk_bf16_f32 v167, v170, v171
    s_branch VAR_33_j
VAR_34_t:
    s_waitcnt lgkmcnt(12)
    v_mfma_f32_16x16x32_bf16 v[0:3], v[196:199], v[156:159], v[0:3]
    v_exp_f32 v172, v172
    v_mfma_f32_16x16x32_bf16 v[32:35], v[196:199], v[164:167], v[32:35]
    v_mfma_f32_16x16x32_bf16 v[64:67], v[196:199], v[188:191], v[64:67]
    ds_read_b64_tr_b16 v[224:225], v241 offset:24576
    ds_read_b64_tr_b16 v[226:227], v241 offset:25600
    v_exp_f32 v180, v180
    s_waitcnt lgkmcnt(12)
    v_mfma_f32_16x16x32_bf16 v[4:7], v[200:203], v[156:159], v[4:7]
    v_mfma_f32_16x16x32_bf16 v[36:39], v[200:203], v[164:167], v[36:39]
    v_exp_f32 v173, v173
    v_mfma_f32_16x16x32_bf16 v[68:71], v[200:203], v[188:191], v[68:71]
    v_exp_f32 v181, v181
    s_waitcnt lgkmcnt(10)
    v_mfma_f32_16x16x32_bf16 v[8:11], v[204:207], v[156:159], v[8:11]
    v_mfma_f32_16x16x32_bf16 v[40:43], v[204:207], v[164:167], v[40:43]
    v_add_f32 v228, v228, v172
    v_mfma_f32_16x16x32_bf16 v[72:75], v[204:207], v[188:191], v[72:75]
    v_add_f32 v230, v230, v180
    s_waitcnt lgkmcnt(8)
    v_mfma_f32_16x16x32_bf16 v[12:15], v[208:211], v[156:159], v[12:15]
    v_exp_f32 v174, v174
    v_mfma_f32_16x16x32_bf16 v[44:47], v[208:211], v[164:167], v[44:47]
    v_mfma_f32_16x16x32_bf16 v[76:79], v[208:211], v[188:191], v[76:79]
    s_waitcnt vmcnt(5) lgkmcnt(0)
    s_barrier
    ds_read_b128 v[196:199], v242 offset:32768
    ds_read_b128 v[200:203], v243 offset:32768
    ds_read_b128 v[204:207], v244 offset:32768
    v_exp_f32 v182, v182
    v_mfma_f32_16x16x32_bf16 v[16:19], v[212:215], v[156:159], v[16:19]
    s_add_u32 m0, s25, 49152
    s_nop 0
    buffer_load_dwordx4 v246, s[8:11], s26 offen nt lds
    v_add_f32 v229, v229, v173
    v_mfma_f32_16x16x32_bf16 v[48:51], v[212:215], v[164:167], v[48:51]
    buffer_load_dwordx4 v246, s[8:11], s26 offen offset:1024 nt lds
    s_add_u32 s26, s26, 8192
    v_add_f32 v231, v231, v181
    v_mfma_f32_16x16x32_bf16 v[80:83], v[212:215], v[188:191], v[80:83]
    s_add_u32 m0, s25, 8192
    s_nop 0
    buffer_load_dwordx4 v247, s[12:15], s27 offen nt lds
    ds_read_b128 v[208:211], v245 offset:32768
    v_exp_f32 v175, v175
    v_mfma_f32_16x16x32_bf16 v[20:23], v[216:219], v[156:159], v[20:23]
    buffer_load_dwordx4 v247, s[12:15], s27 offen offset:1024 nt lds
    s_add_u32 s27, s27, 8192
    v_mfma_f32_16x16x32_bf16 v[52:55], v[216:219], v[164:167], v[52:55]
    v_exp_f32 v183, v183
    v_mfma_f32_16x16x32_bf16 v[84:87], v[216:219], v[188:191], v[84:87]
    ds_read_b128 v[212:215], v242 offset:33792
    v_cvt_pk_bf16_f32 v172, v172, v173
    v_mfma_f32_16x16x32_bf16 v[24:27], v[220:223], v[156:159], v[24:27]
    v_cvt_pk_bf16_f32 v180, v180, v181
    v_mfma_f32_16x16x32_bf16 v[56:59], v[220:223], v[164:167], v[56:59]
    v_add_f32 v228, v228, v174
    v_mfma_f32_16x16x32_bf16 v[88:91], v[220:223], v[188:191], v[88:91]
    ds_read_b128 v[216:219], v243 offset:33792
    v_add_f32 v230, v230, v182
    v_add_f32 v229, v229, v175
    v_mfma_f32_16x16x32_bf16 v[28:31], v[224:227], v[156:159], v[28:31]
    v_add_f32 v231, v231, v183
    v_mfma_f32_16x16x32_bf16 v[60:63], v[224:227], v[164:167], v[60:63]
    v_cvt_pk_bf16_f32 v173, v174, v175
    v_mfma_f32_16x16x32_bf16 v[92:95], v[224:227], v[188:191], v[92:95]
    ds_read_b128 v[220:223], v244 offset:33792
    v_cvt_pk_bf16_f32 v181, v182, v183
    s_branch VAR_34_j
VAR_35_t:
    v_exp_f32 v188, v188
    v_exp_f32 v189, v189
    v_add_f32 v232, v232, v188
    v_exp_f32 v190, v190
    v_add_f32 v233, v233, v189
    v_exp_f32 v191, v191
    v_cvt_pk_bf16_f32 v188, v188, v189
    v_add_f32 v232, v232, v190
    v_add_f32 v233, v233, v191
    v_cvt_pk_bf16_f32 v189, v190, v191
    v_exp_f32 v192, v192
    v_exp_f32 v193, v193
    v_add_f32 v232, v232, v192
    v_exp_f32 v194, v194
    v_add_f32 v233, v233, v193
    v_exp_f32 v195, v195
    v_cvt_pk_bf16_f32 v190, v192, v193
    v_add_f32 v232, v232, v194
    v_add_f32 v233, v233, v195
    v_cvt_pk_bf16_f32 v191, v194, v195
    s_branch VAR_35_j
VAR_36_t:
    s_waitcnt lgkmcnt(6)
    v_mfma_f32_16x16x32_bf16 v[156:159], v[196:199], v[96:99], v[144:147]
    v_exp_f32 v176, v176
    v_mfma_f32_16x16x32_bf16 v[164:167], v[196:199], v[112:115], v[148:151]
    v_mfma_f32_16x16x32_bf16 v[188:191], v[196:199], v[128:131], v[152:155]
    ds_read_b128 v[224:227], v245 offset:33792
    v_exp_f32 v184, v184
    s_waitcnt lgkmcnt(6)
    v_mfma_f32_16x16x32_bf16 v[156:159], v[200:203], v[100:103], v[156:159]
    v_mfma_f32_16x16x32_bf16 v[164:167], v[200:203], v[116:119], v[164:167]
    v_exp_f32 v177, v177
    v_mfma_f32_16x16x32_bf16 v[188:191], v[200:203], v[132:135], v[188:191]
    ds_read_b64_tr_b16 v[196:197], v234 offset:32768
    ds_read_b64_tr_b16 v[198:199], v234 offset:33792
    v_exp_f32 v185, v185
    s_waitcnt lgkmcnt(7)
    v_mfma_f32_16x16x32_bf16 v[156:159], v[204:207], v[104:107], v[156:159]
    v_mfma_f32_16x16x32_bf16 v[164:167], v[204:207], v[120:123], v[164:167]
    v_add_f32 v228, v228, v176
    v_mfma_f32_16x16x32_bf16 v[188:191], v[204:207], v[136:139], v[188:191]
    ds_read_b64_tr_b16 v[200:201], v235 offset:32768
    ds_read_b64_tr_b16 v[202:203], v235 offset:33792
    v_add_f32 v230, v230, v184
    s_waitcnt lgkmcnt(8)
    v_mfma_f32_16x16x32_bf16 v[156:159], v[208:211], v[108:111], v[156:159]
    v_exp_f32 v178, v178
    v_mfma_f32_16x16x32_bf16 v[164:167], v[208:211], v[124:127], v[164:167]
    v_mfma_f32_16x16x32_bf16 v[188:191], v[208:211], v[140:143], v[188:191]
    ds_read_b64_tr_b16 v[204:205], v236 offset:32768
    ds_read_b64_tr_b16 v[206:207], v236 offset:33792
    v_exp_f32 v186, v186
    s_waitcnt lgkmcnt(9)
    v_mfma_f32_16x16x32_bf16 v[160:163], v[212:215], v[96:99], v[144:147]
    v_add_f32 v229, v229, v177
    v_mfma_f32_16x16x32_bf16 v[168:171], v[212:215], v[112:115], v[148:151]
    v_add_f32 v231, v231, v185
    v_mfma_f32_16x16x32_bf16 v[192:195], v[212:215], v[128:131], v[152:155]
    ds_read_b64_tr_b16 v[208:209], v237 offset:32768
    ds_read_b64_tr_b16 v[210:211], v237 offset:33792
    v_exp_f32 v179, v179
    s_waitcnt lgkmcnt(10)
    v_mfma_f32_16x16x32_bf16 v[160:163], v[216:219], v[100:103], v[160:163]
    v_mfma_f32_16x16x32_bf16 v[168:171], v[216:219], v[116:119], v[168:171]
    v_exp_f32 v187, v187
    v_mfma_f32_16x16x32_bf16 v[192:195], v[216:219], v[132:135], v[192:195]
    ds_read_b64_tr_b16 v[212:213], v238 offset:32768
    ds_read_b64_tr_b16 v[214:215], v238 offset:33792
    v_cvt_pk_bf16_f32 v174, v176, v177
    s_waitcnt lgkmcnt(11)
    v_mfma_f32_16x16x32_bf16 v[160:163], v[220:223], v[104:107], v[160:163]
    v_cvt_pk_bf16_f32 v182, v184, v185
    v_mfma_f32_16x16x32_bf16 v[168:171], v[220:223], v[120:123], v[168:171]
    v_add_f32 v228, v228, v178
    v_mfma_f32_16x16x32_bf16 v[192:195], v[220:223], v[136:139], v[192:195]
    ds_read_b64_tr_b16 v[216:217], v239 offset:32768
    ds_read_b64_tr_b16 v[218:219], v239 offset:33792
    v_add_f32 v230, v230, v186
    v_add_f32 v229, v229, v179
    s_waitcnt lgkmcnt(12)
    v_mfma_f32_16x16x32_bf16 v[160:163], v[224:227], v[108:111], v[160:163]
    v_add_f32 v231, v231, v187
    v_mfma_f32_16x16x32_bf16 v[168:171], v[224:227], v[124:127], v[168:171]
    v_cvt_pk_bf16_f32 v175, v178, v179
    v_mfma_f32_16x16x32_bf16 v[192:195], v[224:227], v[140:143], v[192:195]
    ds_read_b64_tr_b16 v[220:221], v240 offset:32768
    ds_read_b64_tr_b16 v[222:223], v240 offset:33792
    v_cvt_pk_bf16_f32 v183, v186, v187
    s_branch VAR_36_j
VAR_37_t:
    s_waitcnt lgkmcnt(12)
    v_mfma_f32_16x16x32_bf16 v[0:3], v[196:199], v[172:175], v[0:3]
    v_exp_f32 v156, v156
    v_mfma_f32_16x16x32_bf16 v[32:35], v[196:199], v[180:183], v[32:35]
    v_mfma_f32_16x16x32_bf16 v[64:67], v[196:199], v[188:191], v[64:67]
    ds_read_b64_tr_b16 v[224:225], v241 offset:32768
    ds_read_b64_tr_b16 v[226:227], v241 offset:33792
    v_exp_f32 v164, v164
    s_waitcnt lgkmcnt(12)
    v_mfma_f32_16x16x32_bf16 v[4:7], v[200:203], v[172:175], v[4:7]
    v_mfma_f32_16x16x32_bf16 v[36:39], v[200:203], v[180:183], v[36:39]
    v_exp_f32 v157, v157
    v_mfma_f32_16x16x32_bf16 v[68:71], v[200:203], v[188:191], v[68:71]
    v_exp_f32 v165, v165
    s_waitcnt lgkmcnt(10)
    v_mfma_f32_16x16x32_bf16 v[8:11], v[204:207], v[172:175], v[8:11]
    v_mfma_f32_16x16x32_bf16 v[40:43], v[204:207], v[180:183], v[40:43]
    v_add_f32 v228, v228, v156
    v_mfma_f32_16x16x32_bf16 v[72:75], v[204:207], v[188:191], v[72:75]
    v_add_f32 v230, v230, v164
    s_waitcnt lgkmcnt(8)
    v_mfma_f32_16x16x32_bf16 v[12:15], v[208:211], v[172:175], v[12:15]
    v_exp_f32 v158, v158
    v_mfma_f32_16x16x32_bf16 v[44:47], v[208:211], v[180:183], v[44:47]
    v_mfma_f32_16x16x32_bf16 v[76:79], v[208:211], v[188:191], v[76:79]
    s_waitcnt vmcnt(5) lgkmcnt(0)
    s_barrier
    ds_read_b128 v[196:199], v242
    ds_read_b128 v[200:203], v243
    ds_read_b128 v[204:207], v244
    v_exp_f32 v166, v166
    v_mfma_f32_16x16x32_bf16 v[16:19], v[212:215], v[172:175], v[16:19]
    s_add_u32 m0, s25, 57344
    s_nop 0
    buffer_load_dwordx4 v246, s[8:11], s26 offen nt lds
    v_add_f32 v229, v229, v157
    v_mfma_f32_16x16x32_bf16 v[48:51], v[212:215], v[180:183], v[48:51]
    buffer_load_dwordx4 v246, s[8:11], s26 offen offset:1024 nt lds
    s_add_u32 s26, s26, 8192
    v_add_f32 v231, v231, v165
    v_mfma_f32_16x16x32_bf16 v[80:83], v[212:215], v[188:191], v[80:83]
    s_add_u32 m0, s25, 16384
    s_nop 0
    buffer_load_dwordx4 v247, s[12:15], s27 offen nt lds
    ds_read_b128 v[208:211], v245
    v_exp_f32 v159, v159
    v_mfma_f32_16x16x32_bf16 v[20:23], v[216:219], v[172:175], v[20:23]
    buffer_load_dwordx4 v247, s[12:15], s27 offen offset:1024 nt lds
    s_add_u32 s27, s27, 8192
    v_mfma_f32_16x16x32_bf16 v[52:55], v[216:219], v[180:183], v[52:55]
    v_exp_f32 v167, v167
    v_mfma_f32_16x16x32_bf16 v[84:87], v[216:219], v[188:191], v[84:87]
    ds_read_b128 v[212:215], v242 offset:1024
    v_cvt_pk_bf16_f32 v156, v156, v157
    v_mfma_f32_16x16x32_bf16 v[24:27], v[220:223], v[172:175], v[24:27]
    v_cvt_pk_bf16_f32 v164, v164, v165
    v_mfma_f32_16x16x32_bf16 v[56:59], v[220:223], v[180:183], v[56:59]
    v_add_f32 v228, v228, v158
    v_mfma_f32_16x16x32_bf16 v[88:91], v[220:223], v[188:191], v[88:91]
    ds_read_b128 v[216:219], v243 offset:1024
    v_add_f32 v230, v230, v166
    v_add_f32 v229, v229, v159
    v_mfma_f32_16x16x32_bf16 v[28:31], v[224:227], v[172:175], v[28:31]
    v_add_f32 v231, v231, v167
    v_mfma_f32_16x16x32_bf16 v[60:63], v[224:227], v[180:183], v[60:63]
    v_cvt_pk_bf16_f32 v157, v158, v159
    v_mfma_f32_16x16x32_bf16 v[92:95], v[224:227], v[188:191], v[92:95]
    ds_read_b128 v[220:223], v244 offset:1024
    v_cvt_pk_bf16_f32 v165, v166, v167
    s_branch VAR_37_j
VAR_38_t:
    v_exp_f32 v188, v188
    v_exp_f32 v189, v189
    v_add_f32 v232, v232, v188
    v_exp_f32 v190, v190
    v_add_f32 v233, v233, v189
    v_exp_f32 v191, v191
    v_cvt_pk_bf16_f32 v188, v188, v189
    v_add_f32 v232, v232, v190
    v_add_f32 v233, v233, v191
    v_cvt_pk_bf16_f32 v189, v190, v191
    v_exp_f32 v192, v192
    v_exp_f32 v193, v193
    v_add_f32 v232, v232, v192
    v_exp_f32 v194, v194
    v_add_f32 v233, v233, v193
    v_exp_f32 v195, v195
    v_cvt_pk_bf16_f32 v190, v192, v193
    v_add_f32 v232, v232, v194
    v_add_f32 v233, v233, v195
    v_cvt_pk_bf16_f32 v191, v194, v195
    s_branch VAR_38_j
VAR_39_t:
    s_waitcnt lgkmcnt(6)
    v_mfma_f32_16x16x32_bf16 v[172:175], v[196:199], v[96:99], v[144:147]
    v_exp_f32 v160, v160
    v_mfma_f32_16x16x32_bf16 v[180:183], v[196:199], v[112:115], v[148:151]
    v_mfma_f32_16x16x32_bf16 v[188:191], v[196:199], v[128:131], v[152:155]
    ds_read_b128 v[224:227], v245 offset:1024
    v_exp_f32 v168, v168
    s_waitcnt lgkmcnt(6)
    v_mfma_f32_16x16x32_bf16 v[172:175], v[200:203], v[100:103], v[172:175]
    v_mfma_f32_16x16x32_bf16 v[180:183], v[200:203], v[116:119], v[180:183]
    v_exp_f32 v161, v161
    v_mfma_f32_16x16x32_bf16 v[188:191], v[200:203], v[132:135], v[188:191]
    ds_read_b64_tr_b16 v[196:197], v234
    ds_read_b64_tr_b16 v[198:199], v234 offset:1024
    v_exp_f32 v169, v169
    s_waitcnt lgkmcnt(7)
    v_mfma_f32_16x16x32_bf16 v[172:175], v[204:207], v[104:107], v[172:175]
    v_mfma_f32_16x16x32_bf16 v[180:183], v[204:207], v[120:123], v[180:183]
    v_add_f32 v228, v228, v160
    v_mfma_f32_16x16x32_bf16 v[188:191], v[204:207], v[136:139], v[188:191]
    ds_read_b64_tr_b16 v[200:201], v235
    ds_read_b64_tr_b16 v[202:203], v235 offset:1024
    v_add_f32 v230, v230, v168
    s_waitcnt lgkmcnt(8)
    v_mfma_f32_16x16x32_bf16 v[172:175], v[208:211], v[108:111], v[172:175]
    v_exp_f32 v162, v162
    v_mfma_f32_16x16x32_bf16 v[180:183], v[208:211], v[124:127], v[180:183]
    v_mfma_f32_16x16x32_bf16 v[188:191], v[208:211], v[140:143], v[188:191]
    ds_read_b64_tr_b16 v[204:205], v236
    ds_read_b64_tr_b16 v[206:207], v236 offset:1024
    v_exp_f32 v170, v170
    s_waitcnt lgkmcnt(9)
    v_mfma_f32_16x16x32_bf16 v[176:179], v[212:215], v[96:99], v[144:147]
    v_add_f32 v229, v229, v161
    v_mfma_f32_16x16x32_bf16 v[184:187], v[212:215], v[112:115], v[148:151]
    v_add_f32 v231, v231, v169
    v_mfma_f32_16x16x32_bf16 v[192:195], v[212:215], v[128:131], v[152:155]
    ds_read_b64_tr_b16 v[208:209], v237
    ds_read_b64_tr_b16 v[210:211], v237 offset:1024
    v_exp_f32 v163, v163
    s_waitcnt lgkmcnt(10)
    v_mfma_f32_16x16x32_bf16 v[176:179], v[216:219], v[100:103], v[176:179]
    v_mfma_f32_16x16x32_bf16 v[184:187], v[216:219], v[116:119], v[184:187]
    v_exp_f32 v171, v171
    v_mfma_f32_16x16x32_bf16 v[192:195], v[216:219], v[132:135], v[192:195]
    ds_read_b64_tr_b16 v[212:213], v238
    ds_read_b64_tr_b16 v[214:215], v238 offset:1024
    v_cvt_pk_bf16_f32 v158, v160, v161
    s_waitcnt lgkmcnt(11)
    v_mfma_f32_16x16x32_bf16 v[176:179], v[220:223], v[104:107], v[176:179]
    v_cvt_pk_bf16_f32 v166, v168, v169
    v_mfma_f32_16x16x32_bf16 v[184:187], v[220:223], v[120:123], v[184:187]
    v_add_f32 v228, v228, v162
    v_mfma_f32_16x16x32_bf16 v[192:195], v[220:223], v[136:139], v[192:195]
    ds_read_b64_tr_b16 v[216:217], v239
    ds_read_b64_tr_b16 v[218:219], v239 offset:1024
    v_add_f32 v230, v230, v170
    v_add_f32 v229, v229, v163
    s_waitcnt lgkmcnt(12)
    v_mfma_f32_16x16x32_bf16 v[176:179], v[224:227], v[108:111], v[176:179]
    v_add_f32 v231, v231, v171
    v_mfma_f32_16x16x32_bf16 v[184:187], v[224:227], v[124:127], v[184:187]
    v_cvt_pk_bf16_f32 v159, v162, v163
    v_mfma_f32_16x16x32_bf16 v[192:195], v[224:227], v[140:143], v[192:195]
    ds_read_b64_tr_b16 v[220:221], v240
    ds_read_b64_tr_b16 v[222:223], v240 offset:1024
    v_cvt_pk_bf16_f32 v167, v170, v171
    s_branch VAR_39_j
VAR_40_t:
    s_waitcnt lgkmcnt(12)
    v_mfma_f32_16x16x32_bf16 v[0:3], v[196:199], v[156:159], v[0:3]
    v_exp_f32 v172, v172
    v_mfma_f32_16x16x32_bf16 v[32:35], v[196:199], v[164:167], v[32:35]
    v_mfma_f32_16x16x32_bf16 v[64:67], v[196:199], v[188:191], v[64:67]
    ds_read_b64_tr_b16 v[224:225], v241
    ds_read_b64_tr_b16 v[226:227], v241 offset:1024
    v_exp_f32 v180, v180
    s_waitcnt lgkmcnt(12)
    v_mfma_f32_16x16x32_bf16 v[4:7], v[200:203], v[156:159], v[4:7]
    v_mfma_f32_16x16x32_bf16 v[36:39], v[200:203], v[164:167], v[36:39]
    v_exp_f32 v173, v173
    v_mfma_f32_16x16x32_bf16 v[68:71], v[200:203], v[188:191], v[68:71]
    v_exp_f32 v181, v181
    s_waitcnt lgkmcnt(10)
    v_mfma_f32_16x16x32_bf16 v[8:11], v[204:207], v[156:159], v[8:11]
    v_mfma_f32_16x16x32_bf16 v[40:43], v[204:207], v[164:167], v[40:43]
    v_add_f32 v228, v228, v172
    v_mfma_f32_16x16x32_bf16 v[72:75], v[204:207], v[188:191], v[72:75]
    v_add_f32 v230, v230, v180
    s_waitcnt lgkmcnt(8)
    v_mfma_f32_16x16x32_bf16 v[12:15], v[208:211], v[156:159], v[12:15]
    v_exp_f32 v174, v174
    v_mfma_f32_16x16x32_bf16 v[44:47], v[208:211], v[164:167], v[44:47]
    v_mfma_f32_16x16x32_bf16 v[76:79], v[208:211], v[188:191], v[76:79]
    s_waitcnt vmcnt(5) lgkmcnt(0)
    s_barrier
    ds_read_b128 v[196:199], v242 offset:8192
    ds_read_b128 v[200:203], v243 offset:8192
    ds_read_b128 v[204:207], v244 offset:8192
    v_exp_f32 v182, v182
    v_mfma_f32_16x16x32_bf16 v[16:19], v[212:215], v[156:159], v[16:19]
    s_add_u32 m0, s25, 65536
    s_nop 0
    buffer_load_dwordx4 v246, s[8:11], s26 offen nt lds
    v_add_f32 v229, v229, v173
    v_mfma_f32_16x16x32_bf16 v[48:51], v[212:215], v[164:167], v[48:51]
    buffer_load_dwordx4 v246, s[8:11], s26 offen offset:1024 nt lds
    s_add_u32 s26, s26, 8192
    v_add_f32 v231, v231, v181
    v_mfma_f32_16x16x32_bf16 v[80:83], v[212:215], v[188:191], v[80:83]
    s_add_u32 m0, s25, 24576
    s_nop 0
    buffer_load_dwordx4 v247, s[12:15], s27 offen nt lds
    ds_read_b128 v[208:211], v245 offset:8192
    v_exp_f32 v175, v175
    v_mfma_f32_16x16x32_bf16 v[20:23], v[216:219], v[156:159], v[20:23]
    buffer_load_dwordx4 v247, s[12:15], s27 offen offset:1024 nt lds
    s_add_u32 s27, s27, 8192
    v_mfma_f32_16x16x32_bf16 v[52:55], v[216:219], v[164:167], v[52:55]
    v_exp_f32 v183, v183
    v_mfma_f32_16x16x32_bf16 v[84:87], v[216:219], v[188:191], v[84:87]
    ds_read_b128 v[212:215], v242 offset:9216
    v_cvt_pk_bf16_f32 v172, v172, v173
    v_mfma_f32_16x16x32_bf16 v[24:27], v[220:223], v[156:159], v[24:27]
    v_cvt_pk_bf16_f32 v180, v180, v181
    v_mfma_f32_16x16x32_bf16 v[56:59], v[220:223], v[164:167], v[56:59]
    v_add_f32 v228, v228, v174
    v_mfma_f32_16x16x32_bf16 v[88:91], v[220:223], v[188:191], v[88:91]
    ds_read_b128 v[216:219], v243 offset:9216
    v_add_f32 v230, v230, v182
    v_add_f32 v229, v229, v175
    v_mfma_f32_16x16x32_bf16 v[28:31], v[224:227], v[156:159], v[28:31]
    v_add_f32 v231, v231, v183
    v_mfma_f32_16x16x32_bf16 v[60:63], v[224:227], v[164:167], v[60:63]
    v_cvt_pk_bf16_f32 v173, v174, v175
    v_mfma_f32_16x16x32_bf16 v[92:95], v[224:227], v[188:191], v[92:95]
    ds_read_b128 v[220:223], v244 offset:9216
    v_cvt_pk_bf16_f32 v181, v182, v183
    s_branch VAR_40_j
VAR_41_t:
    v_exp_f32 v188, v188
    v_exp_f32 v189, v189
    v_add_f32 v232, v232, v188
    v_exp_f32 v190, v190
    v_add_f32 v233, v233, v189
    v_exp_f32 v191, v191
    v_cvt_pk_bf16_f32 v188, v188, v189
    v_add_f32 v232, v232, v190
    v_add_f32 v233, v233, v191
    v_cvt_pk_bf16_f32 v189, v190, v191
    v_exp_f32 v192, v192
    v_exp_f32 v193, v193
    v_add_f32 v232, v232, v192
    v_exp_f32 v194, v194
    v_add_f32 v233, v233, v193
    v_exp_f32 v195, v195
    v_cvt_pk_bf16_f32 v190, v192, v193
    v_add_f32 v232, v232, v194
    v_add_f32 v233, v233, v195
    v_cvt_pk_bf16_f32 v191, v194, v195
    s_branch VAR_41_j
VAR_42_t:
    s_waitcnt lgkmcnt(6)
    v_mfma_f32_16x16x32_bf16 v[156:159], v[196:199], v[96:99], v[144:147]
    v_exp_f32 v176, v176
    v_mfma_f32_16x16x32_bf16 v[164:167], v[196:199], v[112:115], v[148:151]
    v_mfma_f32_16x16x32_bf16 v[188:191], v[196:199], v[128:131], v[152:155]
    ds_read_b128 v[224:227], v245 offset:9216
    v_exp_f32 v184, v184
    s_waitcnt lgkmcnt(6)
    v_mfma_f32_16x16x32_bf16 v[156:159], v[200:203], v[100:103], v[156:159]
    v_mfma_f32_16x16x32_bf16 v[164:167], v[200:203], v[116:119], v[164:167]
    v_exp_f32 v177, v177
    v_mfma_f32_16x16x32_bf16 v[188:191], v[200:203], v[132:135], v[188:191]
    ds_read_b64_tr_b16 v[196:197], v234 offset:8192
    ds_read_b64_tr_b16 v[198:199], v234 offset:9216
    v_exp_f32 v185, v185
    s_waitcnt lgkmcnt(7)
    v_mfma_f32_16x16x32_bf16 v[156:159], v[204:207], v[104:107], v[156:159]
    v_mfma_f32_16x16x32_bf16 v[164:167], v[204:207], v[120:123], v[164:167]
    v_add_f32 v228, v228, v176
    v_mfma_f32_16x16x32_bf16 v[188:191], v[204:207], v[136:139], v[188:191]
    ds_read_b64_tr_b16 v[200:201], v235 offset:8192
    ds_read_b64_tr_b16 v[202:203], v235 offset:9216
    v_add_f32 v230, v230, v184
    s_waitcnt lgkmcnt(8)
    v_mfma_f32_16x16x32_bf16 v[156:159], v[208:211], v[108:111], v[156:159]
    v_exp_f32 v178, v178
    v_mfma_f32_16x16x32_bf16 v[164:167], v[208:211], v[124:127], v[164:167]
    v_mfma_f32_16x16x32_bf16 v[188:191], v[208:211], v[140:143], v[188:191]
    ds_read_b64_tr_b16 v[204:205], v236 offset:8192
    ds_read_b64_tr_b16 v[206:207], v236 offset:9216
    v_exp_f32 v186, v186
    s_waitcnt lgkmcnt(9)
    v_mfma_f32_16x16x32_bf16 v[160:163], v[212:215], v[96:99], v[144:147]
    v_add_f32 v229, v229, v177
    v_mfma_f32_16x16x32_bf16 v[168:171], v[212:215], v[112:115], v[148:151]
    v_add_f32 v231, v231, v185
    v_mfma_f32_16x16x32_bf16 v[192:195], v[212:215], v[128:131], v[152:155]
    ds_read_b64_tr_b16 v[208:209], v237 offset:8192
    ds_read_b64_tr_b16 v[210:211], v237 offset:9216
    v_exp_f32 v179, v179
    s_waitcnt lgkmcnt(10)
    v_mfma_f32_16x16x32_bf16 v[160:163], v[216:219], v[100:103], v[160:163]
    v_mfma_f32_16x16x32_bf16 v[168:171], v[216:219], v[116:119], v[168:171]
    v_exp_f32 v187, v187
    v_mfma_f32_16x16x32_bf16 v[192:195], v[216:219], v[132:135], v[192:195]
    ds_read_b64_tr_b16 v[212:213], v238 offset:8192
    ds_read_b64_tr_b16 v[214:215], v238 offset:9216
    v_cvt_pk_bf16_f32 v174, v176, v177
    s_waitcnt lgkmcnt(11)
    v_mfma_f32_16x16x32_bf16 v[160:163], v[220:223], v[104:107], v[160:163]
    v_cvt_pk_bf16_f32 v182, v184, v185
    v_mfma_f32_16x16x32_bf16 v[168:171], v[220:223], v[120:123], v[168:171]
    v_add_f32 v228, v228, v178
    v_mfma_f32_16x16x32_bf16 v[192:195], v[220:223], v[136:139], v[192:195]
    ds_read_b64_tr_b16 v[216:217], v239 offset:8192
    ds_read_b64_tr_b16 v[218:219], v239 offset:9216
    v_add_f32 v230, v230, v186
    v_add_f32 v229, v229, v179
    s_waitcnt lgkmcnt(12)
    v_mfma_f32_16x16x32_bf16 v[160:163], v[224:227], v[108:111], v[160:163]
    v_add_f32 v231, v231, v187
    v_mfma_f32_16x16x32_bf16 v[168:171], v[224:227], v[124:127], v[168:171]
    v_cvt_pk_bf16_f32 v175, v178, v179
    v_mfma_f32_16x16x32_bf16 v[192:195], v[224:227], v[140:143], v[192:195]
    ds_read_b64_tr_b16 v[220:221], v240 offset:8192
    ds_read_b64_tr_b16 v[222:223], v240 offset:9216
    v_cvt_pk_bf16_f32 v183, v186, v187
    s_branch VAR_42_j
VAR_43_t:
    s_waitcnt lgkmcnt(12)
    v_mfma_f32_16x16x32_bf16 v[0:3], v[196:199], v[172:175], v[0:3]
    v_exp_f32 v156, v156
    v_mfma_f32_16x16x32_bf16 v[32:35], v[196:199], v[180:183], v[32:35]
    v_mfma_f32_16x16x32_bf16 v[64:67], v[196:199], v[188:191], v[64:67]
    ds_read_b64_tr_b16 v[224:225], v241 offset:8192
    ds_read_b64_tr_b16 v[226:227], v241 offset:9216
    v_exp_f32 v164, v164
    s_waitcnt lgkmcnt(12)
    v_mfma_f32_16x16x32_bf16 v[4:7], v[200:203], v[172:175], v[4:7]
    v_mfma_f32_16x16x32_bf16 v[36:39], v[200:203], v[180:183], v[36:39]
    v_exp_f32 v157, v157
    v_mfma_f32_16x16x32_bf16 v[68:71], v[200:203], v[188:191], v[68:71]
    v_exp_f32 v165, v165
    s_waitcnt lgkmcnt(10)
    v_mfma_f32_16x16x32_bf16 v[8:11], v[204:207], v[172:175], v[8:11]
    v_mfma_f32_16x16x32_bf16 v[40:43], v[204:207], v[180:183], v[40:43]
    v_add_f32 v228, v228, v156
    v_mfma_f32_16x16x32_bf16 v[72:75], v[204:207], v[188:191], v[72:75]
    v_add_f32 v230, v230, v164
    s_waitcnt lgkmcnt(8)
    v_mfma_f32_16x16x32_bf16 v[12:15], v[208:211], v[172:175], v[12:15]
    v_exp_f32 v158, v158
    v_mfma_f32_16x16x32_bf16 v[44:47], v[208:211], v[180:183], v[44:47]
    v_mfma_f32_16x16x32_bf16 v[76:79], v[208:211], v[188:191], v[76:79]
    s_waitcnt vmcnt(5) lgkmcnt(0)
    s_barrier
    ds_read_b128 v[196:199], v242 offset:16384
    ds_read_b128 v[200:203], v243 offset:16384
    ds_read_b128 v[204:207], v244 offset:16384
    v_exp_f32 v166, v166
    v_mfma_f32_16x16x32_bf16 v[16:19], v[212:215], v[172:175], v[16:19]
    s_add_u32 m0, s25, 73728
    s_nop 0
    buffer_load_dwordx4 v246, s[8:11], s26 offen nt lds
    v_add_f32 v229, v229, v157
    v_mfma_f32_16x16x32_bf16 v[48:51], v[212:215], v[180:183], v[48:51]
    buffer_load_dwordx4 v246, s[8:11], s26 offen offset:1024 nt lds
    s_add_u32 s26, s26, 8192
    v_add_f32 v231, v231, v165
    v_mfma_f32_16x16x32_bf16 v[80:83], v[212:215], v[188:191], v[80:83]
    s_add_u32 m0, s25, 32768
    s_nop 0
    buffer_load_dwordx4 v247, s[12:15], s27 offen nt lds
    ds_read_b128 v[208:211], v245 offset:16384
    v_exp_f32 v159, v159
    v_mfma_f32_16x16x32_bf16 v[20:23], v[216:219], v[172:175], v[20:23]
    buffer_load_dwordx4 v247, s[12:15], s27 offen offset:1024 nt lds
    s_add_u32 s27, s27, 8192
    v_mfma_f32_16x16x32_bf16 v[52:55], v[216:219], v[180:183], v[52:55]
    v_exp_f32 v167, v167
    v_mfma_f32_16x16x32_bf16 v[84:87], v[216:219], v[188:191], v[84:87]
    ds_read_b128 v[212:215], v242 offset:17408
    v_cvt_pk_bf16_f32 v156, v156, v157
    v_mfma_f32_16x16x32_bf16 v[24:27], v[220:223], v[172:175], v[24:27]
    v_cvt_pk_bf16_f32 v164, v164, v165
    v_mfma_f32_16x16x32_bf16 v[56:59], v[220:223], v[180:183], v[56:59]
    v_add_f32 v228, v228, v158
    v_mfma_f32_16x16x32_bf16 v[88:91], v[220:223], v[188:191], v[88:91]
    ds_read_b128 v[216:219], v243 offset:17408
    v_add_f32 v230, v230, v166
    v_add_f32 v229, v229, v159
    v_mfma_f32_16x16x32_bf16 v[28:31], v[224:227], v[172:175], v[28:31]
    v_add_f32 v231, v231, v167
    v_mfma_f32_16x16x32_bf16 v[60:63], v[224:227], v[180:183], v[60:63]
    v_cvt_pk_bf16_f32 v157, v158, v159
    v_mfma_f32_16x16x32_bf16 v[92:95], v[224:227], v[188:191], v[92:95]
    ds_read_b128 v[220:223], v244 offset:17408
    v_cvt_pk_bf16_f32 v165, v166, v167
    s_branch VAR_43_j
VAR_44_t:
    v_exp_f32 v188, v188
    v_exp_f32 v189, v189
    v_add_f32 v232, v232, v188
    v_exp_f32 v190, v190
    v_add_f32 v233, v233, v189
    v_exp_f32 v191, v191
    v_cvt_pk_bf16_f32 v188, v188, v189
    v_add_f32 v232, v232, v190
    v_add_f32 v233, v233, v191
    v_cvt_pk_bf16_f32 v189, v190, v191
    v_exp_f32 v192, v192
    v_exp_f32 v193, v193
    v_add_f32 v232, v232, v192
    v_exp_f32 v194, v194
    v_add_f32 v233, v233, v193
    v_exp_f32 v195, v195
    v_cvt_pk_bf16_f32 v190, v192, v193
    v_add_f32 v232, v232, v194
    v_add_f32 v233, v233, v195
    v_cvt_pk_bf16_f32 v191, v194, v195
    s_branch VAR_44_j
VAR_45_t:
    s_waitcnt lgkmcnt(6)
    v_mfma_f32_16x16x32_bf16 v[172:175], v[196:199], v[96:99], v[144:147]
    v_exp_f32 v160, v160
    v_mfma_f32_16x16x32_bf16 v[180:183], v[196:199], v[112:115], v[148:151]
    v_mfma_f32_16x16x32_bf16 v[188:191], v[196:199], v[128:131], v[152:155]
    ds_read_b128 v[224:227], v245 offset:17408
    v_exp_f32 v168, v168
    s_waitcnt lgkmcnt(6)
    v_mfma_f32_16x16x32_bf16 v[172:175], v[200:203], v[100:103], v[172:175]
    v_mfma_f32_16x16x32_bf16 v[180:183], v[200:203], v[116:119], v[180:183]
    v_exp_f32 v161, v161
    v_mfma_f32_16x16x32_bf16 v[188:191], v[200:203], v[132:135], v[188:191]
    ds_read_b64_tr_b16 v[196:197], v234 offset:16384
    ds_read_b64_tr_b16 v[198:199], v234 offset:17408
    v_exp_f32 v169, v169
    s_waitcnt lgkmcnt(7)
    v_mfma_f32_16x16x32_bf16 v[172:175], v[204:207], v[104:107], v[172:175]
    v_mfma_f32_16x16x32_bf16 v[180:183], v[204:207], v[120:123], v[180:183]
    v_add_f32 v228, v228, v160
    v_mfma_f32_16x16x32_bf16 v[188:191], v[204:207], v[136:139], v[188:191]
    ds_read_b64_tr_b16 v[200:201], v235 offset:16384
    ds_read_b64_tr_b16 v[202:203], v235 offset:17408
    v_add_f32 v230, v230, v168
    s_waitcnt lgkmcnt(8)
    v_mfma_f32_16x16x32_bf16 v[172:175], v[208:211], v[108:111], v[172:175]
    v_exp_f32 v162, v162
    v_mfma_f32_16x16x32_bf16 v[180:183], v[208:211], v[124:127], v[180:183]
    v_mfma_f32_16x16x32_bf16 v[188:191], v[208:211], v[140:143], v[188:191]
    ds_read_b64_tr_b16 v[204:205], v236 offset:16384
    ds_read_b64_tr_b16 v[206:207], v236 offset:17408
    v_exp_f32 v170, v170
    s_waitcnt lgkmcnt(9)
    v_mfma_f32_16x16x32_bf16 v[176:179], v[212:215], v[96:99], v[144:147]
    v_add_f32 v229, v229, v161
    v_mfma_f32_16x16x32_bf16 v[184:187], v[212:215], v[112:115], v[148:151]
    v_add_f32 v231, v231, v169
    v_mfma_f32_16x16x32_bf16 v[192:195], v[212:215], v[128:131], v[152:155]
    ds_read_b64_tr_b16 v[208:209], v237 offset:16384
    ds_read_b64_tr_b16 v[210:211], v237 offset:17408
    v_exp_f32 v163, v163
    s_waitcnt lgkmcnt(10)
    v_mfma_f32_16x16x32_bf16 v[176:179], v[216:219], v[100:103], v[176:179]
    v_mfma_f32_16x16x32_bf16 v[184:187], v[216:219], v[116:119], v[184:187]
    v_exp_f32 v171, v171
    v_mfma_f32_16x16x32_bf16 v[192:195], v[216:219], v[132:135], v[192:195]
    ds_read_b64_tr_b16 v[212:213], v238 offset:16384
    ds_read_b64_tr_b16 v[214:215], v238 offset:17408
    v_cvt_pk_bf16_f32 v158, v160, v161
    s_waitcnt lgkmcnt(11)
    v_mfma_f32_16x16x32_bf16 v[176:179], v[220:223], v[104:107], v[176:179]
    v_cvt_pk_bf16_f32 v166, v168, v169
    v_mfma_f32_16x16x32_bf16 v[184:187], v[220:223], v[120:123], v[184:187]
    v_add_f32 v228, v228, v162
    v_mfma_f32_16x16x32_bf16 v[192:195], v[220:223], v[136:139], v[192:195]
    ds_read_b64_tr_b16 v[216:217], v239 offset:16384
    ds_read_b64_tr_b16 v[218:219], v239 offset:17408
    v_add_f32 v230, v230, v170
    v_add_f32 v229, v229, v163
    s_waitcnt lgkmcnt(12)
    v_mfma_f32_16x16x32_bf16 v[176:179], v[224:227], v[108:111], v[176:179]
    v_add_f32 v231, v231, v171
    v_mfma_f32_16x16x32_bf16 v[184:187], v[224:227], v[124:127], v[184:187]
    v_cvt_pk_bf16_f32 v159, v162, v163
    v_mfma_f32_16x16x32_bf16 v[192:195], v[224:227], v[140:143], v[192:195]
    ds_read_b64_tr_b16 v[220:221], v240 offset:16384
    ds_read_b64_tr_b16 v[222:223], v240 offset:17408
    v_cvt_pk_bf16_f32 v167, v170, v171
    s_branch VAR_45_j
VAR_46_t:
    s_waitcnt lgkmcnt(12)
    v_mfma_f32_16x16x32_bf16 v[0:3], v[196:199], v[156:159], v[0:3]
    v_exp_f32 v172, v172
    v_mfma_f32_16x16x32_bf16 v[32:35], v[196:199], v[164:167], v[32:35]
    v_mfma_f32_16x16x32_bf16 v[64:67], v[196:199], v[188:191], v[64:67]
    ds_read_b64_tr_b16 v[224:225], v241 offset:16384
    ds_read_b64_tr_b16 v[226:227], v241 offset:17408
    v_exp_f32 v180, v180
    s_waitcnt lgkmcnt(12)
    v_mfma_f32_16x16x32_bf16 v[4:7], v[200:203], v[156:159], v[4:7]
    v_mfma_f32_16x16x32_bf16 v[36:39], v[200:203], v[164:167], v[36:39]
    v_exp_f32 v173, v173
    v_mfma_f32_16x16x32_bf16 v[68:71], v[200:203], v[188:191], v[68:71]
    v_exp_f32 v181, v181
    s_waitcnt lgkmcnt(10)
    v_mfma_f32_16x16x32_bf16 v[8:11], v[204:207], v[156:159], v[8:11]
    v_mfma_f32_16x16x32_bf16 v[40:43], v[204:207], v[164:167], v[40:43]
    v_add_f32 v228, v228, v172
    v_mfma_f32_16x16x32_bf16 v[72:75], v[204:207], v[188:191], v[72:75]
    v_add_f32 v230, v230, v180
    s_waitcnt lgkmcnt(8)
    v_mfma_f32_16x16x32_bf16 v[12:15], v[208:211], v[156:159], v[12:15]
    v_exp_f32 v174, v174
    v_mfma_f32_16x16x32_bf16 v[44:47], v[208:211], v[164:167], v[44:47]
    v_mfma_f32_16x16x32_bf16 v[76:79], v[208:211], v[188:191], v[76:79]
    s_waitcnt vmcnt(4) lgkmcnt(0)
    s_barrier
    ds_read_b128 v[196:199], v242 offset:24576
    ds_read_b128 v[200:203], v243 offset:24576
    ds_read_b128 v[204:207], v244 offset:24576
    v_exp_f32 v182, v182
    v_mfma_f32_16x16x32_bf16 v[16:19], v[212:215], v[156:159], v[16:19]
    s_add_u32 m0, s25, 0
    s_nop 0
    buffer_load_dwordx4 v247, s[12:15], s27 offen nt lds
    v_add_f32 v229, v229, v173
    v_mfma_f32_16x16x32_bf16 v[48:51], v[212:215], v[164:167], v[48:51]
    buffer_load_dwordx4 v247, s[12:15], s27 offen offset:1024 nt lds
    s_add_u32 s27, s27, 8192
    v_add_f32 v231, v231, v181
    v_mfma_f32_16x16x32_bf16 v[80:83], v[212:215], v[188:191], v[80:83]
    ds_read_b128 v[208:211], v245 offset:24576
    v_exp_f32 v175, v175
    v_mfma_f32_16x16x32_bf16 v[20:23], v[216:219], v[156:159], v[20:23]
    v_mfma_f32_16x16x32_bf16 v[52:55], v[216:219], v[164:167], v[52:55]
    v_exp_f32 v183, v183
    v_mfma_f32_16x16x32_bf16 v[84:87], v[216:219], v[188:191], v[84:87]
    ds_read_b128 v[212:215], v242 offset:25600
    v_cvt_pk_bf16_f32 v172, v172, v173
    v_mfma_f32_16x16x32_bf16 v[24:27], v[220:223], v[156:159], v[24:27]
    v_cvt_pk_bf16_f32 v180, v180, v181
    v_mfma_f32_16x16x32_bf16 v[56:59], v[220:223], v[164:167], v[56:59]
    v_add_f32 v228, v228, v174
    v_mfma_f32_16x16x32_bf16 v[88:91], v[220:223], v[188:191], v[88:91]
    ds_read_b128 v[216:219], v243 offset:25600
    v_add_f32 v230, v230, v182
    v_add_f32 v229, v229, v175
    v_mfma_f32_16x16x32_bf16 v[28:31], v[224:227], v[156:159], v[28:31]
    v_add_f32 v231, v231, v183
    v_mfma_f32_16x16x32_bf16 v[60:63], v[224:227], v[164:167], v[60:63]
    v_cvt_pk_bf16_f32 v173, v174, v175
    v_mfma_f32_16x16x32_bf16 v[92:95], v[224:227], v[188:191], v[92:95]
    ds_read_b128 v[220:223], v244 offset:25600
    v_cvt_pk_bf16_f32 v181, v182, v183
    s_branch VAR_46_j
VAR_47_t:
    v_exp_f32 v188, v188
    v_exp_f32 v189, v189
    v_add_f32 v232, v232, v188
    v_exp_f32 v190, v190
    v_add_f32 v233, v233, v189
    v_exp_f32 v191, v191
    v_cvt_pk_bf16_f32 v188, v188, v189
    v_add_f32 v232, v232, v190
    v_add_f32 v233, v233, v191
    v_cvt_pk_bf16_f32 v189, v190, v191
    v_exp_f32 v192, v192
    v_exp_f32 v193, v193
    v_add_f32 v232, v232, v192
    v_exp_f32 v194, v194
    v_add_f32 v233, v233, v193
    v_exp_f32 v195, v195
    v_cvt_pk_bf16_f32 v190, v192, v193
    v_add_f32 v232, v232, v194
    v_add_f32 v233, v233, v195
    v_cvt_pk_bf16_f32 v191, v194, v195
    s_branch VAR_47_j
VAR_48_t:
    s_waitcnt lgkmcnt(6)
    v_mfma_f32_16x16x32_bf16 v[156:159], v[196:199], v[96:99], v[144:147]
    v_exp_f32 v176, v176
    v_mfma_f32_16x16x32_bf16 v[164:167], v[196:199], v[112:115], v[148:151]
    v_mfma_f32_16x16x32_bf16 v[188:191], v[196:199], v[128:131], v[152:155]
    ds_read_b128 v[224:227], v245 offset:25600
    v_exp_f32 v184, v184
    s_waitcnt lgkmcnt(6)
    v_mfma_f32_16x16x32_bf16 v[156:159], v[200:203], v[100:103], v[156:159]
    v_mfma_f32_16x16x32_bf16 v[164:167], v[200:203], v[116:119], v[164:167]
    v_exp_f32 v177, v177
    v_mfma_f32_16x16x32_bf16 v[188:191], v[200:203], v[132:135], v[188:191]
    ds_read_b64_tr_b16 v[196:197], v234 offset:24576
    ds_read_b64_tr_b16 v[198:199], v234 offset:25600
    v_exp_f32 v185, v185
    s_waitcnt lgkmcnt(7)
    v_mfma_f32_16x16x32_bf16 v[156:159], v[204:207], v[104:107], v[156:159]
    v_mfma_f32_16x16x32_bf16 v[164:167], v[204:207], v[120:123], v[164:167]
    v_add_f32 v228, v228, v176
    v_mfma_f32_16x16x32_bf16 v[188:191], v[204:207], v[136:139], v[188:191]
    ds_read_b64_tr_b16 v[200:201], v235 offset:24576
    ds_read_b64_tr_b16 v[202:203], v235 offset:25600
    v_add_f32 v230, v230, v184
    s_waitcnt lgkmcnt(8)
    v_mfma_f32_16x16x32_bf16 v[156:159], v[208:211], v[108:111], v[156:159]
    v_exp_f32 v178, v178
    v_mfma_f32_16x16x32_bf16 v[164:167], v[208:211], v[124:127], v[164:167]
    v_mfma_f32_16x16x32_bf16 v[188:191], v[208:211], v[140:143], v[188:191]
    ds_read_b64_tr_b16 v[204:205], v236 offset:24576
    ds_read_b64_tr_b16 v[206:207], v236 offset:25600
    v_exp_f32 v186, v186
    s_waitcnt lgkmcnt(9)
    v_mfma_f32_16x16x32_bf16 v[160:163], v[212:215], v[96:99], v[144:147]
    v_add_f32 v229, v229, v177
    v_mfma_f32_16x16x32_bf16 v[168:171], v[212:215], v[112:115], v[148:151]
    v_add_f32 v231, v231, v185
    v_mfma_f32_16x16x32_bf16 v[192:195], v[212:215], v[128:131], v[152:155]
    ds_read_b64_tr_b16 v[208:209], v237 offset:24576
    ds_read_b64_tr_b16 v[210:211], v237 offset:25600
    v_exp_f32 v179, v179
    s_waitcnt lgkmcnt(10)
    v_mfma_f32_16x16x32_bf16 v[160:163], v[216:219], v[100:103], v[160:163]
    v_mfma_f32_16x16x32_bf16 v[168:171], v[216:219], v[116:119], v[168:171]
    v_exp_f32 v187, v187
    v_mfma_f32_16x16x32_bf16 v[192:195], v[216:219], v[132:135], v[192:195]
    ds_read_b64_tr_b16 v[212:213], v238 offset:24576
    ds_read_b64_tr_b16 v[214:215], v238 offset:25600
    v_cvt_pk_bf16_f32 v174, v176, v177
    s_waitcnt lgkmcnt(11)
    v_mfma_f32_16x16x32_bf16 v[160:163], v[220:223], v[104:107], v[160:163]
    v_cvt_pk_bf16_f32 v182, v184, v185
    v_mfma_f32_16x16x32_bf16 v[168:171], v[220:223], v[120:123], v[168:171]
    v_add_f32 v228, v228, v178
    v_mfma_f32_16x16x32_bf16 v[192:195], v[220:223], v[136:139], v[192:195]
    ds_read_b64_tr_b16 v[216:217], v239 offset:24576
    ds_read_b64_tr_b16 v[218:219], v239 offset:25600
    v_add_f32 v230, v230, v186
    v_add_f32 v229, v229, v179
    s_waitcnt lgkmcnt(12)
    v_mfma_f32_16x16x32_bf16 v[160:163], v[224:227], v[108:111], v[160:163]
    v_add_f32 v231, v231, v187
    v_mfma_f32_16x16x32_bf16 v[168:171], v[224:227], v[124:127], v[168:171]
    v_cvt_pk_bf16_f32 v175, v178, v179
    v_mfma_f32_16x16x32_bf16 v[192:195], v[224:227], v[140:143], v[192:195]
    ds_read_b64_tr_b16 v[220:221], v240 offset:24576
    ds_read_b64_tr_b16 v[222:223], v240 offset:25600
    v_cvt_pk_bf16_f32 v183, v186, v187
    s_branch VAR_48_j
VAR_49_t:
    s_waitcnt lgkmcnt(12)
    v_mfma_f32_16x16x32_bf16 v[0:3], v[196:199], v[172:175], v[0:3]
    v_exp_f32 v156, v156
    v_mfma_f32_16x16x32_bf16 v[32:35], v[196:199], v[180:183], v[32:35]
    v_mfma_f32_16x16x32_bf16 v[64:67], v[196:199], v[188:191], v[64:67]
    ds_read_b64_tr_b16 v[224:225], v241 offset:24576
    ds_read_b64_tr_b16 v[226:227], v241 offset:25600
    v_exp_f32 v164, v164
    s_waitcnt lgkmcnt(12)
    v_mfma_f32_16x16x32_bf16 v[4:7], v[200:203], v[172:175], v[4:7]
    v_mfma_f32_16x16x32_bf16 v[36:39], v[200:203], v[180:183], v[36:39]
    v_exp_f32 v157, v157
    v_mfma_f32_16x16x32_bf16 v[68:71], v[200:203], v[188:191], v[68:71]
    v_exp_f32 v165, v165
    s_waitcnt lgkmcnt(10)
    v_mfma_f32_16x16x32_bf16 v[8:11], v[204:207], v[172:175], v[8:11]
    v_mfma_f32_16x16x32_bf16 v[40:43], v[204:207], v[180:183], v[40:43]
    v_add_f32 v228, v228, v156
    v_mfma_f32_16x16x32_bf16 v[72:75], v[204:207], v[188:191], v[72:75]
    v_add_f32 v230, v230, v164
    s_waitcnt lgkmcnt(8)
    v_mfma_f32_16x16x32_bf16 v[12:15], v[208:211], v[172:175], v[12:15]
    v_exp_f32 v158, v158
    v_mfma_f32_16x16x32_bf16 v[44:47], v[208:211], v[180:183], v[44:47]
    v_mfma_f32_16x16x32_bf16 v[76:79], v[208:211], v[188:191], v[76:79]
    s_waitcnt vmcnt(2) lgkmcnt(0)
    s_barrier
    ds_read_b128 v[196:199], v242 offset:32768
    ds_read_b128 v[200:203], v243 offset:32768
    ds_read_b128 v[204:207], v244 offset:32768
    v_exp_f32 v166, v166
    v_mfma_f32_16x16x32_bf16 v[16:19], v[212:215], v[172:175], v[16:19]
    v_add_f32 v229, v229, v157
    v_mfma_f32_16x16x32_bf16 v[48:51], v[212:215], v[180:183], v[48:51]
    v_add_f32 v231, v231, v165
    v_mfma_f32_16x16x32_bf16 v[80:83], v[212:215], v[188:191], v[80:83]
    ds_read_b128 v[208:211], v245 offset:32768
    v_exp_f32 v159, v159
    v_mfma_f32_16x16x32_bf16 v[20:23], v[216:219], v[172:175], v[20:23]
    v_mfma_f32_16x16x32_bf16 v[52:55], v[216:219], v[180:183], v[52:55]
    v_exp_f32 v167, v167
    v_mfma_f32_16x16x32_bf16 v[84:87], v[216:219], v[188:191], v[84:87]
    ds_read_b128 v[212:215], v242 offset:33792
    v_cvt_pk_bf16_f32 v156, v156, v157
    v_mfma_f32_16x16x32_bf16 v[24:27], v[220:223], v[172:175], v[24:27]
    v_cvt_pk_bf16_f32 v164, v164, v165
    v_mfma_f32_16x16x32_bf16 v[56:59], v[220:223], v[180:183], v[56:59]
    v_add_f32 v228, v228, v158
    v_mfma_f32_16x16x32_bf16 v[88:91], v[220:223], v[188:191], v[88:91]
    ds_read_b128 v[216:219], v243 offset:33792
    v_add_f32 v230, v230, v166
    v_add_f32 v229, v229, v159
    v_mfma_f32_16x16x32_bf16 v[28:31], v[224:227], v[172:175], v[28:31]
    v_add_f32 v231, v231, v167
    v_mfma_f32_16x16x32_bf16 v[60:63], v[224:227], v[180:183], v[60:63]
    v_cvt_pk_bf16_f32 v157, v158, v159
    v_mfma_f32_16x16x32_bf16 v[92:95], v[224:227], v[188:191], v[92:95]
    ds_read_b128 v[220:223], v244 offset:33792
    v_cvt_pk_bf16_f32 v165, v166, v167
    s_branch VAR_49_j
VAR_50_t:
    v_exp_f32 v188, v188
    v_exp_f32 v189, v189
    v_add_f32 v232, v232, v188
    v_exp_f32 v190, v190
    v_add_f32 v233, v233, v189
    v_exp_f32 v191, v191
    v_cvt_pk_bf16_f32 v188, v188, v189
    v_add_f32 v232, v232, v190
    v_add_f32 v233, v233, v191
    v_cvt_pk_bf16_f32 v189, v190, v191
    v_exp_f32 v192, v192
    v_exp_f32 v193, v193
    v_add_f32 v232, v232, v192
    v_exp_f32 v194, v194
    v_add_f32 v233, v233, v193
    v_exp_f32 v195, v195
    v_cvt_pk_bf16_f32 v190, v192, v193
    v_add_f32 v232, v232, v194
    v_add_f32 v233, v233, v195
    v_cvt_pk_bf16_f32 v191, v194, v195
    s_branch VAR_50_j
VAR_51_t:
    s_waitcnt lgkmcnt(6)
    v_mfma_f32_16x16x32_bf16 v[172:175], v[196:199], v[96:99], v[144:147]
    v_exp_f32 v160, v160
    v_mfma_f32_16x16x32_bf16 v[180:183], v[196:199], v[112:115], v[148:151]
    v_mfma_f32_16x16x32_bf16 v[188:191], v[196:199], v[128:131], v[152:155]
    ds_read_b128 v[224:227], v245 offset:33792
    v_exp_f32 v168, v168
    s_waitcnt lgkmcnt(6)
    v_mfma_f32_16x16x32_bf16 v[172:175], v[200:203], v[100:103], v[172:175]
    v_mfma_f32_16x16x32_bf16 v[180:183], v[200:203], v[116:119], v[180:183]
    v_exp_f32 v161, v161
    v_mfma_f32_16x16x32_bf16 v[188:191], v[200:203], v[132:135], v[188:191]
    ds_read_b64_tr_b16 v[196:197], v234 offset:32768
    ds_read_b64_tr_b16 v[198:199], v234 offset:33792
    v_exp_f32 v169, v169
    s_waitcnt lgkmcnt(7)
    v_mfma_f32_16x16x32_bf16 v[172:175], v[204:207], v[104:107], v[172:175]
    v_mfma_f32_16x16x32_bf16 v[180:183], v[204:207], v[120:123], v[180:183]
    v_add_f32 v228, v228, v160
    v_mfma_f32_16x16x32_bf16 v[188:191], v[204:207], v[136:139], v[188:191]
    ds_read_b64_tr_b16 v[200:201], v235 offset:32768
    ds_read_b64_tr_b16 v[202:203], v235 offset:33792
    v_add_f32 v230, v230, v168
    s_waitcnt lgkmcnt(8)
    v_mfma_f32_16x16x32_bf16 v[172:175], v[208:211], v[108:111], v[172:175]
    v_exp_f32 v162, v162
    v_mfma_f32_16x16x32_bf16 v[180:183], v[208:211], v[124:127], v[180:183]
    v_mfma_f32_16x16x32_bf16 v[188:191], v[208:211], v[140:143], v[188:191]
    ds_read_b64_tr_b16 v[204:205], v236 offset:32768
    ds_read_b64_tr_b16 v[206:207], v236 offset:33792
    v_exp_f32 v170, v170
    s_waitcnt lgkmcnt(9)
    v_mfma_f32_16x16x32_bf16 v[176:179], v[212:215], v[96:99], v[144:147]
    v_add_f32 v229, v229, v161
    v_mfma_f32_16x16x32_bf16 v[184:187], v[212:215], v[112:115], v[148:151]
    v_add_f32 v231, v231, v169
    v_mfma_f32_16x16x32_bf16 v[192:195], v[212:215], v[128:131], v[152:155]
    ds_read_b64_tr_b16 v[208:209], v237 offset:32768
    ds_read_b64_tr_b16 v[210:211], v237 offset:33792
    v_exp_f32 v163, v163
    s_waitcnt lgkmcnt(10)
    v_mfma_f32_16x16x32_bf16 v[176:179], v[216:219], v[100:103], v[176:179]
    v_mfma_f32_16x16x32_bf16 v[184:187], v[216:219], v[116:119], v[184:187]
    v_exp_f32 v171, v171
    v_mfma_f32_16x16x32_bf16 v[192:195], v[216:219], v[132:135], v[192:195]
    ds_read_b64_tr_b16 v[212:213], v238 offset:32768
    ds_read_b64_tr_b16 v[214:215], v238 offset:33792
    v_cvt_pk_bf16_f32 v158, v160, v161
    s_waitcnt lgkmcnt(11)
    v_mfma_f32_16x16x32_bf16 v[176:179], v[220:223], v[104:107], v[176:179]
    v_cvt_pk_bf16_f32 v166, v168, v169
    v_mfma_f32_16x16x32_bf16 v[184:187], v[220:223], v[120:123], v[184:187]
    v_add_f32 v228, v228, v162
    v_mfma_f32_16x16x32_bf16 v[192:195], v[220:223], v[136:139], v[192:195]
    ds_read_b64_tr_b16 v[216:217], v239 offset:32768
    ds_read_b64_tr_b16 v[218:219], v239 offset:33792
    v_add_f32 v230, v230, v170
    v_add_f32 v229, v229, v163
    s_waitcnt lgkmcnt(12)
    v_mfma_f32_16x16x32_bf16 v[176:179], v[224:227], v[108:111], v[176:179]
    v_add_f32 v231, v231, v171
    v_mfma_f32_16x16x32_bf16 v[184:187], v[224:227], v[124:127], v[184:187]
    v_cvt_pk_bf16_f32 v159, v162, v163
    v_mfma_f32_16x16x32_bf16 v[192:195], v[224:227], v[140:143], v[192:195]
    ds_read_b64_tr_b16 v[220:221], v240 offset:32768
    ds_read_b64_tr_b16 v[222:223], v240 offset:33792
    v_cvt_pk_bf16_f32 v167, v170, v171
    s_branch VAR_51_j
VAR_52_t:
    s_waitcnt lgkmcnt(12)
    v_mfma_f32_16x16x32_bf16 v[0:3], v[196:199], v[156:159], v[0:3]
    v_exp_f32 v172, v172
    v_mfma_f32_16x16x32_bf16 v[32:35], v[196:199], v[164:167], v[32:35]
    v_mfma_f32_16x16x32_bf16 v[64:67], v[196:199], v[188:191], v[64:67]
    ds_read_b64_tr_b16 v[224:225], v241 offset:32768
    ds_read_b64_tr_b16 v[226:227], v241 offset:33792
    v_exp_f32 v180, v180
    s_waitcnt lgkmcnt(12)
    v_mfma_f32_16x16x32_bf16 v[4:7], v[200:203], v[156:159], v[4:7]
    v_mfma_f32_16x16x32_bf16 v[36:39], v[200:203], v[164:167], v[36:39]
    v_exp_f32 v173, v173
    v_mfma_f32_16x16x32_bf16 v[68:71], v[200:203], v[188:191], v[68:71]
    v_exp_f32 v181, v181
    s_waitcnt lgkmcnt(10)
    v_mfma_f32_16x16x32_bf16 v[8:11], v[204:207], v[156:159], v[8:11]
    v_mfma_f32_16x16x32_bf16 v[40:43], v[204:207], v[164:167], v[40:43]
    v_add_f32 v228, v228, v172
    v_mfma_f32_16x16x32_bf16 v[72:75], v[204:207], v[188:191], v[72:75]
    v_add_f32 v230, v230, v180
    s_waitcnt lgkmcnt(8)
    v_mfma_f32_16x16x32_bf16 v[12:15], v[208:211], v[156:159], v[12:15]
    v_exp_f32 v174, v174
    v_mfma_f32_16x16x32_bf16 v[44:47], v[208:211], v[164:167], v[44:47]
    v_mfma_f32_16x16x32_bf16 v[76:79], v[208:211], v[188:191], v[76:79]
    s_waitcnt vmcnt(1) lgkmcnt(0)
    s_barrier
    ds_read_b64_tr_b16 v[196:197], v234
    ds_read_b64_tr_b16 v[198:199], v234 offset:1024
    ds_read_b64_tr_b16 v[200:201], v235
    ds_read_b64_tr_b16 v[202:203], v235 offset:1024
    ds_read_b64_tr_b16 v[204:205], v236
    ds_read_b64_tr_b16 v[206:207], v236 offset:1024
    v_exp_f32 v182, v182
    v_mfma_f32_16x16x32_bf16 v[16:19], v[212:215], v[156:159], v[16:19]
    v_add_f32 v229, v229, v173
    v_mfma_f32_16x16x32_bf16 v[48:51], v[212:215], v[164:167], v[48:51]
    v_add_f32 v231, v231, v181
    v_mfma_f32_16x16x32_bf16 v[80:83], v[212:215], v[188:191], v[80:83]
    ds_read_b64_tr_b16 v[208:209], v237
    ds_read_b64_tr_b16 v[210:211], v237 offset:1024
    v_exp_f32 v175, v175
    v_mfma_f32_16x16x32_bf16 v[20:23], v[216:219], v[156:159], v[20:23]
    v_mfma_f32_16x16x32_bf16 v[52:55], v[216:219], v[164:167], v[52:55]
    v_exp_f32 v183, v183
    v_mfma_f32_16x16x32_bf16 v[84:87], v[216:219], v[188:191], v[84:87]
    ds_read_b64_tr_b16 v[212:213], v238
    ds_read_b64_tr_b16 v[214:215], v238 offset:1024
    v_cvt_pk_bf16_f32 v172, v172, v173
    v_mfma_f32_16x16x32_bf16 v[24:27], v[220:223], v[156:159], v[24:27]
    v_cvt_pk_bf16_f32 v180, v180, v181
    v_mfma_f32_16x16x32_bf16 v[56:59], v[220:223], v[164:167], v[56:59]
    v_add_f32 v228, v228, v174
    v_mfma_f32_16x16x32_bf16 v[88:91], v[220:223], v[188:191], v[88:91]
    ds_read_b64_tr_b16 v[216:217], v239
    ds_read_b64_tr_b16 v[218:219], v239 offset:1024
    v_add_f32 v230, v230, v182
    v_add_f32 v229, v229, v175
    v_mfma_f32_16x16x32_bf16 v[28:31], v[224:227], v[156:159], v[28:31]
    v_add_f32 v231, v231, v183
    v_mfma_f32_16x16x32_bf16 v[60:63], v[224:227], v[164:167], v[60:63]
    v_cvt_pk_bf16_f32 v173, v174, v175
    v_mfma_f32_16x16x32_bf16 v[92:95], v[224:227], v[188:191], v[92:95]
    ds_read_b64_tr_b16 v[220:221], v240
    ds_read_b64_tr_b16 v[222:223], v240 offset:1024
    v_cvt_pk_bf16_f32 v181, v182, v183
    s_branch VAR_52_j
VAR_53_t:
    v_exp_f32 v188, v188
    v_exp_f32 v189, v189
    v_add_f32 v232, v232, v188
    v_exp_f32 v190, v190
    v_add_f32 v233, v233, v189
    v_exp_f32 v191, v191
    v_cvt_pk_bf16_f32 v188, v188, v189
    v_add_f32 v232, v232, v190
    v_add_f32 v233, v233, v191
    v_cvt_pk_bf16_f32 v189, v190, v191
    v_exp_f32 v192, v192
    v_exp_f32 v193, v193
    v_add_f32 v232, v232, v192
    v_exp_f32 v194, v194
    v_add_f32 v233, v233, v193
    v_exp_f32 v195, v195
    v_cvt_pk_bf16_f32 v190, v192, v193
    v_add_f32 v232, v232, v194
    v_add_f32 v233, v233, v195
    v_cvt_pk_bf16_f32 v191, v194, v195
    s_branch VAR_53_j
VAR_54_t:
    s_waitcnt lgkmcnt(12)
    v_mfma_f32_16x16x32_bf16 v[0:3], v[196:199], v[172:175], v[0:3]
    v_mfma_f32_16x16x32_bf16 v[32:35], v[196:199], v[180:183], v[32:35]
    v_mfma_f32_16x16x32_bf16 v[64:67], v[196:199], v[188:191], v[64:67]
    ds_read_b64_tr_b16 v[224:225], v241
    ds_read_b64_tr_b16 v[226:227], v241 offset:1024
    s_waitcnt lgkmcnt(12)
    v_mfma_f32_16x16x32_bf16 v[4:7], v[200:203], v[172:175], v[4:7]
    v_mfma_f32_16x16x32_bf16 v[36:39], v[200:203], v[180:183], v[36:39]
    v_mfma_f32_16x16x32_bf16 v[68:71], v[200:203], v[188:191], v[68:71]
    s_waitcnt lgkmcnt(10)
    v_mfma_f32_16x16x32_bf16 v[8:11], v[204:207], v[172:175], v[8:11]
    v_mfma_f32_16x16x32_bf16 v[40:43], v[204:207], v[180:183], v[40:43]
    v_mfma_f32_16x16x32_bf16 v[72:75], v[204:207], v[188:191], v[72:75]
    s_waitcnt lgkmcnt(8)
    v_mfma_f32_16x16x32_bf16 v[12:15], v[208:211], v[172:175], v[12:15]
    v_mfma_f32_16x16x32_bf16 v[44:47], v[208:211], v[180:183], v[44:47]
    v_mfma_f32_16x16x32_bf16 v[76:79], v[208:211], v[188:191], v[76:79]
    s_waitcnt lgkmcnt(6)
    v_mfma_f32_16x16x32_bf16 v[16:19], v[212:215], v[172:175], v[16:19]
    v_mfma_f32_16x16x32_bf16 v[48:51], v[212:215], v[180:183], v[48:51]
    v_mfma_f32_16x16x32_bf16 v[80:83], v[212:215], v[188:191], v[80:83]
    s_waitcnt lgkmcnt(4)
    v_mfma_f32_16x16x32_bf16 v[20:23], v[216:219], v[172:175], v[20:23]
    v_mfma_f32_16x16x32_bf16 v[52:55], v[216:219], v[180:183], v[52:55]
    v_mfma_f32_16x16x32_bf16 v[84:87], v[216:219], v[188:191], v[84:87]
    s_waitcnt lgkmcnt(2)
    v_mfma_f32_16x16x32_bf16 v[24:27], v[220:223], v[172:175], v[24:27]
    v_mfma_f32_16x16x32_bf16 v[56:59], v[220:223], v[180:183], v[56:59]
    v_mfma_f32_16x16x32_bf16 v[88:91], v[220:223], v[188:191], v[88:91]
    s_waitcnt lgkmcnt(0)
    v_mfma_f32_16x16x32_bf16 v[28:31], v[224:227], v[172:175], v[28:31]
    v_mfma_f32_16x16x32_bf16 v[60:63], v[224:227], v[180:183], v[60:63]
    v_mfma_f32_16x16x32_bf16 v[92:95], v[224:227], v[188:191], v[92:95]
    s_branch VAR_54_j
VAR_55_t:
    buffer_store_dwordx4 v[0:3], v180, s[20:23], s61 offen sc1
    s_branch VAR_55_j
VAR_56_t:
    buffer_store_dwordx4 v[8:11], v181, s[20:23], s61 offen sc1
    s_branch VAR_56_j
VAR_57_t:
    buffer_store_dwordx4 v[16:19], v182, s[20:23], s61 offen sc1
    s_branch VAR_57_j
VAR_58_t:
    buffer_store_dwordx4 v[24:27], v183, s[20:23], s61 offen sc1
    s_branch VAR_58_j
VAR_59_t:
    buffer_store_dwordx4 v[32:35], v180, s[20:23], s61 offen sc1
    s_branch VAR_59_j
VAR_60_t:
    buffer_store_dwordx4 v[40:43], v181, s[20:23], s61 offen sc1
    s_branch VAR_60_j
VAR_61_t:
    buffer_store_dwordx4 v[48:51], v182, s[20:23], s61 offen sc1
    s_branch VAR_61_j
VAR_62_t:
    buffer_store_dwordx4 v[56:59], v183, s[20:23], s61 offen sc1
    s_branch VAR_62_j
VAR_63_t:
    buffer_store_dwordx4 v[64:67], v180, s[20:23], s61 offen sc1
    s_branch VAR_63_j

.section .rodata,"a"
.p2align 6
.amdhsa_kernel concat_heads__mha_block_cached__gqa_block_cached__near_ridge_kernel
  .amdhsa_next_free_vgpr 256
  .amdhsa_next_free_sgpr 102
  .amdhsa_accum_offset 256
  .amdhsa_group_segment_fixed_size 0
  .amdhsa_kernarg_size 104
  .amdhsa_user_sgpr_count 2
  .amdhsa_user_sgpr_kernarg_segment_ptr 1
  .amdhsa_system_sgpr_workgroup_id_x 1
.end_amdhsa_kernel
```
